```python
import torch

def _softmax(x, axis=-1):
    return torch.softmax(x, dim=axis)
def _gelu(x):
    return torch.nn.functional.gelu(x, approximate="tanh")
def _silu(x):
    return torch.nn.functional.silu(x)
def _sigmoid(x):
    return torch.sigmoid(x)
def _layernorm(x, axis=-1, eps=1e-5):
    m = x.mean(dim=axis, keepdim=True)
    v = x.var(dim=axis, keepdim=True, unbiased=False)
    return (x - m) / torch.sqrt(v + eps)
def _scatter_add(tgt, idx, src, axis=0):
    return tgt.clone().index_add_(axis, idx, src)
def _segment_sum(src, seg, n):
    out = torch.zeros((n,) + src.shape[1:], dtype=src.dtype)
    return out.index_add_(0, seg, src)
def _pad(x, pw):
    flat = tuple(v for pair in reversed(pw) for v in pair)
    return torch.nn.functional.pad(x, flat)

kernel_name = 'recurrent_scan__mha_block_cached__moe_arch_mod__prompt'

def setup_inputs():

    _w = (lambda a: (lambda t: t.to(torch.bfloat16) if t.is_floating_point() else t)(torch.as_tensor(a)))
    def _A_setup():
        B, Sq, D = 1, 2048, 512
        H, Sk, Dh = 32, 2048, 128
        return {
            "x": _w((lambda *s: torch.randn(*s, dtype=torch.bfloat16) * 0.05)(B, Sq, D)),
            "k_cache": _w((lambda *s: torch.randn(*s, dtype=torch.bfloat16) * 1.6)(B, H, Sk, Dh)),
            "v_cache": _w((lambda *s: torch.randn(*s, dtype=torch.bfloat16) * 0.2)(B, H, Sk, Dh)),
            "wq": _w((lambda *s: torch.randn(*s, dtype=torch.bfloat16) * 1.6)(D, H * Dh) * (D ** -0.5)),
            "wo": _w((lambda *s: torch.randn(*s, dtype=torch.bfloat16) * 0.2)(H * Dh, D) * ((H * Dh) ** -0.5)),
        }
    _A_in = _A_setup()

    def _B_setup():
        B, S, D, F, C = 1, 2048, 512, 1792, 8
        return {
            "x": _w((lambda *s: torch.randn(*s, dtype=torch.bfloat16) * 0.05)(B, S, D)),
            "w_r": _w((lambda *s: torch.randn(*s, dtype=torch.bfloat16) * 0.2)(D)),
            "w_gate": _w((lambda *s: torch.randn(*s, dtype=torch.bfloat16) * 0.1)(D, F)),
            "w_up": _w((lambda *s: torch.randn(*s, dtype=torch.bfloat16) * 0.1)(D, F)),
            "w_down": _w((lambda *s: torch.randn(*s, dtype=torch.bfloat16) * 0.1)(F, D)),
        }
    _B_in = _B_setup()

    return {
        "A_x": _A_in["x"],
        "A_k_cache": _A_in["k_cache"],
        "A_v_cache": _A_in["v_cache"],
        "A_wq": _A_in["wq"],
        "A_wo": _A_in["wo"],
        "B_x": _B_in["x"],
        "B_w_r": _B_in["w_r"],
        "B_w_gate": _B_in["w_gate"],
        "B_w_up": _B_in["w_up"],
        "B_w_down": _B_in["w_down"],
    }

def reference(A_x, A_k_cache, A_v_cache, A_wq, A_wo, B_x, B_w_r, B_w_gate, B_w_up, B_w_down):
    def _A_ref(x, k_cache, v_cache, wq, wo):
        B, Sq, D = x.shape
        H, Dh = 32, 128
        q = (lambda x, *d: x.permute(*d))((x @ wq).reshape(B, Sq, H, Dh), 0, 2, 1, 3)
        scores = torch.einsum("bhqd,bhkd->bhqk", q, k_cache) * (Dh ** -0.5)
        p = _softmax(scores, axis=-1)
        o = torch.einsum("bhqk,bhkd->bhqd", p, v_cache)
        return (lambda x, *d: x.permute(*d))(o, 0, 2, 1, 3).reshape(B, Sq, H * Dh) @ wo

    def _B_ref(x, w_r, w_gate, w_up, w_down):
        B, S, D = x.shape
        C = 8
        r = x @ w_r
        idx = torch.argsort(-r, axis=-1)[:, :C]
        idx_e = (lambda x, n, axis: torch.repeat_interleave(x, n, dim=axis))(idx.reshape(B, C, 1), D, axis=2)
        x_sel = (lambda x, i, axis: torch.take_along_dim(x, i, dim=axis))(x, idx_e, axis=1)
        g = _silu(x_sel @ w_gate)
        u = x_sel @ w_up
        y = (g * u) @ w_down
        r_sel = _sigmoid((lambda x, i, axis: torch.take_along_dim(x, i, dim=axis))(r, idx, axis=1))
        y = y * r_sel.reshape(B, C, 1)
        b_off = (torch.arange(B) * S).reshape(B, 1)
        flat_idx = (idx + b_off).reshape(B * C)
        zero = (x * 0.0).reshape(B * S, D)
        upd = _scatter_add(zero, flat_idx, y.reshape(B * C, D), axis=0)
        return x + upd.reshape(B, S, D)

    x = A_x
    xn = _layernorm(x, axis=-1)
    s = _A_ref(xn, A_k_cache, A_v_cache, A_wq, A_wo)
    g = _silu(_B_ref(xn, B_w_r, B_w_gate, B_w_up, B_w_down))
    return x + s * g
```

```asm
; @launch grid=(256,1,1) block=(256,1,1) lds=163840
.amdgcn_target "amdgcn-amd-amdhsa--gfx950"
.text
.globl recurrent_scan__mha_block_cached__moe_arch_mod__prompt_kernel
.p2align 12
.p2align 8
.type recurrent_scan__mha_block_cached__moe_arch_mod__prompt_kernel,@function
recurrent_scan__mha_block_cached__moe_arch_mod__prompt_kernel:
    s_cmp_ge_u32 s2, 256
    s_cbranch_scc1 L_end
    s_load_dwordx16 s[64:79], s[0:1], 0
    s_load_dwordx8 s[80:87], s[0:1], 64
    s_load_dwordx2 s[88:89], s[0:1], 96
    s_getpc_b64 s[42:43]
L_pc:
    s_bfe_u32 s3, s2, 0x50003
    s_lshl_b32 s3, s3, 11
    v_lshl_add_u32 v124, v0, 3, s3
    v_min_u32 v124, L_end-L_pc, v124
    v_mov_b32 v125, s43
    v_add_co_u32 v124, vcc, s42, v124
    s_nop 1
    v_addc_co_u32 v125, vcc, 0, v125, vcc
    global_load_dword v26, v[124:125], off
    v_and_b32 v1, 63, v0
    v_lshrrev_b32 v2, 6, v0
    v_and_b32 v3, 15, v0
    v_readfirstlane_b32 s28, v2
    v_lshrrev_b32 v4, 4, v1
    s_and_b32 s29, s2, 7
    s_lshl_b32 s29, s29, 2
    s_bfe_u32 s3, s2, 0x20003
    s_add_u32 s29, s29, s3
    s_lshr_b32 s30, s2, 5
    s_lshl_b32 s31, s28, 12
    s_lshl_b32 s36, s28, 13
    v_lshlrev_b32 v43, 4, v1
    v_lshl_add_u32 v51, v2, 11, v43
    s_lshl_b32 s60, s2, 13
    v_lshrrev_b32 v5, 3, v1
    v_lshlrev_b32 v5, 10, v5
    v_and_b32 v6, 7, v1
    v_xor_b32 v6, v6, v4
    v_lshl_add_u32 v64, v6, 4, v5
    v_xor_b32 v65, 64, v64
    v_add_u32 v71, 54272, v65
    v_add_u32 v70, 47104, v64
    v_add_u32 v69, 39936, v65
    v_add_u32 v68, 32768, v64
    v_add_u32 v67, 21504, v65
    v_add_u32 v66, 14336, v64
    v_add_u32 v65, 7168, v65
    v_lshl_add_u32 v5, v2, 4, v4
    v_lshlrev_b32 v5, 13, v5
    v_lshlrev_b32 v6, 2, v4
    v_xor_b32 v6, v6, v3
    v_lshl_add_u32 v72, v6, 4, v5
    v_add_u32 v73, 31744, v72
    v_add_u32 v74, 63488, v72
    v_add_u32 v75, 95232, v72
    s_lshl_b32 s34, s30, 18
    s_lshl_b32 s3, s28, 16
    s_add_u32 s34, s34, s3
    s_lshl_b32 s35, s29, 8
    s_mov_b32 s5, s34
    s_mov_b32 s6, s35
    s_and_b32 s96, s29, 3
    s_mul_i32 s96, s96, 1
    s_add_u32 s96, s96, s30
    s_mov_b32 s93, 0x76543210
    s_and_b32 s96, s96, 1
    s_cmp_eq_u32 s96, 1
    s_cselect_b32 s93, 0x67452301, s93
    s_add_u32 s96, s93, s2
    s_and_b32 s96, s96, 7
    s_lshr_b32 s93, s93, 4
    s_lshl_b32 s35, s96, 19
    s_lshl_b32 s96, s96, 7
    s_add_u32 s35, s35, s6
    s_add_u32 s34, s5, s96
    s_mov_b32 s10, 2097152
    s_mov_b32 s11, 0x00020000
    s_mov_b32 s14, 4194304
    s_mov_b32 s15, 0x00020000
    s_mov_b32 s26, 268435456
    s_mov_b32 s27, 0x00020000
    s_mov_b32 s18, 524288
    s_mov_b32 s19, 0x00020000
    s_mov_b32 s22, 524288
    s_mov_b32 s23, 0x00020000
    s_mov_b32 s50, 1024
    s_mov_b32 s51, 0x00020000
    s_mov_b32 s46, 256
    s_mov_b32 s47, 0x00020000
    s_mov_b32 s54, 4194304
    s_mov_b32 s55, 0x00020000
    s_waitcnt lgkmcnt(0)
    s_mov_b64 s[8:9], s[64:65]
    s_mov_b64 s[12:13], s[70:71]
    s_mov_b64 s[24:25], s[88:89]
    s_cmp_eq_u32 s2, 0
    s_cbranch_scc1 L_clear
L_clear_ok:
    s_add_u32 m0, s31, 98304
    s_nop 0
    buffer_load_dwordx4 v72, s[12:15], s35 offen offset:0 lds
    v_lshrrev_b32 v5, 1, v3
    v_xor_b32 v5, v5, v4
    v_lshlrev_b32 v5, 4, v5
    v_lshl_add_u32 v5, v3, 7, v5
    v_lshl_add_u32 v76, v2, 13, v5
    v_xor_b32 v77, 64, v76
    v_add_u32 v78, 131072, v76
    v_add_u32 v79, 131072, v77
    buffer_load_dwordx4 v73, s[12:15], s35 offen offset:1024 lds
    v_lshrrev_b32 v5, 2, v3
    v_lshl_add_u32 v5, v4, 3, v5
    v_lshlrev_b32 v5, 8, v5
    v_add_u32 v5, 65536, v5
    v_lshlrev_b32 v6, 6, v2
    v_lshl_add_u32 v80, v3, 4, v5
    v_xor_b32 v80, v80, v6
    v_xor_b32 v81, 64, v80
    v_xor_b32 v82, 128, v80
    v_xor_b32 v83, 192, v80
    buffer_load_dwordx4 v74, s[12:15], s35 offen offset:2048 lds
    v_lshrrev_b32 v5, 4, v1
    v_xor_b32 v5, v5, v1
    v_and_b32 v5, 2, v5
    v_cmp_eq_u32 vcc, 0, v5
    v_mov_b32 v6, 0x3f803f80
    s_nop 0
    v_cndmask_b32 v5, 0, v6, vcc
    v_accvgpr_write_b32 a136, v5
    v_accvgpr_write_b32 a140, 0
    v_accvgpr_write_b32 a137, v5
    v_accvgpr_write_b32 a141, 0
    v_accvgpr_write_b32 a138, v5
    v_accvgpr_write_b32 a142, 0
    v_accvgpr_write_b32 a139, v5
    v_accvgpr_write_b32 a143, 0
    buffer_load_dwordx4 v75, s[12:15], s35 offen offset:3072 lds
    v_mov_b32 v6, 1073741824
    v_cmp_eq_u32 vcc, 0, v0
    v_cmp_eq_u32 s[94:95], 0, v1
    v_lshlrev_b32 v5, 3, v2
    v_cndmask_b32 v27, v6, 0, vcc
    v_and_b32 v28, 1, v1
    v_mul_u32_u24 v28, 0xaaaa, v28
    v_add_u32 v28, 17476, v28
    v_or_b32 v27, v27, v28
    v_cndmask_b32 v34, v6, v5, s[94:95]
    s_add_u32 m0, s36, 32768
    s_nop 0
    buffer_load_dwordx4 v64, s[8:11], s34 offen offset:0 lds
    s_lshl_b32 s3, s29, 19
    s_add_u32 s16, s66, s3
    s_addc_u32 s17, s67, 0
    s_add_u32 s20, s68, s3
    s_addc_u32 s21, s69, 0
    s_mov_b64 s[48:49], s[76:77]
    s_mov_b64 s[44:45], s[86:87]
    s_mov_b64 s[52:53], s[72:73]
    v_lshlrev_b32 v127, 4, v0
    s_lshl_b32 s92, s30, 12
    s_add_u32 s96, s93, s2
    buffer_load_dwordx4 v65, s[8:11], s34 offen offset:1024 lds
    s_lshl_b32 s61, s2, 5
    s_add_u32 s61, s61, 2097152
    s_add_u32 s58, s61, 8192
    s_lshl_b32 s97, s2, 3
    s_lshl_b32 s3, s28, 1
    s_add_u32 s97, s97, s3
    s_sub_u32 s97, 0x87ff, s97
    s_sub_u32 s98, s97, 1
    s_mov_b32 s32, 0
    s_mov_b32 s39, 0
    s_and_b32 s96, s96, 7
    buffer_load_dwordx4 v66, s[8:11], s34 offen offset:2048 lds
    s_and_b32 s43, s2, 7
    s_lshl_b32 s43, s43, 2
    s_lshr_b32 s43, 0x73526140, s43
    s_and_b32 s43, s43, 7
    s_lshl_b32 s43, s43, 5
    s_lshr_b32 s4, s2, 3
    s_add_u32 s43, s43, s4
    s_sub_u32 s43, s43, 1
    s_sub_u32 s4, s43, 112
    s_mov_b32 s33, 0
    s_mov_b32 s38, 0x80000
    s_mov_b32 s37, 0
    s_lshr_b32 s93, s93, 4
    buffer_load_dwordx4 v67, s[8:11], s34 offen offset:3072 lds
    s_cmp_lt_u32 s43, 176
    s_cselect_b32 s33, 30, s33
    s_cselect_b32 s38, 0xc80000, s38
    s_cmp_lt_u32 s43, 112
    s_cselect_b32 s33, 21, s33
    s_cselect_b32 s38, 0x1c080000, s38
    s_cselect_b32 s4, s43, s4
    s_cselect_b32 s70, 0, 1073741824
    v_add_u32 v42, s70, v43
    s_cmp_eq_u32 s2, 0
    s_cselect_b32 s33, 10, s33
    s_cselect_b32 s38, 0xc0080000, s38
    s_add_u32 m0, s36, 36864
    s_nop 0
    buffer_load_dwordx4 v68, s[8:11], s34 offen offset:0 lds
    s_lshl_b32 s71, s4, 14
    s_and_b32 s71, s71, 0x1fffff
    s_add_u32 s71, s71, 3145728
    s_add_u32 s71, s71, s31
    s_lshl_b32 s59, s2, 5
    s_add_u32 s59, s59, 2112444
    s_lshl_b32 s35, s96, 19
    buffer_load_dwordx4 v69, s[8:11], s34 offen offset:1024 lds
    s_and_b32 s68, s29, 15
    s_lshl_b32 s68, s68, 1
    s_bfe_u32 s3, s2, 0x10002
    s_add_u32 s68, s68, s3
    s_and_b32 s7, s68, 28
    s_add_u32 s7, s7, s28
    s_lshl_b32 s7, s7, 8
    s_add_u32 s7, s7, 2129920
    s_lshl_b32 s69, s2, 13
    s_lshl_b32 s3, s28, 11
    s_add_u32 s69, s69, s3
    s_add_u32 s69, s69, 25165824
    s_lshl_b32 s96, s96, 7
    buffer_load_dwordx4 v70, s[8:11], s34 offen offset:2048 lds
    s_getpc_b64 s[42:43]
L_pc2:
    s_lshr_b32 s3, s2, 3
    s_lshl_b32 s3, s3, 2
    s_add_u32 s3, s3, s28
    s_lshl_b32 s3, s3, 9
    s_add_u32 s3, s3, L_last-L_pc2
    v_and_b32 v5, 3, v1
    v_lshl_add_u32 v5, v5, 7, s3
    v_min_u32 v5, L_end-L_pc2, v5
    v_mov_b32 v29, s43
    v_add_co_u32 v28, vcc, s42, v5
    s_nop 1
    v_addc_co_u32 v29, vcc, 0, v29, vcc
    s_add_u32 s35, s35, s6
    buffer_load_dwordx4 v71, s[8:11], s34 offen offset:3072 lds
    s_lshl_b32 s90, s30, 10
    s_lshl_b32 s3, s28, 8
    s_add_u32 s90, s90, s3
    s_add_u32 s90, s90, 2105344
    s_lshl_b32 s94, s30, 7
    s_andn2_b32 s95, 4, s2
    s_lshl_b32 s62, s30, 18
    s_lshl_b32 s3, s28, 10
    s_add_u32 s62, s62, s3
    s_and_b32 s3, s29, 3
    s_lshl_b32 s3, s3, 12
    s_add_u32 s62, s62, s3
    s_and_b32 s3, s2, 7
    s_lshl_b32 s3, s3, 21
    s_add_u32 s62, s62, s3
    s_add_u32 s34, s5, s96
    s_mov_b64 exec, 0
    s_cmp_eq_u32 s28, 0
    s_cbranch_scc1 L_pad0
    s_cmp_eq_u32 s28, 1
    s_cbranch_scc1 L_pad1
    s_cmp_eq_u32 s28, 2
    s_cbranch_scc1 L_pad2
    s_branch L_pad3
L_clear:
    v_lshlrev_b32 v5, 4, v0
    v_mov_b32 v120, 0
    v_mov_b32 v121, 0
    v_mov_b32 v122, 0
    v_mov_b32 v123, 0
    s_mov_b32 s3, 2097152
    buffer_store_dwordx4 v[120:123], v5, s[24:27], s3 offen sc1
    s_add_u32 s3, s3, 4096
    buffer_store_dwordx4 v[120:123], v5, s[24:27], s3 offen sc1
    s_add_u32 s3, s3, 4096
    buffer_store_dwordx4 v[120:123], v5, s[24:27], s3 offen sc1
    s_add_u32 s3, s3, 4096
    buffer_store_dwordx4 v[120:123], v5, s[24:27], s3 offen sc1
    s_add_u32 s3, s3, 4096
    v_mov_b32 v116, -1
    v_mov_b32 v117, -1
    v_mov_b32 v118, -1
    v_mov_b32 v119, -1
    buffer_store_dwordx4 v[116:119], v5, s[24:27], s3 offen sc1
    s_add_u32 s3, s3, 4096
    buffer_store_dwordx4 v[116:119], v5, s[24:27], s3 offen sc1
    s_add_u32 s3, s3, 4096
    s_branch L_clear_ok
L_setgo:
    v_mov_b32 v5, 1
    v_lshlrev_b32 v6, 2, v2
    s_waitcnt vmcnt(12)
    buffer_store_dword v5, v6, s[44:47], 0 offen sc1
    s_branch L_setgo_ok
L_pad16:
L_pad17:
L_pad18:
L_pad19:
L_padret:
    s_mov_b64 exec, -1
    s_cmp_eq_u32 s2, 0
    s_cbranch_scc1 L_setgo
L_setgo_ok:
    buffer_load_dwordx4 v[84:87], v51, s[8:11], s60 offen
    buffer_load_dwordx4 v[88:91], v51, s[8:11], s60 offen offset:1024
    s_add_u32 m0, s31, 114688
    s_nop 0
    buffer_load_dwordx4 v72, s[12:15], s35 offen offset:0 lds
    buffer_load_dwordx4 v73, s[12:15], s35 offen offset:1024 lds
    buffer_load_dwordx4 v74, s[12:15], s35 offen offset:2048 lds
    buffer_load_dwordx4 v75, s[12:15], s35 offen offset:3072 lds
    s_add_u32 m0, s36, 131072
    s_nop 0
    buffer_load_dwordx4 v64, s[8:11], s34 offen offset:0 lds
    s_add_u32 s96, s93, s2
    buffer_load_dwordx4 v65, s[8:11], s34 offen offset:1024 lds
    s_and_b32 s96, s96, 7
    buffer_load_dwordx4 v66, s[8:11], s34 offen offset:2048 lds
    s_lshr_b32 s93, s93, 4
    buffer_load_dwordx4 v67, s[8:11], s34 offen offset:3072 lds
    s_add_u32 m0, s36, 135168
    s_nop 0
    buffer_load_dwordx4 v68, s[8:11], s34 offen offset:0 lds
    s_lshl_b32 s35, s96, 19
    buffer_load_dwordx4 v69, s[8:11], s34 offen offset:1024 lds
    s_lshl_b32 s96, s96, 7
    buffer_load_dwordx4 v70, s[8:11], s34 offen offset:2048 lds
    s_add_u32 s35, s35, s6
    buffer_load_dwordx4 v71, s[8:11], s34 offen offset:3072 lds
    s_add_u32 s34, s5, s96
    buffer_load_dwordx4 v[92:95], v43, s[48:51], 0 offen
    buffer_load_dword v26, v127, s[16:19], s92 offen
    buffer_load_dword v26, v127, s[20:23], s92 offen
    s_waitcnt vmcnt(17)
    s_barrier
    ds_read_b64_tr_b16 a[144:145], v80 offset:32768
    ds_read_b64_tr_b16 a[146:147], v80 offset:33792
    ds_read_b64_tr_b16 a[160:161], v80 offset:40960
    ds_read_b64_tr_b16 a[162:163], v80 offset:41984
    ds_read_b128 a[96:99], v76 offset:32768
    ds_read_b128 a[100:103], v77 offset:32768
    ds_read_b128 a[104:107], v76 offset:34816
    ds_read_b128 a[108:111], v77 offset:34816
    ds_read_b128 a[112:115], v76 offset:36864
    ds_read_b128 a[116:119], v77 offset:36864
    ds_read_b128 a[120:123], v76 offset:38912
    ds_read_b128 a[124:127], v77 offset:38912
    ds_read_b64_tr_b16 a[148:149], v80 offset:32776
    ds_read_b64_tr_b16 a[150:151], v80 offset:33800
    ds_read_b64_tr_b16 a[164:165], v80 offset:40968
    ds_read_b64_tr_b16 a[166:167], v80 offset:41992
    ds_read_b64_tr_b16 a[152:153], v81 offset:32768
    ds_read_b64_tr_b16 a[154:155], v81 offset:33792
    ds_read_b64_tr_b16 a[168:169], v81 offset:40960
    ds_read_b64_tr_b16 a[170:171], v81 offset:41984
    ds_read_b64_tr_b16 a[156:157], v81 offset:32776
    ds_read_b64_tr_b16 a[158:159], v81 offset:33800
    ds_read_b64_tr_b16 a[172:173], v81 offset:40968
    ds_read_b64_tr_b16 a[174:175], v81 offset:41992
    s_waitcnt lgkmcnt(15)
    v_mfma_f32_16x16x32_bf16 v[128:131], a[144:147], a[96:99], 0
    v_mfma_f32_16x16x32_bf16 v[128:131], a[160:163], a[100:103], v[128:131]
    s_add_u32 m0, s31, 65536
    s_waitcnt lgkmcnt(15)
    v_mfma_f32_16x16x32_bf16 v[160:163], a[160:163], a[108:111], 0
    v_mfma_f32_16x16x32_bf16 v[160:163], a[144:147], a[104:107], v[160:163]
    buffer_load_dwordx4 v72, s[12:15], s35 offen offset:0 lds
    s_waitcnt lgkmcnt(14)
    v_mfma_f32_16x16x32_bf16 v[192:195], a[144:147], a[112:115], 0
    v_mfma_f32_16x16x32_bf16 v[192:195], a[160:163], a[116:119], v[192:195]
    s_waitcnt vmcnt(16)
    s_waitcnt lgkmcnt(12)
    v_mfma_f32_16x16x32_bf16 v[224:227], a[160:163], a[124:127], 0
    v_lshlrev_b32 v96, 16, v84
    v_lshlrev_b32 v104, 16, v88
    v_mfma_f32_16x16x32_bf16 v[224:227], a[144:147], a[120:123], v[224:227]
    buffer_load_dwordx4 v73, s[12:15], s35 offen offset:1024 lds
    s_waitcnt lgkmcnt(8)
    v_mfma_f32_16x16x32_bf16 v[228:231], a[148:151], a[120:123], 0
    v_and_b32 v97, 0xffff0000, v84
    v_and_b32 v105, 0xffff0000, v88
    v_mfma_f32_16x16x32_bf16 v[228:231], a[164:167], a[124:127], v[228:231]
    v_lshlrev_b32 v98, 16, v85
    v_lshlrev_b32 v106, 16, v89
    v_mfma_f32_16x16x32_bf16 v[196:199], a[164:167], a[116:119], 0
    ds_read_b64_tr_b16 a[176:177], v82 offset:32768
    ds_read_b64_tr_b16 a[178:179], v82 offset:33792
    v_mfma_f32_16x16x32_bf16 v[196:199], a[148:151], a[112:115], v[196:199]
    buffer_load_dwordx4 v74, s[12:15], s35 offen offset:2048 lds
    v_mfma_f32_16x16x32_bf16 v[164:167], a[148:151], a[104:107], 0
    ds_read_b64_tr_b16 a[192:193], v82 offset:40960
    ds_read_b64_tr_b16 a[194:195], v82 offset:41984
    v_mfma_f32_16x16x32_bf16 v[164:167], a[164:167], a[108:111], v[164:167]
    v_and_b32 v99, 0xffff0000, v85
    v_and_b32 v107, 0xffff0000, v89
    v_mfma_f32_16x16x32_bf16 v[132:135], a[164:167], a[100:103], 0
    ds_read_b64_tr_b16 a[180:181], v82 offset:32776
    ds_read_b64_tr_b16 a[182:183], v82 offset:33800
    v_mfma_f32_16x16x32_bf16 v[132:135], a[148:151], a[96:99], v[132:135]
    buffer_load_dwordx4 v75, s[12:15], s35 offen offset:3072 lds
    v_smfmac_f32_16x16x64_bf16 a[140:143], a[136:139], a[160:167], v27
    ds_read_b64_tr_b16 a[196:197], v82 offset:40968
    ds_read_b64_tr_b16 a[198:199], v82 offset:41992
    v_smfmac_f32_16x16x64_bf16 a[140:143], a[136:139], a[144:151], v27
    s_add_u32 m0, s36, 0
    s_waitcnt lgkmcnt(12)
    v_mfma_f32_16x16x32_bf16 v[136:139], a[152:155], a[96:99], 0
    ds_read_b64_tr_b16 a[184:185], v83 offset:32768
    ds_read_b64_tr_b16 a[186:187], v83 offset:33792
    v_mfma_f32_16x16x32_bf16 v[136:139], a[168:171], a[100:103], v[136:139]
    buffer_load_dwordx4 v64, s[8:11], s34 offen offset:0 lds
    v_mfma_f32_16x16x32_bf16 v[168:171], a[168:171], a[108:111], 0
    ds_read_b64_tr_b16 a[200:201], v83 offset:40960
    ds_read_b64_tr_b16 a[202:203], v83 offset:41984
    v_mfma_f32_16x16x32_bf16 v[168:171], a[152:155], a[104:107], v[168:171]
    s_add_u32 s96, s93, s2
    v_lshlrev_b32 v100, 16, v86
    v_lshlrev_b32 v108, 16, v90
    v_mfma_f32_16x16x32_bf16 v[200:203], a[152:155], a[112:115], 0
    ds_read_b64_tr_b16 a[188:189], v83 offset:32776
    ds_read_b64_tr_b16 a[190:191], v83 offset:33800
    v_mfma_f32_16x16x32_bf16 v[200:203], a[168:171], a[116:119], v[200:203]
    buffer_load_dwordx4 v65, s[8:11], s34 offen offset:1024 lds
    v_mfma_f32_16x16x32_bf16 v[232:235], a[168:171], a[124:127], 0
    ds_read_b64_tr_b16 a[204:205], v83 offset:40968
    ds_read_b64_tr_b16 a[206:207], v83 offset:41992
    v_mfma_f32_16x16x32_bf16 v[232:235], a[152:155], a[120:123], v[232:235]
    s_and_b32 s96, s96, 7
    v_and_b32 v101, 0xffff0000, v86
    v_and_b32 v109, 0xffff0000, v90
    s_waitcnt lgkmcnt(15)
    v_mfma_f32_16x16x32_bf16 v[236:239], a[156:159], a[120:123], 0
    v_lshlrev_b32 v102, 16, v87
    v_lshlrev_b32 v110, 16, v91
    v_mfma_f32_16x16x32_bf16 v[236:239], a[172:175], a[124:127], v[236:239]
    buffer_load_dwordx4 v66, s[8:11], s34 offen offset:2048 lds
    v_mfma_f32_16x16x32_bf16 v[204:207], a[172:175], a[116:119], 0
    s_lshr_b32 s93, s93, 4
    v_and_b32 v103, 0xffff0000, v87
    v_and_b32 v111, 0xffff0000, v91
    v_mfma_f32_16x16x32_bf16 v[204:207], a[156:159], a[112:115], v[204:207]
    v_add_f32 v124, v96, v97
    v_add_f32 v125, v104, v105
    v_mfma_f32_16x16x32_bf16 v[172:175], a[156:159], a[104:107], 0
    v_add_f32 v124, v124, v98
    v_add_f32 v125, v125, v106
    v_mfma_f32_16x16x32_bf16 v[172:175], a[172:175], a[108:111], v[172:175]
    buffer_load_dwordx4 v67, s[8:11], s34 offen offset:3072 lds
    v_mfma_f32_16x16x32_bf16 v[140:143], a[172:175], a[100:103], 0
    s_add_u32 m0, s36, 4096
    v_add_f32 v124, v124, v99
    v_add_f32 v125, v125, v107
    v_mfma_f32_16x16x32_bf16 v[140:143], a[156:159], a[96:99], v[140:143]
    s_waitcnt vmcnt(11) lgkmcnt(0)
    s_barrier
    v_mfma_f32_16x16x32_bf16 v[144:147], a[176:179], a[96:99], 0
    ds_read_b128 a[208:211], v78 offset:0
    ds_read_b128 a[212:215], v79 offset:0
    v_mfma_f32_16x16x32_bf16 v[144:147], a[192:195], a[100:103], v[144:147]
    buffer_load_dwordx4 v68, s[8:11], s34 offen offset:0 lds
    v_mfma_f32_16x16x32_bf16 v[176:179], a[192:195], a[108:111], 0
    ds_read_b128 a[216:219], v78 offset:2048
    ds_read_b128 a[220:223], v79 offset:2048
    v_mfma_f32_16x16x32_bf16 v[176:179], a[176:179], a[104:107], v[176:179]
    s_lshl_b32 s35, s96, 19
    v_add_f32 v124, v124, v100
    v_add_f32 v125, v125, v108
    v_mfma_f32_16x16x32_bf16 v[208:211], a[176:179], a[112:115], 0
    ds_read_b128 a[224:227], v78 offset:4096
    ds_read_b128 a[228:231], v79 offset:4096
    v_mfma_f32_16x16x32_bf16 v[208:211], a[192:195], a[116:119], v[208:211]
    buffer_load_dwordx4 v69, s[8:11], s34 offen offset:1024 lds
    v_mfma_f32_16x16x32_bf16 v[240:243], a[192:195], a[124:127], 0
    ds_read_b128 a[232:235], v78 offset:6144
    ds_read_b128 a[236:239], v79 offset:6144
    v_mfma_f32_16x16x32_bf16 v[240:243], a[176:179], a[120:123], v[240:243]
    s_lshl_b32 s96, s96, 7
    v_add_f32 v124, v124, v101
    v_add_f32 v125, v125, v109
    v_mfma_f32_16x16x32_bf16 v[244:247], a[180:183], a[120:123], 0
    ds_read_b64_tr_b16 a[144:145], v80 offset:49152
    ds_read_b64_tr_b16 a[146:147], v80 offset:50176
    v_mfma_f32_16x16x32_bf16 v[244:247], a[196:199], a[124:127], v[244:247]
    buffer_load_dwordx4 v70, s[8:11], s34 offen offset:2048 lds
    v_mfma_f32_16x16x32_bf16 v[212:215], a[196:199], a[116:119], 0
    ds_read_b64_tr_b16 a[160:161], v80 offset:57344
    ds_read_b64_tr_b16 a[162:163], v80 offset:58368
    v_mfma_f32_16x16x32_bf16 v[212:215], a[180:183], a[112:115], v[212:215]
    s_add_u32 s35, s35, s6
    v_add_f32 v124, v124, v102
    v_add_f32 v125, v125, v110
    v_mfma_f32_16x16x32_bf16 v[180:183], a[180:183], a[104:107], 0
    ds_read_b64_tr_b16 a[148:149], v80 offset:49160
    ds_read_b64_tr_b16 a[150:151], v80 offset:50184
    v_mfma_f32_16x16x32_bf16 v[180:183], a[196:199], a[108:111], v[180:183]
    buffer_load_dwordx4 v71, s[8:11], s34 offen offset:3072 lds
    v_mfma_f32_16x16x32_bf16 v[148:151], a[196:199], a[100:103], 0
    ds_read_b64_tr_b16 a[164:165], v80 offset:57352
    ds_read_b64_tr_b16 a[166:167], v80 offset:58376
    v_mfma_f32_16x16x32_bf16 v[148:151], a[180:183], a[96:99], v[148:151]
    s_add_u32 s34, s5, s96
    v_add_f32 v124, v124, v103
    v_add_f32 v125, v125, v111
    v_mfma_f32_16x16x32_bf16 v[152:155], a[184:187], a[96:99], 0
    ds_read_b64_tr_b16 a[152:153], v81 offset:49152
    ds_read_b64_tr_b16 a[154:155], v81 offset:50176
    v_mfma_f32_16x16x32_bf16 v[152:155], a[200:203], a[100:103], v[152:155]
    s_add_u32 m0, s31, 98304
    v_add_f32_dpp v124, v124, v124 quad_perm:[1,0,3,2] row_mask:0xf bank_mask:0xf
    v_add_f32_dpp v125, v125, v125 quad_perm:[1,0,3,2] row_mask:0xf bank_mask:0xf
    v_mfma_f32_16x16x32_bf16 v[184:187], a[200:203], a[108:111], 0
    ds_read_b64_tr_b16 a[168:169], v81 offset:57344
    ds_read_b64_tr_b16 a[170:171], v81 offset:58368
    v_mfma_f32_16x16x32_bf16 v[184:187], a[184:187], a[104:107], v[184:187]
    buffer_load_dwordx4 v72, s[12:15], s35 offen offset:0 lds
    v_mfma_f32_16x16x32_bf16 v[216:219], a[184:187], a[112:115], 0
    ds_read_b64_tr_b16 a[156:157], v81 offset:49160
    ds_read_b64_tr_b16 a[158:159], v81 offset:50184
    v_mfma_f32_16x16x32_bf16 v[216:219], a[200:203], a[116:119], v[216:219]
    v_add_f32_dpp v124, v124, v124 quad_perm:[2,3,0,1] row_mask:0xf bank_mask:0xf
    v_add_f32_dpp v125, v125, v125 quad_perm:[2,3,0,1] row_mask:0xf bank_mask:0xf
    v_mfma_f32_16x16x32_bf16 v[248:251], a[200:203], a[124:127], 0
    ds_read_b64_tr_b16 a[172:173], v81 offset:57352
    ds_read_b64_tr_b16 a[174:175], v81 offset:58376
    v_mfma_f32_16x16x32_bf16 v[248:251], a[184:187], a[120:123], v[248:251]
    buffer_load_dwordx4 v73, s[12:15], s35 offen offset:1024 lds
    v_mfma_f32_16x16x32_bf16 v[252:255], a[188:191], a[120:123], 0
    v_add_f32_dpp v124, v124, v124 row_half_mirror row_mask:0xf bank_mask:0xf
    v_add_f32_dpp v125, v125, v125 row_half_mirror row_mask:0xf bank_mask:0xf
    v_mfma_f32_16x16x32_bf16 v[252:255], a[204:207], a[124:127], v[252:255]
    v_add_f32_dpp v124, v124, v124 row_mirror row_mask:0xf bank_mask:0xf
    v_add_f32_dpp v125, v125, v125 row_mirror row_mask:0xf bank_mask:0xf
    v_mfma_f32_16x16x32_bf16 v[220:223], a[204:207], a[116:119], 0
    v_mov_b32 v122, v124
    v_mov_b32 v123, v125
    v_mfma_f32_16x16x32_bf16 v[220:223], a[188:191], a[112:115], v[220:223]
    buffer_load_dwordx4 v74, s[12:15], s35 offen offset:2048 lds
    v_mfma_f32_16x16x32_bf16 v[188:191], a[188:191], a[104:107], 0
    v_permlane16_swap_b32 v124, v122
    v_mfma_f32_16x16x32_bf16 v[188:191], a[204:207], a[108:111], v[188:191]
    v_permlane16_swap_b32 v125, v123
    v_mfma_f32_16x16x32_bf16 v[156:159], a[204:207], a[100:103], 0
    v_add_f32 v124, v124, v122
    v_add_f32 v125, v125, v123
    v_mfma_f32_16x16x32_bf16 v[156:159], a[188:191], a[96:99], v[156:159]
    s_waitcnt lgkmcnt(0)
    v_smfmac_f32_16x16x64_bf16 a[140:143], a[136:139], a[160:167], v27
L_pad0:
    s_cbranch_execz L_pad4
    ds_read_b64_tr_b16 a[176:177], v82 offset:49152
    ds_read_b64_tr_b16 a[178:179], v82 offset:50176
    v_smfmac_f32_16x16x64_bf16 a[140:143], a[136:139], a[144:151], v27
    buffer_load_dwordx4 v75, s[12:15], s35 offen offset:3072 lds
    v_mfma_f32_16x16x32_bf16 v[128:131], a[144:147], a[208:211], v[128:131]
    ds_read_b64_tr_b16 a[192:193], v82 offset:57344
    ds_read_b64_tr_b16 a[194:195], v82 offset:58368
    v_mfma_f32_16x16x32_bf16 v[128:131], a[160:163], a[212:215], v[128:131]
    s_add_u32 m0, s36, 32768
    v_mov_b32 v122, v124
    v_mov_b32 v123, v125
    v_mfma_f32_16x16x32_bf16 v[160:163], a[160:163], a[220:223], v[160:163]
    ds_read_b64_tr_b16 a[180:181], v82 offset:49160
    ds_read_b64_tr_b16 a[182:183], v82 offset:50184
    v_mfma_f32_16x16x32_bf16 v[160:163], a[144:147], a[216:219], v[160:163]
    buffer_load_dwordx4 v64, s[8:11], s34 offen offset:0 lds
    v_mfma_f32_16x16x32_bf16 v[192:195], a[144:147], a[224:227], v[192:195]
    ds_read_b64_tr_b16 a[196:197], v82 offset:57352
    ds_read_b64_tr_b16 a[198:199], v82 offset:58376
    v_mfma_f32_16x16x32_bf16 v[192:195], a[160:163], a[228:231], v[192:195]
    s_add_u32 s96, s93, s2
    v_permlane32_swap_b32 v124, v122
    v_mfma_f32_16x16x32_bf16 v[224:227], a[160:163], a[236:239], v[224:227]
    ds_read_b64_tr_b16 a[184:185], v83 offset:49152
    ds_read_b64_tr_b16 a[186:187], v83 offset:50176
    v_mfma_f32_16x16x32_bf16 v[224:227], a[144:147], a[232:235], v[224:227]
    buffer_load_dwordx4 v65, s[8:11], s34 offen offset:1024 lds
    v_mfma_f32_16x16x32_bf16 v[228:231], a[148:151], a[232:235], v[228:231]
    ds_read_b64_tr_b16 a[200:201], v83 offset:57344
    ds_read_b64_tr_b16 a[202:203], v83 offset:58368
    v_mfma_f32_16x16x32_bf16 v[228:231], a[164:167], a[236:239], v[228:231]
    s_and_b32 s96, s96, 7
    v_permlane32_swap_b32 v125, v123
    v_mfma_f32_16x16x32_bf16 v[196:199], a[164:167], a[228:231], v[196:199]
    ds_read_b64_tr_b16 a[188:189], v83 offset:49160
    ds_read_b64_tr_b16 a[190:191], v83 offset:50184
    v_mfma_f32_16x16x32_bf16 v[196:199], a[148:151], a[224:227], v[196:199]
    buffer_load_dwordx4 v66, s[8:11], s34 offen offset:2048 lds
    v_mfma_f32_16x16x32_bf16 v[164:167], a[148:151], a[216:219], v[164:167]
    ds_read_b64_tr_b16 a[204:205], v83 offset:57352
    ds_read_b64_tr_b16 a[206:207], v83 offset:58376
    v_mfma_f32_16x16x32_bf16 v[164:167], a[164:167], a[220:223], v[164:167]
    s_lshr_b32 s93, s93, 4
    v_add_f32 v124, v124, v122
    v_add_f32 v125, v125, v123
    v_mfma_f32_16x16x32_bf16 v[132:135], a[164:167], a[212:215], v[132:135]
    v_mul_f32 v124, 0x3b000000, v124
    v_mul_f32 v125, 0x3b000000, v125
    v_mfma_f32_16x16x32_bf16 v[132:135], a[148:151], a[208:211], v[132:135]
    buffer_load_dwordx4 v67, s[8:11], s34 offen offset:3072 lds
    v_mfma_f32_16x16x32_bf16 v[136:139], a[152:155], a[208:211], v[136:139]
    s_add_u32 m0, s36, 36864
    v_sub_f32 v122, v96, v124
    v_sub_f32 v123, v104, v125
    v_mfma_f32_16x16x32_bf16 v[136:139], a[168:171], a[212:215], v[136:139]
    v_mul_f32 v120, v122, v122
    v_mul_f32 v121, v123, v123
    v_mfma_f32_16x16x32_bf16 v[168:171], a[168:171], a[220:223], v[168:171]
    v_sub_f32 v122, v97, v124
    v_sub_f32 v123, v105, v125
    v_mfma_f32_16x16x32_bf16 v[168:171], a[152:155], a[216:219], v[168:171]
    buffer_load_dwordx4 v68, s[8:11], s34 offen offset:0 lds
    v_mfma_f32_16x16x32_bf16 v[200:203], a[152:155], a[224:227], v[200:203]
    s_lshl_b32 s35, s96, 19
    v_fmac_f32 v120, v122, v122
    v_fmac_f32 v121, v123, v123
    v_mfma_f32_16x16x32_bf16 v[200:203], a[168:171], a[228:231], v[200:203]
    v_sub_f32 v122, v98, v124
    v_sub_f32 v123, v106, v125
    v_mfma_f32_16x16x32_bf16 v[232:235], a[168:171], a[236:239], v[232:235]
    v_fmac_f32 v120, v122, v122
    v_fmac_f32 v121, v123, v123
    v_mfma_f32_16x16x32_bf16 v[232:235], a[152:155], a[232:235], v[232:235]
    buffer_load_dwordx4 v69, s[8:11], s34 offen offset:1024 lds
    v_mfma_f32_16x16x32_bf16 v[236:239], a[156:159], a[232:235], v[236:239]
    s_lshl_b32 s96, s96, 7
    v_sub_f32 v122, v99, v124
    v_sub_f32 v123, v107, v125
    v_mfma_f32_16x16x32_bf16 v[236:239], a[172:175], a[236:239], v[236:239]
    v_fmac_f32 v120, v122, v122
    v_fmac_f32 v121, v123, v123
    v_mfma_f32_16x16x32_bf16 v[204:207], a[172:175], a[228:231], v[204:207]
    v_sub_f32 v122, v100, v124
    v_sub_f32 v123, v108, v125
    v_mfma_f32_16x16x32_bf16 v[204:207], a[156:159], a[224:227], v[204:207]
    buffer_load_dwordx4 v70, s[8:11], s34 offen offset:2048 lds
    v_mfma_f32_16x16x32_bf16 v[172:175], a[156:159], a[216:219], v[172:175]
    s_add_u32 s35, s35, s6
    v_fmac_f32 v120, v122, v122
    v_fmac_f32 v121, v123, v123
    v_mfma_f32_16x16x32_bf16 v[172:175], a[172:175], a[220:223], v[172:175]
    v_sub_f32 v122, v101, v124
    v_sub_f32 v123, v109, v125
    v_mfma_f32_16x16x32_bf16 v[140:143], a[172:175], a[212:215], v[140:143]
    v_fmac_f32 v120, v122, v122
    v_fmac_f32 v121, v123, v123
    v_mfma_f32_16x16x32_bf16 v[140:143], a[156:159], a[208:211], v[140:143]
    s_waitcnt vmcnt(11) lgkmcnt(0)
    s_barrier
    v_mfma_f32_16x16x32_bf16 v[144:147], a[176:179], a[208:211], v[144:147]
    ds_read_b128 a[96:99], v76 offset:0
    ds_read_b128 a[100:103], v77 offset:0
    v_mfma_f32_16x16x32_bf16 v[144:147], a[192:195], a[212:215], v[144:147]
    buffer_load_dwordx4 v[116:119], off, s[44:47], 0 sc1
    v_mfma_f32_16x16x32_bf16 v[176:179], a[192:195], a[220:223], v[176:179]
    ds_read_b128 a[104:107], v76 offset:2048
    ds_read_b128 a[108:111], v77 offset:2048
    v_mfma_f32_16x16x32_bf16 v[176:179], a[176:179], a[216:219], v[176:179]
    v_sub_f32 v122, v102, v124
    v_sub_f32 v123, v110, v125
    v_mfma_f32_16x16x32_bf16 v[208:211], a[176:179], a[224:227], v[208:211]
    ds_read_b128 a[112:115], v76 offset:4096
    ds_read_b128 a[116:119], v77 offset:4096
    v_mfma_f32_16x16x32_bf16 v[208:211], a[192:195], a[228:231], v[208:211]
    buffer_load_dwordx4 v71, s[8:11], s34 offen offset:3072 lds
    v_mfma_f32_16x16x32_bf16 v[240:243], a[192:195], a[236:239], v[240:243]
    ds_read_b128 a[120:123], v76 offset:6144
    ds_read_b128 a[124:127], v77 offset:6144
    v_mfma_f32_16x16x32_bf16 v[240:243], a[176:179], a[232:235], v[240:243]
    s_add_u32 s34, s5, s96
    v_fmac_f32 v120, v122, v122
    v_fmac_f32 v121, v123, v123
    v_mfma_f32_16x16x32_bf16 v[244:247], a[180:183], a[232:235], v[244:247]
    ds_read_b64_tr_b16 a[144:145], v80 offset:0
    ds_read_b64_tr_b16 a[146:147], v80 offset:1024
    v_mfma_f32_16x16x32_bf16 v[244:247], a[196:199], a[236:239], v[244:247]
    s_add_u32 m0, s31, 114688
    v_sub_f32 v122, v103, v124
    v_sub_f32 v123, v111, v125
    v_mfma_f32_16x16x32_bf16 v[212:215], a[196:199], a[228:231], v[212:215]
    ds_read_b64_tr_b16 a[160:161], v80 offset:8192
    ds_read_b64_tr_b16 a[162:163], v80 offset:9216
    v_mfma_f32_16x16x32_bf16 v[212:215], a[180:183], a[224:227], v[212:215]
    buffer_load_dwordx4 v72, s[12:15], s35 offen offset:0 lds
    v_mfma_f32_16x16x32_bf16 v[180:183], a[180:183], a[216:219], v[180:183]
    ds_read_b64_tr_b16 a[148:149], v80 offset:8
    ds_read_b64_tr_b16 a[150:151], v80 offset:1032
    v_mfma_f32_16x16x32_bf16 v[180:183], a[196:199], a[220:223], v[180:183]
    v_fmac_f32 v120, v122, v122
    v_fmac_f32 v121, v123, v123
    v_mfma_f32_16x16x32_bf16 v[148:151], a[196:199], a[212:215], v[148:151]
    ds_read_b64_tr_b16 a[164:165], v80 offset:8200
    ds_read_b64_tr_b16 a[166:167], v80 offset:9224
    v_mfma_f32_16x16x32_bf16 v[148:151], a[180:183], a[208:211], v[148:151]
    buffer_load_dwordx4 v73, s[12:15], s35 offen offset:1024 lds
    v_mfma_f32_16x16x32_bf16 v[152:155], a[184:187], a[208:211], v[152:155]
    ds_read_b64_tr_b16 a[152:153], v81 offset:0
    ds_read_b64_tr_b16 a[154:155], v81 offset:1024
    v_mfma_f32_16x16x32_bf16 v[152:155], a[200:203], a[212:215], v[152:155]
    v_add_f32_dpp v120, v120, v120 quad_perm:[1,0,3,2] row_mask:0xf bank_mask:0xf
    v_add_f32_dpp v121, v121, v121 quad_perm:[1,0,3,2] row_mask:0xf bank_mask:0xf
    v_mfma_f32_16x16x32_bf16 v[184:187], a[200:203], a[220:223], v[184:187]
    ds_read_b64_tr_b16 a[168:169], v81 offset:8192
    ds_read_b64_tr_b16 a[170:171], v81 offset:9216
    v_mfma_f32_16x16x32_bf16 v[184:187], a[184:187], a[216:219], v[184:187]
    buffer_load_dwordx4 v74, s[12:15], s35 offen offset:2048 lds
    v_mfma_f32_16x16x32_bf16 v[216:219], a[184:187], a[224:227], v[216:219]
    ds_read_b64_tr_b16 a[156:157], v81 offset:8
    ds_read_b64_tr_b16 a[158:159], v81 offset:1032
    v_mfma_f32_16x16x32_bf16 v[216:219], a[200:203], a[228:231], v[216:219]
    v_add_f32_dpp v120, v120, v120 quad_perm:[2,3,0,1] row_mask:0xf bank_mask:0xf
    v_add_f32_dpp v121, v121, v121 quad_perm:[2,3,0,1] row_mask:0xf bank_mask:0xf
    v_mfma_f32_16x16x32_bf16 v[248:251], a[200:203], a[236:239], v[248:251]
    ds_read_b64_tr_b16 a[172:173], v81 offset:8200
    ds_read_b64_tr_b16 a[174:175], v81 offset:9224
    v_mfma_f32_16x16x32_bf16 v[248:251], a[184:187], a[232:235], v[248:251]
    buffer_load_dwordx4 v75, s[12:15], s35 offen offset:3072 lds
    v_mfma_f32_16x16x32_bf16 v[252:255], a[188:191], a[232:235], v[252:255]
    s_add_u32 m0, s36, 131072
    v_add_f32_dpp v120, v120, v120 row_half_mirror row_mask:0xf bank_mask:0xf
    v_add_f32_dpp v121, v121, v121 row_half_mirror row_mask:0xf bank_mask:0xf
    v_mfma_f32_16x16x32_bf16 v[252:255], a[204:207], a[236:239], v[252:255]
    v_add_f32_dpp v120, v120, v120 row_mirror row_mask:0xf bank_mask:0xf
    v_add_f32_dpp v121, v121, v121 row_mirror row_mask:0xf bank_mask:0xf
    v_mfma_f32_16x16x32_bf16 v[220:223], a[204:207], a[228:231], v[220:223]
    v_mov_b32 v122, v120
    v_mov_b32 v123, v121
    v_mfma_f32_16x16x32_bf16 v[220:223], a[188:191], a[224:227], v[220:223]
    buffer_load_dwordx4 v64, s[8:11], s34 offen offset:0 lds
    v_mfma_f32_16x16x32_bf16 v[188:191], a[188:191], a[216:219], v[188:191]
    s_add_u32 s96, s93, s2
    v_permlane16_swap_b32 v120, v122
    v_mfma_f32_16x16x32_bf16 v[188:191], a[204:207], a[220:223], v[188:191]
    v_permlane16_swap_b32 v121, v123
    v_mfma_f32_16x16x32_bf16 v[156:159], a[204:207], a[212:215], v[156:159]
    v_add_f32 v120, v120, v122
    v_add_f32 v121, v121, v123
    v_mfma_f32_16x16x32_bf16 v[156:159], a[188:191], a[208:211], v[156:159]
    s_waitcnt lgkmcnt(0)
    v_smfmac_f32_16x16x64_bf16 a[140:143], a[136:139], a[160:167], v27
    ds_read_b64_tr_b16 a[176:177], v82 offset:0
    ds_read_b64_tr_b16 a[178:179], v82 offset:1024
    v_smfmac_f32_16x16x64_bf16 a[140:143], a[136:139], a[144:151], v27
    buffer_load_dwordx4 v65, s[8:11], s34 offen offset:1024 lds
    v_mfma_f32_16x16x32_bf16 v[128:131], a[144:147], a[96:99], v[128:131]
    ds_read_b64_tr_b16 a[192:193], v82 offset:8192
    ds_read_b64_tr_b16 a[194:195], v82 offset:9216
    v_mfma_f32_16x16x32_bf16 v[128:131], a[160:163], a[100:103], v[128:131]
    s_and_b32 s96, s96, 7
    v_mov_b32 v122, v120
    v_mov_b32 v123, v121
    v_mfma_f32_16x16x32_bf16 v[160:163], a[160:163], a[108:111], v[160:163]
    ds_read_b64_tr_b16 a[180:181], v82 offset:8
    ds_read_b64_tr_b16 a[182:183], v82 offset:1032
    v_mfma_f32_16x16x32_bf16 v[160:163], a[144:147], a[104:107], v[160:163]
    buffer_load_dwordx4 v66, s[8:11], s34 offen offset:2048 lds
    v_mfma_f32_16x16x32_bf16 v[192:195], a[144:147], a[112:115], v[192:195]
    ds_read_b64_tr_b16 a[196:197], v82 offset:8200
    ds_read_b64_tr_b16 a[198:199], v82 offset:9224
    v_mfma_f32_16x16x32_bf16 v[192:195], a[160:163], a[116:119], v[192:195]
    s_lshr_b32 s93, s93, 4
    v_permlane32_swap_b32 v120, v122
    v_mfma_f32_16x16x32_bf16 v[224:227], a[160:163], a[124:127], v[224:227]
    ds_read_b64_tr_b16 a[184:185], v83 offset:0
    ds_read_b64_tr_b16 a[186:187], v83 offset:1024
    v_mfma_f32_16x16x32_bf16 v[224:227], a[144:147], a[120:123], v[224:227]
    buffer_load_dwordx4 v67, s[8:11], s34 offen offset:3072 lds
    v_mfma_f32_16x16x32_bf16 v[228:231], a[148:151], a[120:123], v[228:231]
    ds_read_b64_tr_b16 a[200:201], v83 offset:8192
    ds_read_b64_tr_b16 a[202:203], v83 offset:9216
    v_mfma_f32_16x16x32_bf16 v[228:231], a[164:167], a[124:127], v[228:231]
    s_add_u32 m0, s36, 135168
    v_permlane32_swap_b32 v121, v123
    v_mfma_f32_16x16x32_bf16 v[196:199], a[164:167], a[116:119], v[196:199]
    ds_read_b64_tr_b16 a[188:189], v83 offset:8
    ds_read_b64_tr_b16 a[190:191], v83 offset:1032
    v_mfma_f32_16x16x32_bf16 v[196:199], a[148:151], a[112:115], v[196:199]
    buffer_load_dwordx4 v68, s[8:11], s34 offen offset:0 lds
    v_mfma_f32_16x16x32_bf16 v[164:167], a[148:151], a[104:107], v[164:167]
    ds_read_b64_tr_b16 a[204:205], v83 offset:8200
    ds_read_b64_tr_b16 a[206:207], v83 offset:9224
    v_mfma_f32_16x16x32_bf16 v[164:167], a[164:167], a[108:111], v[164:167]
    s_lshl_b32 s35, s96, 19
    v_add_f32 v120, v120, v122
    v_add_f32 v121, v121, v123
    v_mfma_f32_16x16x32_bf16 v[132:135], a[164:167], a[100:103], v[132:135]
    v_mul_f32 v120, 0x3b000000, v120
    v_mul_f32 v121, 0x3b000000, v121
    v_mfma_f32_16x16x32_bf16 v[132:135], a[148:151], a[96:99], v[132:135]
    buffer_load_dwordx4 v69, s[8:11], s34 offen offset:1024 lds
    v_mfma_f32_16x16x32_bf16 v[136:139], a[152:155], a[96:99], v[136:139]
    s_lshl_b32 s96, s96, 7
    v_cvt_pk_bf16_f32 v124, v124, v124
    v_cvt_pk_bf16_f32 v125, v125, v125
    v_mfma_f32_16x16x32_bf16 v[136:139], a[168:171], a[100:103], v[136:139]
    v_and_b32 v124, 0xffff0000, v124
    v_and_b32 v125, 0xffff0000, v125
    v_mfma_f32_16x16x32_bf16 v[168:171], a[168:171], a[108:111], v[168:171]
    v_cvt_pk_bf16_f32 v120, v120, v120
    v_cvt_pk_bf16_f32 v121, v121, v121
    v_mfma_f32_16x16x32_bf16 v[168:171], a[152:155], a[104:107], v[168:171]
    buffer_load_dwordx4 v70, s[8:11], s34 offen offset:2048 lds
    v_mfma_f32_16x16x32_bf16 v[200:203], a[152:155], a[112:115], v[200:203]
    s_add_u32 s35, s35, s6
    v_and_b32 v120, 0xffff0000, v120
    v_and_b32 v121, 0xffff0000, v121
    v_mfma_f32_16x16x32_bf16 v[200:203], a[168:171], a[116:119], v[200:203]
    s_waitcnt vmcnt(12)
    v_and_b32 v116, v116, v117
    v_and_b32 v118, v118, v119
    v_mfma_f32_16x16x32_bf16 v[232:235], a[168:171], a[124:127], v[232:235]
    v_and_b32 v116, v116, v118
    v_mfma_f32_16x16x32_bf16 v[232:235], a[152:155], a[120:123], v[232:235]
    buffer_load_dwordx4 v71, s[8:11], s34 offen offset:3072 lds
    v_mfma_f32_16x16x32_bf16 v[236:239], a[156:159], a[120:123], v[236:239]
    s_add_u32 s34, s5, s96
    v_readfirstlane_b32 s42, v116
    v_mfma_f32_16x16x32_bf16 v[236:239], a[172:175], a[124:127], v[236:239]
    v_add_f32 v120, 0x3727c5ac, v120
    v_add_f32 v121, 0x3727c5ac, v121
    v_mfma_f32_16x16x32_bf16 v[204:207], a[172:175], a[116:119], v[204:207]
    s_cmp_lg_u32 s42, 0
    s_cbranch_scc0 L_go_wait
L_go_ok:
    v_mfma_f32_16x16x32_bf16 v[204:207], a[156:159], a[112:115], v[204:207]
    v_cvt_pk_bf16_f32 v120, v120, v120
    v_cvt_pk_bf16_f32 v121, v121, v121
    v_mfma_f32_16x16x32_bf16 v[172:175], a[156:159], a[104:107], v[172:175]
    v_and_b32 v120, 0xffff0000, v120
    v_and_b32 v121, 0xffff0000, v121
    v_mfma_f32_16x16x32_bf16 v[172:175], a[172:175], a[108:111], v[172:175]
    v_sqrt_f32 v120, v120
    v_mfma_f32_16x16x32_bf16 v[140:143], a[172:175], a[100:103], v[140:143]
    v_sqrt_f32 v121, v121
    v_mfma_f32_16x16x32_bf16 v[140:143], a[156:159], a[96:99], v[140:143]
    s_waitcnt vmcnt(12) lgkmcnt(0)
    s_barrier
    v_mfma_f32_16x16x32_bf16 v[144:147], a[176:179], a[96:99], v[144:147]
    ds_read_b128 a[208:211], v76 offset:32768
    ds_read_b128 a[212:215], v77 offset:32768
    v_mfma_f32_16x16x32_bf16 v[144:147], a[192:195], a[100:103], v[144:147]
    s_add_u32 m0, s31, 65536
    v_cvt_pk_bf16_f32 v120, v120, v120
    v_cvt_pk_bf16_f32 v121, v121, v121
    v_mfma_f32_16x16x32_bf16 v[176:179], a[192:195], a[108:111], v[176:179]
    ds_read_b128 a[216:219], v76 offset:34816
    ds_read_b128 a[220:223], v77 offset:34816
    v_mfma_f32_16x16x32_bf16 v[176:179], a[176:179], a[104:107], v[176:179]
    buffer_load_dwordx4 v72, s[12:15], s35 offen offset:0 lds
    v_mfma_f32_16x16x32_bf16 v[208:211], a[176:179], a[112:115], v[208:211]
    ds_read_b128 a[224:227], v76 offset:36864
    ds_read_b128 a[228:231], v77 offset:36864
    v_mfma_f32_16x16x32_bf16 v[208:211], a[192:195], a[116:119], v[208:211]
    v_and_b32 v120, 0xffff0000, v120
    v_and_b32 v121, 0xffff0000, v121
    v_mfma_f32_16x16x32_bf16 v[240:243], a[192:195], a[124:127], v[240:243]
    ds_read_b128 a[232:235], v76 offset:38912
    ds_read_b128 a[236:239], v77 offset:38912
    v_mfma_f32_16x16x32_bf16 v[240:243], a[176:179], a[120:123], v[240:243]
    buffer_load_dwordx4 v73, s[12:15], s35 offen offset:1024 lds
    v_mfma_f32_16x16x32_bf16 v[244:247], a[180:183], a[120:123], v[244:247]
    ds_read_b64_tr_b16 a[144:145], v80 offset:32768
    ds_read_b64_tr_b16 a[146:147], v80 offset:33792
    v_mfma_f32_16x16x32_bf16 v[244:247], a[196:199], a[124:127], v[244:247]
    v_lshrrev_b32 v122, 16, v124
    v_lshrrev_b32 v123, 16, v125
    v_mfma_f32_16x16x32_bf16 v[212:215], a[196:199], a[116:119], v[212:215]
    ds_read_b64_tr_b16 a[160:161], v80 offset:40960
    ds_read_b64_tr_b16 a[162:163], v80 offset:41984
    v_mfma_f32_16x16x32_bf16 v[212:215], a[180:183], a[112:115], v[212:215]
    buffer_load_dwordx4 v74, s[12:15], s35 offen offset:2048 lds
    v_mfma_f32_16x16x32_bf16 v[180:183], a[180:183], a[104:107], v[180:183]
    ds_read_b64_tr_b16 a[148:149], v80 offset:32776
    ds_read_b64_tr_b16 a[150:151], v80 offset:33800
    v_mfma_f32_16x16x32_bf16 v[180:183], a[196:199], a[108:111], v[180:183]
    v_or_b32 v40, v122, v120
    v_or_b32 v41, v123, v121
    v_mfma_f32_16x16x32_bf16 v[148:151], a[196:199], a[100:103], v[148:151]
    ds_read_b64_tr_b16 a[164:165], v80 offset:40968
    ds_read_b64_tr_b16 a[166:167], v80 offset:41992
    v_mfma_f32_16x16x32_bf16 v[148:151], a[180:183], a[96:99], v[148:151]
    buffer_load_dwordx4 v75, s[12:15], s35 offen offset:3072 lds
    v_mfma_f32_16x16x32_bf16 v[152:155], a[184:187], a[96:99], v[152:155]
    ds_read_b64_tr_b16 a[152:153], v81 offset:32768
    ds_read_b64_tr_b16 a[154:155], v81 offset:33792
    v_mfma_f32_16x16x32_bf16 v[152:155], a[200:203], a[100:103], v[152:155]
    s_add_u32 m0, s36, 0
    buffer_store_dwordx2 v[40:41], v34, s[24:27], s58 offen sc1
    v_mfma_f32_16x16x32_bf16 v[184:187], a[200:203], a[108:111], v[184:187]
    ds_read_b64_tr_b16 a[168:169], v81 offset:40960
    ds_read_b64_tr_b16 a[170:171], v81 offset:41984
    v_mfma_f32_16x16x32_bf16 v[184:187], a[184:187], a[104:107], v[184:187]
    buffer_load_dwordx4 v64, s[8:11], s34 offen offset:0 lds
    v_mfma_f32_16x16x32_bf16 v[216:219], a[184:187], a[112:115], v[216:219]
    ds_read_b64_tr_b16 a[156:157], v81 offset:32776
    ds_read_b64_tr_b16 a[158:159], v81 offset:33800
    v_mfma_f32_16x16x32_bf16 v[216:219], a[200:203], a[116:119], v[216:219]
    s_add_u32 s96, s93, s2
    v_lshlrev_b32 v55, 2, v3
    v_lshl_add_u32 v5, v2, 4, v4
    v_mfma_f32_16x16x32_bf16 v[248:251], a[200:203], a[124:127], v[248:251]
    ds_read_b64_tr_b16 a[172:173], v81 offset:40968
    ds_read_b64_tr_b16 a[174:175], v81 offset:41992
    v_mfma_f32_16x16x32_bf16 v[248:251], a[184:187], a[120:123], v[248:251]
    buffer_load_dwordx4 v65, s[8:11], s34 offen offset:1024 lds
    v_mfma_f32_16x16x32_bf16 v[252:255], a[188:191], a[120:123], v[252:255]
    s_and_b32 s96, s96, 7
    v_lshlrev_b32 v5, 8, v5
    v_xor_b32 v6, v3, v4
    v_mfma_f32_16x16x32_bf16 v[252:255], a[204:207], a[124:127], v[252:255]
    v_lshl_add_u32 v20, v6, 4, v5
    v_xor_b32 v21, 64, v20
    v_mfma_f32_16x16x32_bf16 v[220:223], a[204:207], a[116:119], v[220:223]
    v_xor_b32 v22, 128, v20
    v_xor_b32 v23, 192, v20
    v_mfma_f32_16x16x32_bf16 v[220:223], a[188:191], a[112:115], v[220:223]
    buffer_load_dwordx4 v66, s[8:11], s34 offen offset:2048 lds
    v_mfma_f32_16x16x32_bf16 v[188:191], a[188:191], a[104:107], v[188:191]
    s_lshr_b32 s93, s93, 4
    v_lshlrev_b32 v6, 1, v4
    v_xor_b32 v6, v6, v3
    v_mfma_f32_16x16x32_bf16 v[188:191], a[204:207], a[108:111], v[188:191]
    v_lshl_add_u32 v24, v6, 4, v5
    v_xor_b32 v25, 128, v24
    v_mfma_f32_16x16x32_bf16 v[156:159], a[204:207], a[100:103], v[156:159]
    v_lshlrev_b32 v112, 16, v92
    v_and_b32 v113, 0xffff0000, v92
    v_mfma_f32_16x16x32_bf16 v[156:159], a[188:191], a[96:99], v[156:159]
    s_waitcnt lgkmcnt(0)
    v_smfmac_f32_16x16x64_bf16 a[140:143], a[136:139], a[160:167], v27
    ds_read_b64_tr_b16 a[176:177], v82 offset:32768
    ds_read_b64_tr_b16 a[178:179], v82 offset:33792
    v_smfmac_f32_16x16x64_bf16 a[140:143], a[136:139], a[144:151], v27
    buffer_load_dwordx4 v67, s[8:11], s34 offen offset:3072 lds
    v_mfma_f32_16x16x32_bf16 v[128:131], a[144:147], a[208:211], v[128:131]
    ds_read_b64_tr_b16 a[192:193], v82 offset:40960
    ds_read_b64_tr_b16 a[194:195], v82 offset:41984
    v_mfma_f32_16x16x32_bf16 v[128:131], a[160:163], a[212:215], v[128:131]
    s_add_u32 m0, s36, 4096
    v_lshlrev_b32 v114, 16, v93
    v_and_b32 v115, 0xffff0000, v93
    v_mfma_f32_16x16x32_bf16 v[160:163], a[160:163], a[220:223], v[160:163]
    ds_read_b64_tr_b16 a[180:181], v82 offset:32776
    ds_read_b64_tr_b16 a[182:183], v82 offset:33800
    v_mfma_f32_16x16x32_bf16 v[160:163], a[144:147], a[216:219], v[160:163]
    buffer_load_dwordx4 v68, s[8:11], s34 offen offset:0 lds
    v_mfma_f32_16x16x32_bf16 v[192:195], a[144:147], a[224:227], v[192:195]
    ds_read_b64_tr_b16 a[196:197], v82 offset:40968
    ds_read_b64_tr_b16 a[198:199], v82 offset:41992
    v_mfma_f32_16x16x32_bf16 v[192:195], a[160:163], a[228:231], v[192:195]
    s_lshl_b32 s35, s96, 19
    v_lshlrev_b32 v116, 16, v94
    v_and_b32 v117, 0xffff0000, v94
    v_mfma_f32_16x16x32_bf16 v[224:227], a[160:163], a[236:239], v[224:227]
    ds_read_b64_tr_b16 a[184:185], v83 offset:32768
    ds_read_b64_tr_b16 a[186:187], v83 offset:33792
    v_mfma_f32_16x16x32_bf16 v[224:227], a[144:147], a[232:235], v[224:227]
    buffer_load_dwordx4 v69, s[8:11], s34 offen offset:1024 lds
    v_mfma_f32_16x16x32_bf16 v[228:231], a[148:151], a[232:235], v[228:231]
    ds_read_b64_tr_b16 a[200:201], v83 offset:40960
    ds_read_b64_tr_b16 a[202:203], v83 offset:41984
    v_mfma_f32_16x16x32_bf16 v[228:231], a[164:167], a[236:239], v[228:231]
    s_lshl_b32 s96, s96, 7
    v_lshlrev_b32 v118, 16, v95
    v_and_b32 v119, 0xffff0000, v95
    v_mfma_f32_16x16x32_bf16 v[196:199], a[164:167], a[228:231], v[196:199]
    ds_read_b64_tr_b16 a[188:189], v83 offset:32776
    ds_read_b64_tr_b16 a[190:191], v83 offset:33800
    v_mfma_f32_16x16x32_bf16 v[196:199], a[148:151], a[224:227], v[196:199]
    buffer_load_dwordx4 v70, s[8:11], s34 offen offset:2048 lds
    v_mfma_f32_16x16x32_bf16 v[164:167], a[148:151], a[216:219], v[164:167]
    ds_read_b64_tr_b16 a[204:205], v83 offset:40968
    ds_read_b64_tr_b16 a[206:207], v83 offset:41992
    v_mfma_f32_16x16x32_bf16 v[164:167], a[164:167], a[220:223], v[164:167]
    s_add_u32 s35, s35, s6
    v_rcp_f32 v120, v120
    v_mfma_f32_16x16x32_bf16 v[132:135], a[164:167], a[212:215], v[132:135]
    v_rcp_f32 v121, v121
    v_mfma_f32_16x16x32_bf16 v[132:135], a[148:151], a[208:211], v[132:135]
    buffer_load_dwordx4 v71, s[8:11], s34 offen offset:3072 lds
    v_mfma_f32_16x16x32_bf16 v[136:139], a[152:155], a[208:211], v[136:139]
    s_add_u32 s34, s5, s96
    v_sub_f32 v96, v96, v124
    v_sub_f32 v104, v104, v125
    v_mfma_f32_16x16x32_bf16 v[136:139], a[168:171], a[212:215], v[136:139]
    v_sub_f32 v97, v97, v124
    v_sub_f32 v105, v105, v125
    v_mfma_f32_16x16x32_bf16 v[168:171], a[168:171], a[220:223], v[168:171]
    v_sub_f32 v98, v98, v124
    v_sub_f32 v106, v106, v125
    v_mfma_f32_16x16x32_bf16 v[168:171], a[152:155], a[216:219], v[168:171]
    v_sub_f32 v99, v99, v124
    v_sub_f32 v107, v107, v125
    v_mfma_f32_16x16x32_bf16 v[200:203], a[152:155], a[224:227], v[200:203]
    v_sub_f32 v100, v100, v124
    v_sub_f32 v108, v108, v125
    v_mfma_f32_16x16x32_bf16 v[200:203], a[168:171], a[228:231], v[200:203]
    v_sub_f32 v101, v101, v124
    v_sub_f32 v109, v109, v125
    v_mfma_f32_16x16x32_bf16 v[232:235], a[168:171], a[236:239], v[232:235]
    v_sub_f32 v102, v102, v124
    v_sub_f32 v110, v110, v125
    v_mfma_f32_16x16x32_bf16 v[232:235], a[152:155], a[232:235], v[232:235]
    v_sub_f32 v103, v103, v124
    v_sub_f32 v111, v111, v125
    v_mfma_f32_16x16x32_bf16 v[236:239], a[156:159], a[232:235], v[236:239]
    v_cvt_pk_bf16_f32 v84, v96, v97
    v_cvt_pk_bf16_f32 v88, v104, v105
    v_mfma_f32_16x16x32_bf16 v[236:239], a[172:175], a[236:239], v[236:239]
    v_cvt_pk_bf16_f32 v85, v98, v99
    v_cvt_pk_bf16_f32 v89, v106, v107
    v_mfma_f32_16x16x32_bf16 v[204:207], a[172:175], a[228:231], v[204:207]
    v_cvt_pk_bf16_f32 v86, v100, v101
    v_cvt_pk_bf16_f32 v90, v108, v109
    v_mfma_f32_16x16x32_bf16 v[204:207], a[156:159], a[224:227], v[204:207]
    v_cvt_pk_bf16_f32 v87, v102, v103
    v_cvt_pk_bf16_f32 v91, v110, v111
    v_mfma_f32_16x16x32_bf16 v[172:175], a[156:159], a[216:219], v[172:175]
    v_lshlrev_b32 v96, 16, v84
    v_lshlrev_b32 v104, 16, v88
    v_mfma_f32_16x16x32_bf16 v[172:175], a[172:175], a[220:223], v[172:175]
    v_and_b32 v97, 0xffff0000, v84
    v_and_b32 v105, 0xffff0000, v88
    v_mfma_f32_16x16x32_bf16 v[140:143], a[172:175], a[212:215], v[140:143]
    v_lshlrev_b32 v98, 16, v85
    v_lshlrev_b32 v106, 16, v89
    v_mfma_f32_16x16x32_bf16 v[140:143], a[156:159], a[208:211], v[140:143]
    s_waitcnt vmcnt(13) lgkmcnt(0)
    s_barrier
    v_mfma_f32_16x16x32_bf16 v[144:147], a[176:179], a[208:211], v[144:147]
    ds_read_b128 a[96:99], v78 offset:0
    ds_read_b128 a[100:103], v79 offset:0
    v_mfma_f32_16x16x32_bf16 v[144:147], a[192:195], a[212:215], v[144:147]
    s_add_u32 m0, s31, 98304
    v_and_b32 v99, 0xffff0000, v85
    v_and_b32 v107, 0xffff0000, v89
    v_mfma_f32_16x16x32_bf16 v[176:179], a[192:195], a[220:223], v[176:179]
    ds_read_b128 a[104:107], v78 offset:2048
    ds_read_b128 a[108:111], v79 offset:2048
    v_mfma_f32_16x16x32_bf16 v[176:179], a[176:179], a[216:219], v[176:179]
    buffer_load_dwordx4 v72, s[12:15], s35 offen offset:0 lds
    v_mfma_f32_16x16x32_bf16 v[208:211], a[176:179], a[224:227], v[208:211]
    ds_read_b128 a[112:115], v78 offset:4096
    ds_read_b128 a[116:119], v79 offset:4096
    v_mfma_f32_16x16x32_bf16 v[208:211], a[192:195], a[228:231], v[208:211]
    v_lshlrev_b32 v100, 16, v86
    v_lshlrev_b32 v108, 16, v90
    v_mfma_f32_16x16x32_bf16 v[240:243], a[192:195], a[236:239], v[240:243]
    ds_read_b128 a[120:123], v78 offset:6144
    ds_read_b128 a[124:127], v79 offset:6144
    v_mfma_f32_16x16x32_bf16 v[240:243], a[176:179], a[232:235], v[240:243]
    buffer_load_dwordx4 v73, s[12:15], s35 offen offset:1024 lds
    v_mfma_f32_16x16x32_bf16 v[244:247], a[180:183], a[232:235], v[244:247]
    ds_read_b64_tr_b16 a[144:145], v80 offset:49152
    ds_read_b64_tr_b16 a[146:147], v80 offset:50176
    v_mfma_f32_16x16x32_bf16 v[244:247], a[196:199], a[236:239], v[244:247]
    v_and_b32 v101, 0xffff0000, v86
    v_and_b32 v109, 0xffff0000, v90
    v_mfma_f32_16x16x32_bf16 v[212:215], a[196:199], a[228:231], v[212:215]
    ds_read_b64_tr_b16 a[160:161], v80 offset:57344
    ds_read_b64_tr_b16 a[162:163], v80 offset:58368
    v_mfma_f32_16x16x32_bf16 v[212:215], a[180:183], a[224:227], v[212:215]
    buffer_load_dwordx4 v74, s[12:15], s35 offen offset:2048 lds
    v_mfma_f32_16x16x32_bf16 v[180:183], a[180:183], a[216:219], v[180:183]
    ds_read_b64_tr_b16 a[148:149], v80 offset:49160
    ds_read_b64_tr_b16 a[150:151], v80 offset:50184
    v_mfma_f32_16x16x32_bf16 v[180:183], a[196:199], a[220:223], v[180:183]
    v_lshlrev_b32 v102, 16, v87
    v_lshlrev_b32 v110, 16, v91
    v_mfma_f32_16x16x32_bf16 v[148:151], a[196:199], a[212:215], v[148:151]
    ds_read_b64_tr_b16 a[164:165], v80 offset:57352
    ds_read_b64_tr_b16 a[166:167], v80 offset:58376
    v_mfma_f32_16x16x32_bf16 v[148:151], a[180:183], a[208:211], v[148:151]
    buffer_load_dwordx4 v75, s[12:15], s35 offen offset:3072 lds
    v_mfma_f32_16x16x32_bf16 v[152:155], a[184:187], a[208:211], v[152:155]
    ds_read_b64_tr_b16 a[152:153], v81 offset:49152
    ds_read_b64_tr_b16 a[154:155], v81 offset:50176
    v_mfma_f32_16x16x32_bf16 v[152:155], a[200:203], a[212:215], v[152:155]
    s_add_u32 m0, s36, 32768
    v_and_b32 v103, 0xffff0000, v87
    v_and_b32 v111, 0xffff0000, v91
    v_mfma_f32_16x16x32_bf16 v[184:187], a[200:203], a[220:223], v[184:187]
    ds_read_b64_tr_b16 a[168:169], v81 offset:57344
    ds_read_b64_tr_b16 a[170:171], v81 offset:58368
    v_mfma_f32_16x16x32_bf16 v[184:187], a[184:187], a[216:219], v[184:187]
    buffer_load_dwordx4 v64, s[8:11], s34 offen offset:0 lds
    v_mfma_f32_16x16x32_bf16 v[216:219], a[184:187], a[224:227], v[216:219]
    ds_read_b64_tr_b16 a[156:157], v81 offset:49160
    ds_read_b64_tr_b16 a[158:159], v81 offset:50184
    v_mfma_f32_16x16x32_bf16 v[216:219], a[200:203], a[228:231], v[216:219]
    s_add_u32 s96, s93, s2
    v_mul_f32 v96, v96, v120
    v_mul_f32 v104, v104, v121
    v_mfma_f32_16x16x32_bf16 v[248:251], a[200:203], a[236:239], v[248:251]
    ds_read_b64_tr_b16 a[172:173], v81 offset:57352
    ds_read_b64_tr_b16 a[174:175], v81 offset:58376
    v_mfma_f32_16x16x32_bf16 v[248:251], a[184:187], a[232:235], v[248:251]
    buffer_load_dwordx4 v65, s[8:11], s34 offen offset:1024 lds
    v_mfma_f32_16x16x32_bf16 v[252:255], a[188:191], a[232:235], v[252:255]
    s_and_b32 s96, s96, 7
    v_mul_f32 v97, v97, v120
    v_mul_f32 v105, v105, v121
    v_mfma_f32_16x16x32_bf16 v[252:255], a[204:207], a[236:239], v[252:255]
    v_mul_f32 v98, v98, v120
    v_mul_f32 v106, v106, v121
    v_mfma_f32_16x16x32_bf16 v[220:223], a[204:207], a[228:231], v[220:223]
    v_mul_f32 v99, v99, v120
    v_mul_f32 v107, v107, v121
    v_mfma_f32_16x16x32_bf16 v[220:223], a[188:191], a[224:227], v[220:223]
    buffer_load_dwordx4 v66, s[8:11], s34 offen offset:2048 lds
    v_mfma_f32_16x16x32_bf16 v[188:191], a[188:191], a[216:219], v[188:191]
    s_lshr_b32 s93, s93, 4
    v_mul_f32 v100, v100, v120
    v_mul_f32 v108, v108, v121
    v_mfma_f32_16x16x32_bf16 v[188:191], a[204:207], a[220:223], v[188:191]
    v_mul_f32 v101, v101, v120
    v_mul_f32 v109, v109, v121
    v_mfma_f32_16x16x32_bf16 v[156:159], a[204:207], a[212:215], v[156:159]
    v_mul_f32 v102, v102, v120
    v_mul_f32 v110, v110, v121
    v_mfma_f32_16x16x32_bf16 v[156:159], a[188:191], a[208:211], v[156:159]
    s_waitcnt lgkmcnt(0)
    v_smfmac_f32_16x16x64_bf16 a[140:143], a[136:139], a[160:167], v27
    ds_read_b64_tr_b16 a[176:177], v82 offset:49152
    ds_read_b64_tr_b16 a[178:179], v82 offset:50176
    v_smfmac_f32_16x16x64_bf16 a[140:143], a[136:139], a[144:151], v27
    buffer_load_dwordx4 v67, s[8:11], s34 offen offset:3072 lds
    v_mfma_f32_16x16x32_bf16 v[128:131], a[144:147], a[96:99], v[128:131]
    ds_read_b64_tr_b16 a[192:193], v82 offset:57344
    ds_read_b64_tr_b16 a[194:195], v82 offset:58368
    v_mfma_f32_16x16x32_bf16 v[128:131], a[160:163], a[100:103], v[128:131]
    s_add_u32 m0, s36, 36864
    v_mul_f32 v103, v103, v120
    v_mul_f32 v111, v111, v121
    v_mfma_f32_16x16x32_bf16 v[160:163], a[160:163], a[108:111], v[160:163]
    ds_read_b64_tr_b16 a[180:181], v82 offset:49160
    ds_read_b64_tr_b16 a[182:183], v82 offset:50184
    v_mfma_f32_16x16x32_bf16 v[160:163], a[144:147], a[104:107], v[160:163]
L_pad1:
    s_cbranch_execz L_pad5
    buffer_load_dwordx4 v68, s[8:11], s34 offen offset:0 lds
    v_mfma_f32_16x16x32_bf16 v[192:195], a[144:147], a[112:115], v[192:195]
    ds_read_b64_tr_b16 a[196:197], v82 offset:57352
    ds_read_b64_tr_b16 a[198:199], v82 offset:58376
    v_mfma_f32_16x16x32_bf16 v[192:195], a[160:163], a[116:119], v[192:195]
    s_lshl_b32 s35, s96, 19
    v_cvt_pk_bf16_f32 v84, v96, v97
    v_cvt_pk_bf16_f32 v88, v104, v105
    v_mfma_f32_16x16x32_bf16 v[224:227], a[160:163], a[124:127], v[224:227]
    ds_read_b64_tr_b16 a[184:185], v83 offset:49152
    ds_read_b64_tr_b16 a[186:187], v83 offset:50176
    v_mfma_f32_16x16x32_bf16 v[224:227], a[144:147], a[120:123], v[224:227]
    buffer_load_dwordx4 v69, s[8:11], s34 offen offset:1024 lds
    v_mfma_f32_16x16x32_bf16 v[228:231], a[148:151], a[120:123], v[228:231]
    ds_read_b64_tr_b16 a[200:201], v83 offset:57344
    ds_read_b64_tr_b16 a[202:203], v83 offset:58368
    v_mfma_f32_16x16x32_bf16 v[228:231], a[164:167], a[124:127], v[228:231]
    s_lshl_b32 s96, s96, 7
    v_cvt_pk_bf16_f32 v85, v98, v99
    v_cvt_pk_bf16_f32 v89, v106, v107
    v_mfma_f32_16x16x32_bf16 v[196:199], a[164:167], a[116:119], v[196:199]
    ds_read_b64_tr_b16 a[188:189], v83 offset:49160
    ds_read_b64_tr_b16 a[190:191], v83 offset:50184
    v_mfma_f32_16x16x32_bf16 v[196:199], a[148:151], a[112:115], v[196:199]
    buffer_load_dwordx4 v70, s[8:11], s34 offen offset:2048 lds
    v_mfma_f32_16x16x32_bf16 v[164:167], a[148:151], a[104:107], v[164:167]
    ds_read_b64_tr_b16 a[204:205], v83 offset:57352
    ds_read_b64_tr_b16 a[206:207], v83 offset:58376
    v_mfma_f32_16x16x32_bf16 v[164:167], a[164:167], a[108:111], v[164:167]
    s_add_u32 s35, s35, s6
    v_cvt_pk_bf16_f32 v86, v100, v101
    v_cvt_pk_bf16_f32 v90, v108, v109
    v_mfma_f32_16x16x32_bf16 v[132:135], a[164:167], a[100:103], v[132:135]
    v_cvt_pk_bf16_f32 v87, v102, v103
    v_cvt_pk_bf16_f32 v91, v110, v111
    v_mfma_f32_16x16x32_bf16 v[132:135], a[148:151], a[96:99], v[132:135]
    buffer_load_dwordx4 v71, s[8:11], s34 offen offset:3072 lds
    v_mfma_f32_16x16x32_bf16 v[136:139], a[152:155], a[96:99], v[136:139]
    s_add_u32 s34, s5, s96
    v_lshlrev_b32 v96, 16, v84
    v_lshlrev_b32 v104, 16, v88
    v_mfma_f32_16x16x32_bf16 v[136:139], a[168:171], a[100:103], v[136:139]
    v_and_b32 v97, 0xffff0000, v84
    v_and_b32 v105, 0xffff0000, v88
    v_mfma_f32_16x16x32_bf16 v[168:171], a[168:171], a[108:111], v[168:171]
    v_lshlrev_b32 v98, 16, v85
    v_lshlrev_b32 v106, 16, v89
    v_mfma_f32_16x16x32_bf16 v[168:171], a[152:155], a[104:107], v[168:171]
    v_and_b32 v99, 0xffff0000, v85
    v_and_b32 v107, 0xffff0000, v89
    v_mfma_f32_16x16x32_bf16 v[200:203], a[152:155], a[112:115], v[200:203]
    v_lshlrev_b32 v100, 16, v86
    v_lshlrev_b32 v108, 16, v90
    v_mfma_f32_16x16x32_bf16 v[200:203], a[168:171], a[116:119], v[200:203]
    v_and_b32 v101, 0xffff0000, v86
    v_and_b32 v109, 0xffff0000, v90
    v_mfma_f32_16x16x32_bf16 v[232:235], a[168:171], a[124:127], v[232:235]
    v_lshlrev_b32 v102, 16, v87
    v_lshlrev_b32 v110, 16, v91
    v_mfma_f32_16x16x32_bf16 v[232:235], a[152:155], a[120:123], v[232:235]
    v_and_b32 v103, 0xffff0000, v87
    v_and_b32 v111, 0xffff0000, v91
    v_mfma_f32_16x16x32_bf16 v[236:239], a[156:159], a[120:123], v[236:239]
    v_mul_f32 v120, v96, v112
    v_mul_f32 v121, v104, v112
    v_mfma_f32_16x16x32_bf16 v[236:239], a[172:175], a[124:127], v[236:239]
    v_fmac_f32 v120, v97, v113
    v_fmac_f32 v121, v105, v113
    v_mfma_f32_16x16x32_bf16 v[204:207], a[172:175], a[116:119], v[204:207]
    v_fmac_f32 v120, v98, v114
    v_fmac_f32 v121, v106, v114
    v_mfma_f32_16x16x32_bf16 v[204:207], a[156:159], a[112:115], v[204:207]
    v_fmac_f32 v120, v99, v115
    v_fmac_f32 v121, v107, v115
    v_mfma_f32_16x16x32_bf16 v[172:175], a[156:159], a[104:107], v[172:175]
    v_fmac_f32 v120, v100, v116
    v_fmac_f32 v121, v108, v116
    v_mfma_f32_16x16x32_bf16 v[172:175], a[172:175], a[108:111], v[172:175]
    v_fmac_f32 v120, v101, v117
    v_fmac_f32 v121, v109, v117
    v_mfma_f32_16x16x32_bf16 v[140:143], a[172:175], a[100:103], v[140:143]
    v_fmac_f32 v120, v102, v118
    v_fmac_f32 v121, v110, v118
    v_mfma_f32_16x16x32_bf16 v[140:143], a[156:159], a[96:99], v[140:143]
    s_waitcnt vmcnt(12) lgkmcnt(0)
    s_barrier
    v_mfma_f32_16x16x32_bf16 v[144:147], a[176:179], a[96:99], v[144:147]
    ds_read_b128 a[208:211], v76 offset:0
    ds_read_b128 a[212:215], v77 offset:0
    v_mfma_f32_16x16x32_bf16 v[144:147], a[192:195], a[100:103], v[144:147]
    s_add_u32 m0, s31, 114688
    v_fmac_f32 v120, v103, v119
    v_fmac_f32 v121, v111, v119
    v_mfma_f32_16x16x32_bf16 v[176:179], a[192:195], a[108:111], v[176:179]
    ds_read_b128 a[216:219], v76 offset:2048
    ds_read_b128 a[220:223], v77 offset:2048
    v_mfma_f32_16x16x32_bf16 v[176:179], a[176:179], a[104:107], v[176:179]
    buffer_load_dwordx4 v72, s[12:15], s35 offen offset:0 lds
    v_mfma_f32_16x16x32_bf16 v[208:211], a[176:179], a[112:115], v[208:211]
    ds_read_b128 a[224:227], v76 offset:4096
    ds_read_b128 a[228:231], v77 offset:4096
    v_mfma_f32_16x16x32_bf16 v[208:211], a[192:195], a[116:119], v[208:211]
    v_add_f32_dpp v120, v120, v120 quad_perm:[1,0,3,2] row_mask:0xf bank_mask:0xf
    v_add_f32_dpp v121, v121, v121 quad_perm:[1,0,3,2] row_mask:0xf bank_mask:0xf
    v_mfma_f32_16x16x32_bf16 v[240:243], a[192:195], a[124:127], v[240:243]
    ds_read_b128 a[232:235], v76 offset:6144
    ds_read_b128 a[236:239], v77 offset:6144
    v_mfma_f32_16x16x32_bf16 v[240:243], a[176:179], a[120:123], v[240:243]
    buffer_load_dwordx4 v73, s[12:15], s35 offen offset:1024 lds
    v_mfma_f32_16x16x32_bf16 v[244:247], a[180:183], a[120:123], v[244:247]
    ds_read_b64_tr_b16 a[144:145], v80 offset:0
    ds_read_b64_tr_b16 a[146:147], v80 offset:1024
    v_mfma_f32_16x16x32_bf16 v[244:247], a[196:199], a[124:127], v[244:247]
    v_add_f32_dpp v120, v120, v120 quad_perm:[2,3,0,1] row_mask:0xf bank_mask:0xf
    v_add_f32_dpp v121, v121, v121 quad_perm:[2,3,0,1] row_mask:0xf bank_mask:0xf
    v_mfma_f32_16x16x32_bf16 v[212:215], a[196:199], a[116:119], v[212:215]
    ds_read_b64_tr_b16 a[160:161], v80 offset:8192
    ds_read_b64_tr_b16 a[162:163], v80 offset:9216
    v_mfma_f32_16x16x32_bf16 v[212:215], a[180:183], a[112:115], v[212:215]
    buffer_load_dwordx4 v74, s[12:15], s35 offen offset:2048 lds
    v_mfma_f32_16x16x32_bf16 v[180:183], a[180:183], a[104:107], v[180:183]
    ds_read_b64_tr_b16 a[148:149], v80 offset:8
    ds_read_b64_tr_b16 a[150:151], v80 offset:1032
    v_mfma_f32_16x16x32_bf16 v[180:183], a[196:199], a[108:111], v[180:183]
    v_add_f32_dpp v120, v120, v120 row_half_mirror row_mask:0xf bank_mask:0xf
    v_add_f32_dpp v121, v121, v121 row_half_mirror row_mask:0xf bank_mask:0xf
    v_mfma_f32_16x16x32_bf16 v[148:151], a[196:199], a[100:103], v[148:151]
    ds_read_b64_tr_b16 a[164:165], v80 offset:8200
    ds_read_b64_tr_b16 a[166:167], v80 offset:9224
    v_mfma_f32_16x16x32_bf16 v[148:151], a[180:183], a[96:99], v[148:151]
    buffer_load_dwordx4 v75, s[12:15], s35 offen offset:3072 lds
    v_mfma_f32_16x16x32_bf16 v[152:155], a[184:187], a[96:99], v[152:155]
    ds_read_b64_tr_b16 a[152:153], v81 offset:0
    ds_read_b64_tr_b16 a[154:155], v81 offset:1024
    v_mfma_f32_16x16x32_bf16 v[152:155], a[200:203], a[100:103], v[152:155]
    s_add_u32 m0, s36, 131072
    v_add_f32_dpp v120, v120, v120 row_mirror row_mask:0xf bank_mask:0xf
    v_add_f32_dpp v121, v121, v121 row_mirror row_mask:0xf bank_mask:0xf
    v_mfma_f32_16x16x32_bf16 v[184:187], a[200:203], a[108:111], v[184:187]
    ds_read_b64_tr_b16 a[168:169], v81 offset:8192
    ds_read_b64_tr_b16 a[170:171], v81 offset:9216
    v_mfma_f32_16x16x32_bf16 v[184:187], a[184:187], a[104:107], v[184:187]
    buffer_load_dwordx4 v64, s[8:11], s34 offen offset:0 lds
    v_mfma_f32_16x16x32_bf16 v[216:219], a[184:187], a[112:115], v[216:219]
    ds_read_b64_tr_b16 a[156:157], v81 offset:8
    ds_read_b64_tr_b16 a[158:159], v81 offset:1032
    v_mfma_f32_16x16x32_bf16 v[216:219], a[200:203], a[116:119], v[216:219]
    v_mov_b32 v122, v120
    v_mov_b32 v123, v121
    v_mfma_f32_16x16x32_bf16 v[248:251], a[200:203], a[124:127], v[248:251]
    ds_read_b64_tr_b16 a[172:173], v81 offset:8200
    ds_read_b64_tr_b16 a[174:175], v81 offset:9224
    v_mfma_f32_16x16x32_bf16 v[248:251], a[184:187], a[120:123], v[248:251]
    buffer_load_dwordx4 v65, s[8:11], s34 offen offset:1024 lds
    v_mfma_f32_16x16x32_bf16 v[252:255], a[188:191], a[120:123], v[252:255]
    v_permlane16_swap_b32 v120, v122
    v_mfma_f32_16x16x32_bf16 v[252:255], a[204:207], a[124:127], v[252:255]
    v_permlane16_swap_b32 v121, v123
    v_mfma_f32_16x16x32_bf16 v[220:223], a[204:207], a[116:119], v[220:223]
    v_add_f32 v120, v120, v122
    v_add_f32 v121, v121, v123
    v_mfma_f32_16x16x32_bf16 v[220:223], a[188:191], a[112:115], v[220:223]
    buffer_load_dwordx4 v66, s[8:11], s34 offen offset:2048 lds
    v_mfma_f32_16x16x32_bf16 v[188:191], a[188:191], a[104:107], v[188:191]
    v_mov_b32 v122, v120
    v_mov_b32 v123, v121
    v_mfma_f32_16x16x32_bf16 v[188:191], a[204:207], a[108:111], v[188:191]
    v_permlane32_swap_b32 v120, v122
    v_mfma_f32_16x16x32_bf16 v[156:159], a[204:207], a[100:103], v[156:159]
    v_permlane32_swap_b32 v121, v123
    v_mfma_f32_16x16x32_bf16 v[156:159], a[188:191], a[96:99], v[156:159]
    s_waitcnt lgkmcnt(0)
    v_smfmac_f32_16x16x64_bf16 a[140:143], a[136:139], a[160:167], v27
    ds_read_b64_tr_b16 a[176:177], v82 offset:0
    ds_read_b64_tr_b16 a[178:179], v82 offset:1024
    v_smfmac_f32_16x16x64_bf16 a[140:143], a[136:139], a[144:151], v27
    buffer_load_dwordx4 v67, s[8:11], s34 offen offset:3072 lds
    v_mfma_f32_16x16x32_bf16 v[128:131], a[144:147], a[208:211], v[128:131]
    ds_read_b64_tr_b16 a[192:193], v82 offset:8192
    ds_read_b64_tr_b16 a[194:195], v82 offset:9216
    v_mfma_f32_16x16x32_bf16 v[128:131], a[160:163], a[212:215], v[128:131]
    s_add_u32 m0, s36, 135168
    v_add_f32 v120, v120, v122
    v_add_f32 v121, v121, v123
    v_mfma_f32_16x16x32_bf16 v[160:163], a[160:163], a[220:223], v[160:163]
    ds_read_b64_tr_b16 a[180:181], v82 offset:8
    ds_read_b64_tr_b16 a[182:183], v82 offset:1032
    v_mfma_f32_16x16x32_bf16 v[160:163], a[144:147], a[216:219], v[160:163]
    buffer_load_dwordx4 v68, s[8:11], s34 offen offset:0 lds
    v_mfma_f32_16x16x32_bf16 v[192:195], a[144:147], a[224:227], v[192:195]
    ds_read_b64_tr_b16 a[196:197], v82 offset:8200
    ds_read_b64_tr_b16 a[198:199], v82 offset:9224
    v_mfma_f32_16x16x32_bf16 v[192:195], a[160:163], a[228:231], v[192:195]
    v_cvt_pk_bf16_f32 v120, v120, v120
    v_cvt_pk_bf16_f32 v121, v121, v121
    v_mfma_f32_16x16x32_bf16 v[224:227], a[160:163], a[236:239], v[224:227]
    ds_read_b64_tr_b16 a[184:185], v83 offset:0
    ds_read_b64_tr_b16 a[186:187], v83 offset:1024
    v_mfma_f32_16x16x32_bf16 v[224:227], a[144:147], a[232:235], v[224:227]
    buffer_load_dwordx4 v69, s[8:11], s34 offen offset:1024 lds
    v_mfma_f32_16x16x32_bf16 v[228:231], a[148:151], a[232:235], v[228:231]
    ds_read_b64_tr_b16 a[200:201], v83 offset:8192
    ds_read_b64_tr_b16 a[202:203], v83 offset:9216
    v_mfma_f32_16x16x32_bf16 v[228:231], a[164:167], a[236:239], v[228:231]
    v_ashrrev_i32 v122, 31, v120
    v_ashrrev_i32 v123, 31, v121
    v_mfma_f32_16x16x32_bf16 v[196:199], a[164:167], a[228:231], v[196:199]
    ds_read_b64_tr_b16 a[188:189], v83 offset:8
    ds_read_b64_tr_b16 a[190:191], v83 offset:1032
    v_mfma_f32_16x16x32_bf16 v[196:199], a[148:151], a[224:227], v[196:199]
    buffer_load_dwordx4 v70, s[8:11], s34 offen offset:2048 lds
    v_mfma_f32_16x16x32_bf16 v[164:167], a[148:151], a[216:219], v[164:167]
    ds_read_b64_tr_b16 a[204:205], v83 offset:8200
    ds_read_b64_tr_b16 a[206:207], v83 offset:9224
    v_mfma_f32_16x16x32_bf16 v[164:167], a[164:167], a[220:223], v[164:167]
    v_or_b32 v122, 0x80000000, v122
    v_or_b32 v123, 0x80000000, v123
    v_mfma_f32_16x16x32_bf16 v[132:135], a[164:167], a[212:215], v[132:135]
    v_xor_b32 v120, v120, v122
    v_xor_b32 v121, v121, v123
    v_mfma_f32_16x16x32_bf16 v[132:135], a[148:151], a[208:211], v[132:135]
    buffer_load_dwordx4 v71, s[8:11], s34 offen offset:3072 lds
    v_mfma_f32_16x16x32_bf16 v[136:139], a[152:155], a[208:211], v[136:139]
    v_and_b32 v120, 0xffff0000, v120
    v_and_b32 v121, 0xffff0000, v121
    v_mfma_f32_16x16x32_bf16 v[136:139], a[168:171], a[212:215], v[136:139]
    v_or_b32 v40, s97, v120
    v_or_b32 v41, s98, v121
    v_mfma_f32_16x16x32_bf16 v[168:171], a[168:171], a[220:223], v[168:171]
    v_mov_b32 v44, -1
    v_mov_b32 v45, -1
    v_mfma_f32_16x16x32_bf16 v[168:171], a[152:155], a[216:219], v[168:171]
    v_mov_b32 v46, -1
    v_mov_b32 v47, -1
    v_mfma_f32_16x16x32_bf16 v[200:203], a[152:155], a[224:227], v[200:203]
    v_mov_b32 v127, 0
    v_lshl_add_u32 v63, v2, 13, v55
    v_mfma_f32_16x16x32_bf16 v[200:203], a[168:171], a[228:231], v[200:203]
    v_add_u32 v63, 131072, v63
    v_lshlrev_b32 v126, 4, v4
    v_mfma_f32_16x16x32_bf16 v[232:235], a[168:171], a[236:239], v[232:235]
    v_lshl_add_u32 v126, v2, 13, v126
    v_lshlrev_b32 v6, 6, v2
    v_mfma_f32_16x16x32_bf16 v[232:235], a[152:155], a[232:235], v[232:235]
    v_xor_b32 v5, v4, v3
    v_lshlrev_b32 v5, 4, v5
    v_mfma_f32_16x16x32_bf16 v[236:239], a[156:159], a[232:235], v[236:239]
    v_lshl_add_u32 v8, v3, 8, v5
    v_xor_b32 v8, v8, v6
    v_mfma_f32_16x16x32_bf16 v[236:239], a[172:175], a[236:239], v[236:239]
    v_xor_b32 v9, 64, v8
    v_xor_b32 v10, 128, v8
    v_mfma_f32_16x16x32_bf16 v[204:207], a[172:175], a[228:231], v[204:207]
    v_xor_b32 v11, 192, v8
    v_lshrrev_b32 v5, 2, v1
    v_mfma_f32_16x16x32_bf16 v[204:207], a[156:159], a[224:227], v[204:207]
    v_and_b32 v6, 7, v5
    v_lshlrev_b32 v6, 5, v6
    v_mfma_f32_16x16x32_bf16 v[172:175], a[156:159], a[216:219], v[172:175]
    v_lshl_add_u32 v5, v5, 8, v6
    v_and_b32 v6, 3, v1
    v_mfma_f32_16x16x32_bf16 v[172:175], a[172:175], a[220:223], v[172:175]
    v_lshl_add_u32 v5, v6, 3, v5
    v_add_u32 v12, 65536, v5
    v_mfma_f32_16x16x32_bf16 v[140:143], a[172:175], a[212:215], v[140:143]
    v_xor_b32 v13, 32, v12
    v_xor_b32 v14, 64, v12
    v_mfma_f32_16x16x32_bf16 v[140:143], a[156:159], a[208:211], v[140:143]
    s_waitcnt vmcnt(12) lgkmcnt(0)
    s_barrier
    v_mfma_f32_16x16x32_bf16 v[144:147], a[176:179], a[208:211], v[144:147]
    ds_read_b128 a[96:99], v76 offset:32768
    ds_read_b128 a[100:103], v77 offset:32768
    v_mfma_f32_16x16x32_bf16 v[144:147], a[192:195], a[212:215], v[144:147]
    s_add_u32 m0, s31, 0
    v_xor_b32 v15, 96, v12
    v_xor_b32 v16, 128, v12
    v_mfma_f32_16x16x32_bf16 v[176:179], a[192:195], a[220:223], v[176:179]
    ds_read_b128 a[104:107], v76 offset:34816
    ds_read_b128 a[108:111], v77 offset:34816
    v_mfma_f32_16x16x32_bf16 v[176:179], a[176:179], a[216:219], v[176:179]
    buffer_load_dwordx4 v20, s[16:19], s32 offen offset:0 lds
    v_mfma_f32_16x16x32_bf16 v[208:211], a[176:179], a[224:227], v[208:211]
    ds_read_b128 a[112:115], v76 offset:36864
    ds_read_b128 a[116:119], v77 offset:36864
    v_mfma_f32_16x16x32_bf16 v[208:211], a[192:195], a[228:231], v[208:211]
    v_xor_b32 v17, 160, v12
    v_xor_b32 v18, 192, v12
    v_mfma_f32_16x16x32_bf16 v[240:243], a[192:195], a[236:239], v[240:243]
    ds_read_b128 a[120:123], v76 offset:38912
    ds_read_b128 a[124:127], v77 offset:38912
    v_mfma_f32_16x16x32_bf16 v[240:243], a[176:179], a[232:235], v[240:243]
    buffer_load_dwordx4 v21, s[16:19], s32 offen offset:1024 lds
    v_mfma_f32_16x16x32_bf16 v[244:247], a[180:183], a[232:235], v[244:247]
    ds_read_b64_tr_b16 a[144:145], v80 offset:32768
    ds_read_b64_tr_b16 a[146:147], v80 offset:33792
    v_mfma_f32_16x16x32_bf16 v[244:247], a[196:199], a[236:239], v[244:247]
    v_xor_b32 v19, 224, v12
    v_lshrrev_b32 v5, 3, v1
    v_mfma_f32_16x16x32_bf16 v[212:215], a[196:199], a[228:231], v[212:215]
    ds_read_b64_tr_b16 a[160:161], v80 offset:40960
    ds_read_b64_tr_b16 a[162:163], v80 offset:41984
    v_mfma_f32_16x16x32_bf16 v[212:215], a[180:183], a[224:227], v[212:215]
    buffer_load_dwordx4 v22, s[16:19], s32 offen offset:2048 lds
    v_mfma_f32_16x16x32_bf16 v[180:183], a[180:183], a[216:219], v[180:183]
    ds_read_b64_tr_b16 a[148:149], v80 offset:32776
    ds_read_b64_tr_b16 a[150:151], v80 offset:33800
    v_mfma_f32_16x16x32_bf16 v[180:183], a[196:199], a[220:223], v[180:183]
    v_lshlrev_b32 v5, 10, v5
    v_and_b32 v6, 7, v1
    v_mfma_f32_16x16x32_bf16 v[148:151], a[196:199], a[212:215], v[148:151]
    ds_read_b64_tr_b16 a[164:165], v80 offset:40968
    ds_read_b64_tr_b16 a[166:167], v80 offset:41992
    v_mfma_f32_16x16x32_bf16 v[148:151], a[180:183], a[208:211], v[148:151]
    buffer_load_dwordx4 v23, s[16:19], s32 offen offset:3072 lds
    v_mfma_f32_16x16x32_bf16 v[152:155], a[184:187], a[208:211], v[152:155]
    ds_read_b64_tr_b16 a[152:153], v81 offset:32768
    ds_read_b64_tr_b16 a[154:155], v81 offset:33792
    v_mfma_f32_16x16x32_bf16 v[152:155], a[200:203], a[212:215], v[152:155]
    s_add_u32 s32, s32, 16384
    v_lshlrev_b32 v35, 1, v4
    v_xor_b32 v6, v6, v35
    v_mfma_f32_16x16x32_bf16 v[184:187], a[200:203], a[220:223], v[184:187]
    ds_read_b64_tr_b16 a[168:169], v81 offset:40960
    ds_read_b64_tr_b16 a[170:171], v81 offset:41984
    v_mfma_f32_16x16x32_bf16 v[184:187], a[184:187], a[216:219], v[184:187]
    s_add_u32 m0, s31, 16384
    v_lshl_add_u32 v5, v6, 4, v5
    v_add_u32 v30, s94, v5
    v_mfma_f32_16x16x32_bf16 v[216:219], a[184:187], a[224:227], v[216:219]
    ds_read_b64_tr_b16 a[156:157], v81 offset:32776
    ds_read_b64_tr_b16 a[158:159], v81 offset:33800
    v_mfma_f32_16x16x32_bf16 v[216:219], a[200:203], a[228:231], v[216:219]
    buffer_load_dwordx4 v20, s[16:19], s32 offen offset:0 lds
    v_mfma_f32_16x16x32_bf16 v[248:251], a[200:203], a[236:239], v[248:251]
    ds_read_b64_tr_b16 a[172:173], v81 offset:40968
    ds_read_b64_tr_b16 a[174:175], v81 offset:41992
    v_mfma_f32_16x16x32_bf16 v[248:251], a[184:187], a[232:235], v[248:251]
    v_add_u32 v31, 7168, v30
    v_add_u32 v32, 14336, v30
    v_mfma_f32_16x16x32_bf16 v[252:255], a[188:191], a[232:235], v[252:255]
    v_add_u32 v33, 21504, v30
    v_and_or_b32 v35, v1, 3, s95
    v_mfma_f32_16x16x32_bf16 v[252:255], a[204:207], a[236:239], v[252:255]
    buffer_load_dwordx4 v21, s[16:19], s32 offen offset:1024 lds
    v_mfma_f32_16x16x32_bf16 v[220:223], a[204:207], a[228:231], v[220:223]
    v_lshlrev_b32 v35, 5, v35
    v_lshrrev_b32 v5, 2, v1
    v_mfma_f32_16x16x32_bf16 v[220:223], a[188:191], a[224:227], v[220:223]
    v_bfe_u32 v6, v1, 3, 2
    v_lshlrev_b32 v6, 5, v6
    v_mfma_f32_16x16x32_bf16 v[188:191], a[188:191], a[216:219], v[188:191]
    v_lshl_add_u32 v5, v5, 7, v6
    v_and_b32 v6, 3, v1
    v_mfma_f32_16x16x32_bf16 v[188:191], a[204:207], a[220:223], v[188:191]
    buffer_load_dwordx4 v22, s[16:19], s32 offen offset:2048 lds
    v_mfma_f32_16x16x32_bf16 v[156:159], a[204:207], a[212:215], v[156:159]
    v_lshl_add_u32 v5, v6, 3, v5
    v_lshl_add_u32 v5, v2, 12, v5
    v_mfma_f32_16x16x32_bf16 v[156:159], a[188:191], a[208:211], v[156:159]
    s_waitcnt lgkmcnt(0)
    v_smfmac_f32_16x16x64_bf16 a[140:143], a[136:139], a[160:167], v27
    ds_read_b64_tr_b16 a[176:177], v82 offset:32768
    ds_read_b64_tr_b16 a[178:179], v82 offset:33792
    v_smfmac_f32_16x16x64_bf16 a[140:143], a[136:139], a[144:151], v27
    buffer_load_dword v49, v55, s[24:27], s90 offen offset:0 sc1
    v_mfma_f32_16x16x32_bf16 v[128:131], a[144:147], a[96:99], v[128:131]
    ds_read_b64_tr_b16 a[192:193], v82 offset:40960
    ds_read_b64_tr_b16 a[194:195], v82 offset:41984
    v_mfma_f32_16x16x32_bf16 v[128:131], a[160:163], a[100:103], v[128:131]
    v_add_u32 v36, 131072, v5
    v_xor_b32 v37, 32, v36
    v_mfma_f32_16x16x32_bf16 v[160:163], a[160:163], a[108:111], v[160:163]
    ds_read_b64_tr_b16 a[180:181], v82 offset:32776
    ds_read_b64_tr_b16 a[182:183], v82 offset:33800
    v_mfma_f32_16x16x32_bf16 v[160:163], a[144:147], a[104:107], v[160:163]
    buffer_load_dword v53, v55, s[24:27], s90 offen offset:64 sc1
    v_mfma_f32_16x16x32_bf16 v[192:195], a[144:147], a[112:115], v[192:195]
    ds_read_b64_tr_b16 a[196:197], v82 offset:40968
    ds_read_b64_tr_b16 a[198:199], v82 offset:41992
    v_mfma_f32_16x16x32_bf16 v[192:195], a[160:163], a[116:119], v[192:195]
    v_xor_b32 v38, 64, v36
    v_xor_b32 v39, 96, v36
    v_mfma_f32_16x16x32_bf16 v[224:227], a[160:163], a[124:127], v[224:227]
    ds_read_b64_tr_b16 a[184:185], v83 offset:32768
    ds_read_b64_tr_b16 a[186:187], v83 offset:33792
    v_mfma_f32_16x16x32_bf16 v[224:227], a[144:147], a[120:123], v[224:227]
    buffer_load_dword v57, v55, s[24:27], s90 offen offset:128 sc1
    v_mfma_f32_16x16x32_bf16 v[228:231], a[148:151], a[120:123], v[228:231]
    ds_read_b64_tr_b16 a[200:201], v83 offset:40960
    ds_read_b64_tr_b16 a[202:203], v83 offset:41984
    v_mfma_f32_16x16x32_bf16 v[228:231], a[164:167], a[124:127], v[228:231]
    v_accvgpr_write_b32 a128, 0
    v_accvgpr_write_b32 a129, 0
    v_mfma_f32_16x16x32_bf16 v[196:199], a[164:167], a[116:119], v[196:199]
    ds_read_b64_tr_b16 a[188:189], v83 offset:32776
    ds_read_b64_tr_b16 a[190:191], v83 offset:33800
    v_mfma_f32_16x16x32_bf16 v[196:199], a[148:151], a[112:115], v[196:199]
    buffer_load_dword v61, v55, s[24:27], s90 offen offset:192 sc1
    v_mfma_f32_16x16x32_bf16 v[164:167], a[148:151], a[104:107], v[164:167]
    ds_read_b64_tr_b16 a[204:205], v83 offset:40968
    ds_read_b64_tr_b16 a[206:207], v83 offset:41992
    v_mfma_f32_16x16x32_bf16 v[164:167], a[164:167], a[108:111], v[164:167]
    v_accvgpr_write_b32 a130, 0
    v_accvgpr_write_b32 a131, 0
    v_mfma_f32_16x16x32_bf16 v[132:135], a[164:167], a[100:103], v[132:135]
    v_accvgpr_write_b32 a132, 0
    v_accvgpr_write_b32 a133, 0
    v_mfma_f32_16x16x32_bf16 v[132:135], a[148:151], a[96:99], v[132:135]
    buffer_load_dwordx4 v23, s[16:19], s32 offen offset:3072 lds
    v_mfma_f32_16x16x32_bf16 v[136:139], a[152:155], a[96:99], v[136:139]
    s_add_u32 s32, s32, 16384
    v_accvgpr_write_b32 a134, 0
    v_accvgpr_write_b32 a135, 0
    v_mfma_f32_16x16x32_bf16 v[136:139], a[168:171], a[100:103], v[136:139]
    s_add_u32 m0, s31, 65536
    v_mfma_f32_16x16x32_bf16 v[168:171], a[168:171], a[108:111], v[168:171]
    v_mfma_f32_16x16x32_bf16 v[168:171], a[152:155], a[104:107], v[168:171]
    buffer_load_dwordx4 v24, s[20:23], s39 offen offset:0 lds
    v_mfma_f32_16x16x32_bf16 v[200:203], a[152:155], a[112:115], v[200:203]
    v_mfma_f32_16x16x32_bf16 v[200:203], a[168:171], a[116:119], v[200:203]
    v_mfma_f32_16x16x32_bf16 v[232:235], a[168:171], a[124:127], v[232:235]
    v_mfma_f32_16x16x32_bf16 v[232:235], a[152:155], a[120:123], v[232:235]
    buffer_load_dwordx4 v25, s[20:23], s39 offen offset:1024 lds
    v_mfma_f32_16x16x32_bf16 v[236:239], a[156:159], a[120:123], v[236:239]
    v_mfma_f32_16x16x32_bf16 v[236:239], a[172:175], a[124:127], v[236:239]
    v_mfma_f32_16x16x32_bf16 v[204:207], a[172:175], a[116:119], v[204:207]
    v_mfma_f32_16x16x32_bf16 v[204:207], a[156:159], a[112:115], v[204:207]
    buffer_load_dwordx4 v24, s[20:23], s39 offen offset:2048 lds
    v_mfma_f32_16x16x32_bf16 v[172:175], a[156:159], a[104:107], v[172:175]
    v_mfma_f32_16x16x32_bf16 v[172:175], a[172:175], a[108:111], v[172:175]
    v_mfma_f32_16x16x32_bf16 v[140:143], a[172:175], a[100:103], v[140:143]
    v_mfma_f32_16x16x32_bf16 v[140:143], a[156:159], a[96:99], v[140:143]
    s_waitcnt vmcnt(15) lgkmcnt(0)
    s_barrier
    v_mfma_f32_16x16x32_bf16 v[144:147], a[176:179], a[96:99], v[144:147]
    ds_read_b128 a[208:211], v78 offset:0
    ds_read_b128 a[212:215], v79 offset:0
    v_mfma_f32_16x16x32_bf16 v[144:147], a[192:195], a[100:103], v[144:147]
    buffer_load_dwordx4 v25, s[20:23], s39 offen offset:3072 lds
    v_mfma_f32_16x16x32_bf16 v[176:179], a[192:195], a[108:111], v[176:179]
    ds_read_b128 a[216:219], v78 offset:2048
    ds_read_b128 a[220:223], v79 offset:2048
    v_mfma_f32_16x16x32_bf16 v[176:179], a[176:179], a[104:107], v[176:179]
    s_add_u32 s39, s39, 16384
    v_mfma_f32_16x16x32_bf16 v[208:211], a[176:179], a[112:115], v[208:211]
    ds_read_b128 a[224:227], v78 offset:4096
    ds_read_b128 a[228:231], v79 offset:4096
    v_mfma_f32_16x16x32_bf16 v[208:211], a[192:195], a[116:119], v[208:211]
    v_mfma_f32_16x16x32_bf16 v[240:243], a[192:195], a[124:127], v[240:243]
    ds_read_b128 a[232:235], v78 offset:6144
    ds_read_b128 a[236:239], v79 offset:6144
    v_mfma_f32_16x16x32_bf16 v[240:243], a[176:179], a[120:123], v[240:243]
    v_mfma_f32_16x16x32_bf16 v[244:247], a[180:183], a[120:123], v[244:247]
    ds_read_b64_tr_b16 a[144:145], v80 offset:49152
    ds_read_b64_tr_b16 a[146:147], v80 offset:50176
    v_mfma_f32_16x16x32_bf16 v[244:247], a[196:199], a[124:127], v[244:247]
    v_mfma_f32_16x16x32_bf16 v[212:215], a[196:199], a[116:119], v[212:215]
    ds_read_b64_tr_b16 a[160:161], v80 offset:57344
    ds_read_b64_tr_b16 a[162:163], v80 offset:58368
    v_mfma_f32_16x16x32_bf16 v[212:215], a[180:183], a[112:115], v[212:215]
    buffer_store_dword v127, v27, s[24:27], s59 offen sc1
    v_mfma_f32_16x16x32_bf16 v[180:183], a[180:183], a[104:107], v[180:183]
    ds_read_b64_tr_b16 a[148:149], v80 offset:49160
    ds_read_b64_tr_b16 a[150:151], v80 offset:50184
    v_mfma_f32_16x16x32_bf16 v[180:183], a[196:199], a[108:111], v[180:183]
    v_mfma_f32_16x16x32_bf16 v[148:151], a[196:199], a[100:103], v[148:151]
    ds_read_b64_tr_b16 a[164:165], v80 offset:57352
    ds_read_b64_tr_b16 a[166:167], v80 offset:58376
    v_mfma_f32_16x16x32_bf16 v[148:151], a[180:183], a[96:99], v[148:151]
    v_mfma_f32_16x16x32_bf16 v[152:155], a[184:187], a[96:99], v[152:155]
    ds_read_b64_tr_b16 a[152:153], v81 offset:49152
    ds_read_b64_tr_b16 a[154:155], v81 offset:50176
    v_mfma_f32_16x16x32_bf16 v[152:155], a[200:203], a[100:103], v[152:155]
    v_mfma_f32_16x16x32_bf16 v[184:187], a[200:203], a[108:111], v[184:187]
    ds_read_b64_tr_b16 a[168:169], v81 offset:57344
    ds_read_b64_tr_b16 a[170:171], v81 offset:58368
    v_mfma_f32_16x16x32_bf16 v[184:187], a[184:187], a[104:107], v[184:187]
    v_mfma_f32_16x16x32_bf16 v[216:219], a[184:187], a[112:115], v[216:219]
    ds_read_b64_tr_b16 a[156:157], v81 offset:49160
    ds_read_b64_tr_b16 a[158:159], v81 offset:50184
    v_mfma_f32_16x16x32_bf16 v[216:219], a[200:203], a[116:119], v[216:219]
    buffer_store_dwordx4 v[84:87], v51, s[24:27], s60 offen offset:0 sc1
    v_mfma_f32_16x16x32_bf16 v[248:251], a[200:203], a[124:127], v[248:251]
    ds_read_b64_tr_b16 a[172:173], v81 offset:57352
    ds_read_b64_tr_b16 a[174:175], v81 offset:58376
    v_mfma_f32_16x16x32_bf16 v[248:251], a[184:187], a[120:123], v[248:251]
    v_mfma_f32_16x16x32_bf16 v[252:255], a[188:191], a[120:123], v[252:255]
    v_mfma_f32_16x16x32_bf16 v[252:255], a[204:207], a[124:127], v[252:255]
    v_mfma_f32_16x16x32_bf16 v[220:223], a[204:207], a[116:119], v[220:223]
    v_mfma_f32_16x16x32_bf16 v[220:223], a[188:191], a[112:115], v[220:223]
    v_mfma_f32_16x16x32_bf16 v[188:191], a[188:191], a[104:107], v[188:191]
    v_mfma_f32_16x16x32_bf16 v[188:191], a[204:207], a[108:111], v[188:191]
    v_mfma_f32_16x16x32_bf16 v[156:159], a[204:207], a[100:103], v[156:159]
    buffer_store_dwordx4 v[88:91], v51, s[24:27], s60 offen offset:1024 sc1
    v_mfma_f32_16x16x32_bf16 v[156:159], a[188:191], a[96:99], v[156:159]
    s_waitcnt lgkmcnt(0)
    v_smfmac_f32_16x16x64_bf16 a[140:143], a[136:139], a[160:167], v27
    ds_read_b64_tr_b16 a[176:177], v82 offset:49152
    ds_read_b64_tr_b16 a[178:179], v82 offset:50176
    v_smfmac_f32_16x16x64_bf16 a[140:143], a[136:139], a[144:151], v27
    v_mfma_f32_16x16x32_bf16 v[128:131], a[144:147], a[208:211], v[128:131]
    ds_read_b64_tr_b16 a[192:193], v82 offset:57344
    ds_read_b64_tr_b16 a[194:195], v82 offset:58368
    v_mfma_f32_16x16x32_bf16 v[128:131], a[160:163], a[212:215], v[128:131]
    s_waitcnt vmcnt(8)
    v_mfma_f32_16x16x32_bf16 v[160:163], a[160:163], a[220:223], v[160:163]
    ds_read_b64_tr_b16 a[180:181], v82 offset:49160
    ds_read_b64_tr_b16 a[182:183], v82 offset:50184
    v_mfma_f32_16x16x32_bf16 v[160:163], a[144:147], a[216:219], v[160:163]
    v_min3_u32 v59, v49, v53, v57
    v_mfma_f32_16x16x32_bf16 v[192:195], a[144:147], a[224:227], v[192:195]
    ds_read_b64_tr_b16 a[196:197], v82 offset:57352
    ds_read_b64_tr_b16 a[198:199], v82 offset:58376
    v_mfma_f32_16x16x32_bf16 v[192:195], a[160:163], a[228:231], v[192:195]
    buffer_store_dwordx4 v[44:47], v43, s[24:27], s69 offen offset:0 sc1
    v_mfma_f32_16x16x32_bf16 v[224:227], a[160:163], a[236:239], v[224:227]
    ds_read_b64_tr_b16 a[184:185], v83 offset:49152
    ds_read_b64_tr_b16 a[186:187], v83 offset:50176
    v_mfma_f32_16x16x32_bf16 v[224:227], a[144:147], a[232:235], v[224:227]
    v_min_u32 v59, v59, v61
    v_mfma_f32_16x16x32_bf16 v[228:231], a[148:151], a[232:235], v[228:231]
    ds_read_b64_tr_b16 a[200:201], v83 offset:57344
    ds_read_b64_tr_b16 a[202:203], v83 offset:58368
    v_mfma_f32_16x16x32_bf16 v[228:231], a[164:167], a[236:239], v[228:231]
    v_cmp_ne_u32 vcc, 0, v59
    v_mfma_f32_16x16x32_bf16 v[196:199], a[164:167], a[228:231], v[196:199]
    ds_read_b64_tr_b16 a[188:189], v83 offset:49160
    ds_read_b64_tr_b16 a[190:191], v83 offset:50184
    v_mfma_f32_16x16x32_bf16 v[196:199], a[148:151], a[224:227], v[196:199]
    v_mfma_f32_16x16x32_bf16 v[164:167], a[148:151], a[216:219], v[164:167]
    ds_read_b64_tr_b16 a[204:205], v83 offset:57352
    ds_read_b64_tr_b16 a[206:207], v83 offset:58376
    v_mfma_f32_16x16x32_bf16 v[164:167], a[164:167], a[220:223], v[164:167]
    s_cmp_eq_u64 vcc, -1
    s_cbranch_scc0 L_st_wait
L_st_ok:
    v_mfma_f32_16x16x32_bf16 v[132:135], a[164:167], a[212:215], v[132:135]
    buffer_store_dwordx4 v[44:47], v43, s[24:27], s69 offen offset:1024 sc1
    v_mfma_f32_16x16x32_bf16 v[132:135], a[148:151], a[208:211], v[132:135]
    v_lshlrev_b32 v48, 16, v49
    v_lshlrev_b32 v52, 16, v53
    v_mfma_f32_16x16x32_bf16 v[136:139], a[152:155], a[208:211], v[136:139]
    v_lshlrev_b32 v56, 16, v57
    v_lshlrev_b32 v60, 16, v61
    v_mfma_f32_16x16x32_bf16 v[136:139], a[168:171], a[212:215], v[136:139]
    v_and_b32 v50, 0xffff0000, v49
    v_and_b32 v54, 0xffff0000, v53
    v_mfma_f32_16x16x32_bf16 v[168:171], a[168:171], a[220:223], v[168:171]
    v_and_b32 v58, 0xffff0000, v57
    v_and_b32 v62, 0xffff0000, v61
    v_mfma_f32_16x16x32_bf16 v[168:171], a[152:155], a[216:219], v[168:171]
    v_rcp_f32 v50, v50
    v_mfma_f32_16x16x32_bf16 v[200:203], a[152:155], a[224:227], v[200:203]
    v_rcp_f32 v54, v54
    v_mfma_f32_16x16x32_bf16 v[200:203], a[168:171], a[228:231], v[200:203]
    v_rcp_f32 v58, v58
    v_mfma_f32_16x16x32_bf16 v[232:235], a[168:171], a[236:239], v[232:235]
    v_rcp_f32 v62, v62
    v_mfma_f32_16x16x32_bf16 v[232:235], a[152:155], a[232:235], v[232:235]
L_pad2:
    s_cbranch_execz L_pad6
    buffer_store_dwordx4 v[44:47], v42, s[24:27], s71 offen offset:0 sc1
    v_mfma_f32_16x16x32_bf16 v[236:239], a[156:159], a[232:235], v[236:239]
    v_xor_b32 v48, 0x80000000, v48
    v_xor_b32 v52, 0x80000000, v52
    v_mfma_f32_16x16x32_bf16 v[236:239], a[172:175], a[236:239], v[236:239]
    v_accvgpr_read_b32 v120, a140
    v_accvgpr_read_b32 v121, a141
    v_mfma_f32_16x16x32_bf16 v[204:207], a[172:175], a[228:231], v[204:207]
    v_accvgpr_read_b32 v122, a142
    v_accvgpr_read_b32 v123, a143
    v_mfma_f32_16x16x32_bf16 v[204:207], a[156:159], a[224:227], v[204:207]
    v_add_f32 v120, v120, v121
    v_add_f32 v122, v122, v123
    v_mfma_f32_16x16x32_bf16 v[172:175], a[156:159], a[216:219], v[172:175]
    ds_write2_b32 v63, v120, v122 offset1:16
    v_mfma_f32_16x16x32_bf16 v[172:175], a[172:175], a[220:223], v[172:175]
    v_xor_b32 v56, 0x80000000, v56
    v_xor_b32 v60, 0x80000000, v60
    v_mfma_f32_16x16x32_bf16 v[140:143], a[172:175], a[212:215], v[140:143]
    v_mul_f32 v50, 0x3e0293ee, v50
    v_mul_f32 v54, 0x3e0293ee, v54
    v_mfma_f32_16x16x32_bf16 v[140:143], a[156:159], a[208:211], v[140:143]
    s_waitcnt lgkmcnt(0)
    v_mfma_f32_16x16x32_bf16 v[144:147], a[176:179], a[208:211], v[144:147]
    buffer_store_dwordx4 v[44:47], v42, s[24:27], s71 offen offset:1024 sc1
    v_mfma_f32_16x16x32_bf16 v[144:147], a[192:195], a[212:215], v[144:147]
    v_mul_f32 v58, 0x3e0293ee, v58
    v_mul_f32 v62, 0x3e0293ee, v62
    v_mfma_f32_16x16x32_bf16 v[148:151], a[196:199], a[212:215], v[148:151]
    v_add_u32 v64, 131072, v126
    v_xor_b32 v65, 8192, v126
    v_mfma_f32_16x16x32_bf16 v[148:151], a[180:183], a[208:211], v[148:151]
    v_xor_b32 v66, 16384, v126
    v_xor_b32 v67, 24576, v126
    v_mfma_f32_16x16x32_bf16 v[152:155], a[184:187], a[208:211], v[152:155]
    v_add_u32 v65, 131072, v65
    v_add_u32 v66, 131072, v66
    v_mfma_f32_16x16x32_bf16 v[152:155], a[200:203], a[212:215], v[152:155]
    v_add_u32 v67, 131072, v67
    v_mfma_f32_16x16x32_bf16 v[156:159], a[204:207], a[212:215], v[156:159]
    s_waitcnt vmcnt(19)
    s_barrier
    v_mfma_f32_16x16x32_bf16 v[156:159], a[188:191], a[208:211], v[156:159]
    v_mfma_f32_16x16x32_bf16 v[188:191], a[188:191], a[216:219], v[188:191]
    ds_read_b128 v[96:99], v64 offset:0
    ds_read_b128 v[100:103], v64 offset:64
    v_mfma_f32_16x16x32_bf16 v[188:191], a[204:207], a[220:223], v[188:191]
    buffer_store_dwordx4 v[44:47], v42, s[24:27], s71 offen offset:2048 sc1
    v_mfma_f32_16x16x32_bf16 v[184:187], a[200:203], a[220:223], v[184:187]
    ds_read_b128 v[104:107], v65 offset:0
    ds_read_b128 v[108:111], v65 offset:64
    v_mfma_f32_16x16x32_bf16 v[184:187], a[184:187], a[216:219], v[184:187]
    v_mfma_f32_16x16x32_bf16 v[180:183], a[180:183], a[216:219], v[180:183]
    ds_read_b128 v[112:115], v66 offset:0
    ds_read_b128 v[116:119], v66 offset:64
    v_mfma_f32_16x16x32_bf16 v[180:183], a[196:199], a[220:223], v[180:183]
    v_mfma_f32_16x16x32_bf16 v[176:179], a[192:195], a[220:223], v[176:179]
    ds_read_b128 v[120:123], v67 offset:0
    ds_read_b128 v[124:127], v67 offset:64
    v_mfma_f32_16x16x32_bf16 v[176:179], a[176:179], a[216:219], v[176:179]
    v_mfma_f32_16x16x32_bf16 v[208:211], a[176:179], a[224:227], v[208:211]
    ds_read_b128 a[64:67], v8 offset:0
    ds_read_b128 a[68:71], v9 offset:0
    v_mfma_f32_16x16x32_bf16 v[208:211], a[192:195], a[228:231], v[208:211]
    v_mfma_f32_16x16x32_bf16 v[212:215], a[196:199], a[228:231], v[212:215]
    ds_read_b128 a[72:75], v10 offset:0
    ds_read_b128 a[76:79], v11 offset:0
    v_mfma_f32_16x16x32_bf16 v[212:215], a[180:183], a[224:227], v[212:215]
    buffer_store_dwordx4 v[44:47], v42, s[24:27], s71 offen offset:3072 sc1
    v_mfma_f32_16x16x32_bf16 v[216:219], a[184:187], a[224:227], v[216:219]
    ds_read_b128 a[80:83], v8 offset:4096
    ds_read_b128 a[84:87], v9 offset:4096
    v_mfma_f32_16x16x32_bf16 v[216:219], a[200:203], a[228:231], v[216:219]
    v_mfma_f32_16x16x32_bf16 v[220:223], a[204:207], a[228:231], v[220:223]
    ds_read_b128 a[88:91], v10 offset:4096
    ds_read_b128 a[92:95], v11 offset:4096
    v_mfma_f32_16x16x32_bf16 v[220:223], a[188:191], a[224:227], v[220:223]
    v_mfma_f32_16x16x32_bf16 v[252:255], a[188:191], a[232:235], v[252:255]
    s_mov_b64 s[48:49], s[78:79]
    s_mov_b32 s50, 1835008
    v_mfma_f32_16x16x32_bf16 v[252:255], a[204:207], a[236:239], v[252:255]
    s_mov_b64 s[12:13], s[80:81]
    s_mov_b32 s14, 1835008
    v_mfma_f32_16x16x32_bf16 v[248:251], a[200:203], a[236:239], v[248:251]
    s_mul_i32 s91, s28, 458752
    s_and_b32 s43, s4, 127
    v_mfma_f32_16x16x32_bf16 v[248:251], a[184:187], a[232:235], v[248:251]
    s_lshl_b32 s43, s43, 5
    s_add_u32 s91, s91, s43
    v_mfma_f32_16x16x32_bf16 v[244:247], a[180:183], a[232:235], v[244:247]
    s_lshl_b32 s64, s95, 19
    s_lshl_b32 s43, s28, 17
    v_mfma_f32_16x16x32_bf16 v[244:247], a[196:199], a[236:239], v[244:247]
    s_add_u32 s64, s64, s43
    s_add_u32 s65, s64, 524288
    v_mfma_f32_16x16x32_bf16 v[240:243], a[192:195], a[236:239], v[240:243]
    s_add_u32 s66, s64, 1048576
    s_add_u32 s67, s64, 1572864
    v_mfma_f32_16x16x32_bf16 v[240:243], a[176:179], a[232:235], v[240:243]
    s_waitcnt lgkmcnt(8)
    v_pk_fma_f32 v[128:129], v[96:97], v[48:49], v[128:129] op_sel_hi:[1,0,1]
    v_pk_fma_f32 v[130:131], v[98:99], v[48:49], v[130:131] op_sel_hi:[1,0,1]
    v_pk_fma_f32 v[132:133], v[100:101], v[48:49], v[132:133] op_sel_hi:[1,0,1]
    v_pk_fma_f32 v[134:135], v[102:103], v[48:49], v[134:135] op_sel_hi:[1,0,1]
    v_pk_fma_f32 v[136:137], v[104:105], v[48:49], v[136:137] op_sel_hi:[1,0,1]
    v_pk_fma_f32 v[138:139], v[106:107], v[48:49], v[138:139] op_sel_hi:[1,0,1]
    v_pk_fma_f32 v[140:141], v[108:109], v[48:49], v[140:141] op_sel_hi:[1,0,1]
    v_pk_fma_f32 v[142:143], v[110:111], v[48:49], v[142:143] op_sel_hi:[1,0,1]
    v_pk_fma_f32 v[144:145], v[112:113], v[48:49], v[144:145] op_sel_hi:[1,0,1]
    v_pk_fma_f32 v[146:147], v[114:115], v[48:49], v[146:147] op_sel_hi:[1,0,1]
    v_pk_fma_f32 v[148:149], v[116:117], v[48:49], v[148:149] op_sel_hi:[1,0,1]
    v_pk_fma_f32 v[150:151], v[118:119], v[48:49], v[150:151] op_sel_hi:[1,0,1]
    v_pk_fma_f32 v[152:153], v[120:121], v[48:49], v[152:153] op_sel_hi:[1,0,1]
    v_pk_fma_f32 v[154:155], v[122:123], v[48:49], v[154:155] op_sel_hi:[1,0,1]
    v_pk_fma_f32 v[156:157], v[124:125], v[48:49], v[156:157] op_sel_hi:[1,0,1]
    v_pk_fma_f32 v[158:159], v[126:127], v[48:49], v[158:159] op_sel_hi:[1,0,1]
    v_pk_mul_f32 v[128:129], v[128:129], v[50:51] op_sel_hi:[1,0]
    v_pk_mul_f32 v[130:131], v[130:131], v[50:51] op_sel_hi:[1,0]
    v_pk_mul_f32 v[132:133], v[132:133], v[50:51] op_sel_hi:[1,0]
    v_pk_mul_f32 v[134:135], v[134:135], v[50:51] op_sel_hi:[1,0]
    v_pk_mul_f32 v[136:137], v[136:137], v[50:51] op_sel_hi:[1,0]
    v_pk_mul_f32 v[138:139], v[138:139], v[50:51] op_sel_hi:[1,0]
    v_pk_mul_f32 v[140:141], v[140:141], v[50:51] op_sel_hi:[1,0]
    v_pk_mul_f32 v[142:143], v[142:143], v[50:51] op_sel_hi:[1,0]
    v_pk_mul_f32 v[144:145], v[144:145], v[50:51] op_sel_hi:[1,0]
    v_pk_mul_f32 v[146:147], v[146:147], v[50:51] op_sel_hi:[1,0]
    v_pk_mul_f32 v[148:149], v[148:149], v[50:51] op_sel_hi:[1,0]
    v_pk_mul_f32 v[150:151], v[150:151], v[50:51] op_sel_hi:[1,0]
    v_pk_mul_f32 v[152:153], v[152:153], v[50:51] op_sel_hi:[1,0]
    v_pk_mul_f32 v[154:155], v[154:155], v[50:51] op_sel_hi:[1,0]
    v_pk_mul_f32 v[156:157], v[156:157], v[50:51] op_sel_hi:[1,0]
    v_pk_mul_f32 v[158:159], v[158:159], v[50:51] op_sel_hi:[1,0]
    v_cvt_pk_bf16_f32 v128, v128, v129
    v_accvgpr_write_b32 a0, v128
    v_cvt_pk_bf16_f32 v130, v130, v131
    v_accvgpr_write_b32 a1, v130
    v_cvt_pk_bf16_f32 v132, v132, v133
    v_accvgpr_write_b32 a2, v132
    v_cvt_pk_bf16_f32 v134, v134, v135
    v_accvgpr_write_b32 a3, v134
    v_cvt_pk_bf16_f32 v136, v136, v137
    v_accvgpr_write_b32 a4, v136
    v_cvt_pk_bf16_f32 v138, v138, v139
    v_accvgpr_write_b32 a5, v138
    v_cvt_pk_bf16_f32 v140, v140, v141
    v_accvgpr_write_b32 a6, v140
    v_cvt_pk_bf16_f32 v142, v142, v143
    v_accvgpr_write_b32 a7, v142
    v_cvt_pk_bf16_f32 v144, v144, v145
    v_accvgpr_write_b32 a8, v144
    v_cvt_pk_bf16_f32 v146, v146, v147
    v_accvgpr_write_b32 a9, v146
    v_cvt_pk_bf16_f32 v148, v148, v149
    v_accvgpr_write_b32 a10, v148
    v_cvt_pk_bf16_f32 v150, v150, v151
    v_accvgpr_write_b32 a11, v150
    v_cvt_pk_bf16_f32 v152, v152, v153
    v_accvgpr_write_b32 a12, v152
    v_cvt_pk_bf16_f32 v154, v154, v155
    v_accvgpr_write_b32 a13, v154
    v_cvt_pk_bf16_f32 v156, v156, v157
    v_accvgpr_write_b32 a14, v156
    v_cvt_pk_bf16_f32 v158, v158, v159
    v_accvgpr_write_b32 a15, v158
    s_waitcnt lgkmcnt(0)
    v_pk_fma_f32 v[160:161], v[96:97], v[52:53], v[160:161] op_sel_hi:[1,0,1]
    v_pk_fma_f32 v[162:163], v[98:99], v[52:53], v[162:163] op_sel_hi:[1,0,1]
    v_pk_fma_f32 v[164:165], v[100:101], v[52:53], v[164:165] op_sel_hi:[1,0,1]
    v_pk_fma_f32 v[166:167], v[102:103], v[52:53], v[166:167] op_sel_hi:[1,0,1]
    v_pk_fma_f32 v[168:169], v[104:105], v[52:53], v[168:169] op_sel_hi:[1,0,1]
    v_pk_fma_f32 v[170:171], v[106:107], v[52:53], v[170:171] op_sel_hi:[1,0,1]
    v_pk_fma_f32 v[172:173], v[108:109], v[52:53], v[172:173] op_sel_hi:[1,0,1]
    v_pk_fma_f32 v[174:175], v[110:111], v[52:53], v[174:175] op_sel_hi:[1,0,1]
    v_pk_fma_f32 v[176:177], v[112:113], v[52:53], v[176:177] op_sel_hi:[1,0,1]
    v_pk_fma_f32 v[178:179], v[114:115], v[52:53], v[178:179] op_sel_hi:[1,0,1]
    v_pk_fma_f32 v[180:181], v[116:117], v[52:53], v[180:181] op_sel_hi:[1,0,1]
    v_pk_fma_f32 v[182:183], v[118:119], v[52:53], v[182:183] op_sel_hi:[1,0,1]
    v_pk_fma_f32 v[184:185], v[120:121], v[52:53], v[184:185] op_sel_hi:[1,0,1]
    v_pk_fma_f32 v[186:187], v[122:123], v[52:53], v[186:187] op_sel_hi:[1,0,1]
    v_pk_fma_f32 v[188:189], v[124:125], v[52:53], v[188:189] op_sel_hi:[1,0,1]
    v_pk_fma_f32 v[190:191], v[126:127], v[52:53], v[190:191] op_sel_hi:[1,0,1]
    v_pk_mul_f32 v[160:161], v[160:161], v[54:55] op_sel_hi:[1,0]
    v_pk_mul_f32 v[162:163], v[162:163], v[54:55] op_sel_hi:[1,0]
    v_pk_mul_f32 v[164:165], v[164:165], v[54:55] op_sel_hi:[1,0]
    v_pk_mul_f32 v[166:167], v[166:167], v[54:55] op_sel_hi:[1,0]
    v_pk_mul_f32 v[168:169], v[168:169], v[54:55] op_sel_hi:[1,0]
    v_pk_mul_f32 v[170:171], v[170:171], v[54:55] op_sel_hi:[1,0]
    v_pk_mul_f32 v[172:173], v[172:173], v[54:55] op_sel_hi:[1,0]
    v_pk_mul_f32 v[174:175], v[174:175], v[54:55] op_sel_hi:[1,0]
    v_pk_mul_f32 v[176:177], v[176:177], v[54:55] op_sel_hi:[1,0]
    v_pk_mul_f32 v[178:179], v[178:179], v[54:55] op_sel_hi:[1,0]
    v_pk_mul_f32 v[180:181], v[180:181], v[54:55] op_sel_hi:[1,0]
    v_pk_mul_f32 v[182:183], v[182:183], v[54:55] op_sel_hi:[1,0]
    v_pk_mul_f32 v[184:185], v[184:185], v[54:55] op_sel_hi:[1,0]
    v_pk_mul_f32 v[186:187], v[186:187], v[54:55] op_sel_hi:[1,0]
    v_pk_mul_f32 v[188:189], v[188:189], v[54:55] op_sel_hi:[1,0]
    v_pk_mul_f32 v[190:191], v[190:191], v[54:55] op_sel_hi:[1,0]
    v_mfma_f32_16x16x32_bf16 v[64:67], a[64:67], a[0:3], 0
    s_add_u32 m0, s31, 32768
    v_cvt_pk_bf16_f32 v160, v160, v161
    v_accvgpr_write_b32 a16, v160
    v_cvt_pk_bf16_f32 v162, v162, v163
    v_accvgpr_write_b32 a17, v162
    v_mfma_f32_16x16x32_bf16 v[64:67], a[68:71], a[4:7], v[64:67]
    v_cvt_pk_bf16_f32 v164, v164, v165
    v_accvgpr_write_b32 a18, v164
    v_cvt_pk_bf16_f32 v166, v166, v167
    v_accvgpr_write_b32 a19, v166
    v_mfma_f32_16x16x32_bf16 v[64:67], a[72:75], a[8:11], v[64:67]
    buffer_load_dwordx4 v20, s[16:19], s32 offen offset:0 lds
    v_cvt_pk_bf16_f32 v168, v168, v169
    v_accvgpr_write_b32 a20, v168
    v_cvt_pk_bf16_f32 v170, v170, v171
    v_accvgpr_write_b32 a21, v170
    v_mfma_f32_16x16x32_bf16 v[64:67], a[76:79], a[12:15], v[64:67]
    v_cvt_pk_bf16_f32 v172, v172, v173
    v_accvgpr_write_b32 a22, v172
    v_cvt_pk_bf16_f32 v174, v174, v175
    v_accvgpr_write_b32 a23, v174
    v_mfma_f32_16x16x32_bf16 v[68:71], a[92:95], a[12:15], 0
    buffer_load_dwordx4 v21, s[16:19], s32 offen offset:1024 lds
    v_cvt_pk_bf16_f32 v176, v176, v177
    v_accvgpr_write_b32 a24, v176
    v_cvt_pk_bf16_f32 v178, v178, v179
    v_accvgpr_write_b32 a25, v178
    v_mfma_f32_16x16x32_bf16 v[68:71], a[88:91], a[8:11], v[68:71]
    v_cvt_pk_bf16_f32 v180, v180, v181
    v_accvgpr_write_b32 a26, v180
    v_cvt_pk_bf16_f32 v182, v182, v183
    v_accvgpr_write_b32 a27, v182
    v_mfma_f32_16x16x32_bf16 v[68:71], a[84:87], a[4:7], v[68:71]
    buffer_load_dwordx4 v22, s[16:19], s32 offen offset:2048 lds
    v_cvt_pk_bf16_f32 v184, v184, v185
    v_accvgpr_write_b32 a28, v184
    v_cvt_pk_bf16_f32 v186, v186, v187
    v_accvgpr_write_b32 a29, v186
    v_mfma_f32_16x16x32_bf16 v[68:71], a[80:83], a[0:3], v[68:71]
    v_cvt_pk_bf16_f32 v188, v188, v189
    v_accvgpr_write_b32 a30, v188
    v_cvt_pk_bf16_f32 v190, v190, v191
    v_accvgpr_write_b32 a31, v190
    v_pk_fma_f32 v[192:193], v[96:97], v[56:57], v[192:193] op_sel_hi:[1,0,1]
    v_pk_fma_f32 v[194:195], v[98:99], v[56:57], v[194:195] op_sel_hi:[1,0,1]
    v_pk_fma_f32 v[196:197], v[100:101], v[56:57], v[196:197] op_sel_hi:[1,0,1]
    v_pk_fma_f32 v[198:199], v[102:103], v[56:57], v[198:199] op_sel_hi:[1,0,1]
    v_pk_fma_f32 v[200:201], v[104:105], v[56:57], v[200:201] op_sel_hi:[1,0,1]
    v_pk_fma_f32 v[202:203], v[106:107], v[56:57], v[202:203] op_sel_hi:[1,0,1]
    v_pk_fma_f32 v[204:205], v[108:109], v[56:57], v[204:205] op_sel_hi:[1,0,1]
    v_pk_fma_f32 v[206:207], v[110:111], v[56:57], v[206:207] op_sel_hi:[1,0,1]
    v_pk_fma_f32 v[208:209], v[112:113], v[56:57], v[208:209] op_sel_hi:[1,0,1]
    v_pk_fma_f32 v[210:211], v[114:115], v[56:57], v[210:211] op_sel_hi:[1,0,1]
    v_pk_fma_f32 v[212:213], v[116:117], v[56:57], v[212:213] op_sel_hi:[1,0,1]
    v_pk_fma_f32 v[214:215], v[118:119], v[56:57], v[214:215] op_sel_hi:[1,0,1]
    v_pk_fma_f32 v[216:217], v[120:121], v[56:57], v[216:217] op_sel_hi:[1,0,1]
    v_pk_fma_f32 v[218:219], v[122:123], v[56:57], v[218:219] op_sel_hi:[1,0,1]
    v_pk_fma_f32 v[220:221], v[124:125], v[56:57], v[220:221] op_sel_hi:[1,0,1]
    v_pk_fma_f32 v[222:223], v[126:127], v[56:57], v[222:223] op_sel_hi:[1,0,1]
    v_pk_mul_f32 v[192:193], v[192:193], v[58:59] op_sel_hi:[1,0]
    v_pk_mul_f32 v[194:195], v[194:195], v[58:59] op_sel_hi:[1,0]
    v_pk_mul_f32 v[196:197], v[196:197], v[58:59] op_sel_hi:[1,0]
    v_pk_mul_f32 v[198:199], v[198:199], v[58:59] op_sel_hi:[1,0]
    v_pk_mul_f32 v[200:201], v[200:201], v[58:59] op_sel_hi:[1,0]
    v_pk_mul_f32 v[202:203], v[202:203], v[58:59] op_sel_hi:[1,0]
    v_pk_mul_f32 v[204:205], v[204:205], v[58:59] op_sel_hi:[1,0]
    v_pk_mul_f32 v[206:207], v[206:207], v[58:59] op_sel_hi:[1,0]
    v_pk_mul_f32 v[208:209], v[208:209], v[58:59] op_sel_hi:[1,0]
    v_pk_mul_f32 v[210:211], v[210:211], v[58:59] op_sel_hi:[1,0]
    v_pk_mul_f32 v[212:213], v[212:213], v[58:59] op_sel_hi:[1,0]
    v_pk_mul_f32 v[214:215], v[214:215], v[58:59] op_sel_hi:[1,0]
    v_pk_mul_f32 v[216:217], v[216:217], v[58:59] op_sel_hi:[1,0]
    v_pk_mul_f32 v[218:219], v[218:219], v[58:59] op_sel_hi:[1,0]
    v_pk_mul_f32 v[220:221], v[220:221], v[58:59] op_sel_hi:[1,0]
    v_pk_mul_f32 v[222:223], v[222:223], v[58:59] op_sel_hi:[1,0]
    v_mfma_f32_16x16x32_bf16 v[76:79], a[80:83], a[16:19], 0
    buffer_load_dwordx4 v23, s[16:19], s32 offen offset:3072 lds
    v_cvt_pk_bf16_f32 v192, v192, v193
    v_accvgpr_write_b32 a32, v192
    v_cvt_pk_bf16_f32 v194, v194, v195
    v_accvgpr_write_b32 a33, v194
    v_mfma_f32_16x16x32_bf16 v[76:79], a[84:87], a[20:23], v[76:79]
    v_cvt_pk_bf16_f32 v196, v196, v197
    v_accvgpr_write_b32 a34, v196
    v_cvt_pk_bf16_f32 v198, v198, v199
    v_accvgpr_write_b32 a35, v198
    v_mfma_f32_16x16x32_bf16 v[76:79], a[88:91], a[24:27], v[76:79]
    s_add_u32 s32, s32, 16384
    v_cvt_pk_bf16_f32 v200, v200, v201
    v_accvgpr_write_b32 a36, v200
    v_cvt_pk_bf16_f32 v202, v202, v203
    v_accvgpr_write_b32 a37, v202
    v_mfma_f32_16x16x32_bf16 v[76:79], a[92:95], a[28:31], v[76:79]
    v_cvt_pk_bf16_f32 v204, v204, v205
    v_accvgpr_write_b32 a38, v204
    v_cvt_pk_bf16_f32 v206, v206, v207
    v_accvgpr_write_b32 a39, v206
    v_mfma_f32_16x16x32_bf16 v[72:75], a[76:79], a[28:31], 0
    s_add_u32 m0, s31, 81920
    v_cvt_pk_bf16_f32 v208, v208, v209
    v_accvgpr_write_b32 a40, v208
    v_cvt_pk_bf16_f32 v210, v210, v211
    v_accvgpr_write_b32 a41, v210
    v_mfma_f32_16x16x32_bf16 v[72:75], a[72:75], a[24:27], v[72:75]
    v_cvt_pk_bf16_f32 v212, v212, v213
    v_accvgpr_write_b32 a42, v212
    v_cvt_pk_bf16_f32 v214, v214, v215
    v_accvgpr_write_b32 a43, v214
    v_mfma_f32_16x16x32_bf16 v[72:75], a[68:71], a[20:23], v[72:75]
    buffer_load_dwordx4 v24, s[20:23], s39 offen offset:0 lds
    v_cvt_pk_bf16_f32 v216, v216, v217
    v_accvgpr_write_b32 a44, v216
    v_cvt_pk_bf16_f32 v218, v218, v219
    v_accvgpr_write_b32 a45, v218
    v_mfma_f32_16x16x32_bf16 v[72:75], a[64:67], a[16:19], v[72:75]
    v_cvt_pk_bf16_f32 v220, v220, v221
    v_accvgpr_write_b32 a46, v220
    v_cvt_pk_bf16_f32 v222, v222, v223
    v_accvgpr_write_b32 a47, v222
    v_pk_fma_f32 v[224:225], v[96:97], v[60:61], v[224:225] op_sel_hi:[1,0,1]
    v_pk_fma_f32 v[226:227], v[98:99], v[60:61], v[226:227] op_sel_hi:[1,0,1]
    v_pk_fma_f32 v[228:229], v[100:101], v[60:61], v[228:229] op_sel_hi:[1,0,1]
    v_pk_fma_f32 v[230:231], v[102:103], v[60:61], v[230:231] op_sel_hi:[1,0,1]
    v_pk_fma_f32 v[232:233], v[104:105], v[60:61], v[232:233] op_sel_hi:[1,0,1]
    v_pk_fma_f32 v[234:235], v[106:107], v[60:61], v[234:235] op_sel_hi:[1,0,1]
    v_pk_fma_f32 v[236:237], v[108:109], v[60:61], v[236:237] op_sel_hi:[1,0,1]
    v_pk_fma_f32 v[238:239], v[110:111], v[60:61], v[238:239] op_sel_hi:[1,0,1]
    v_pk_fma_f32 v[240:241], v[112:113], v[60:61], v[240:241] op_sel_hi:[1,0,1]
    v_pk_fma_f32 v[242:243], v[114:115], v[60:61], v[242:243] op_sel_hi:[1,0,1]
    v_pk_fma_f32 v[244:245], v[116:117], v[60:61], v[244:245] op_sel_hi:[1,0,1]
    v_pk_fma_f32 v[246:247], v[118:119], v[60:61], v[246:247] op_sel_hi:[1,0,1]
    v_pk_fma_f32 v[248:249], v[120:121], v[60:61], v[248:249] op_sel_hi:[1,0,1]
    v_pk_fma_f32 v[250:251], v[122:123], v[60:61], v[250:251] op_sel_hi:[1,0,1]
    v_pk_fma_f32 v[252:253], v[124:125], v[60:61], v[252:253] op_sel_hi:[1,0,1]
    v_pk_fma_f32 v[254:255], v[126:127], v[60:61], v[254:255] op_sel_hi:[1,0,1]
    v_pk_mul_f32 v[224:225], v[224:225], v[62:63] op_sel_hi:[1,0]
    v_pk_mul_f32 v[226:227], v[226:227], v[62:63] op_sel_hi:[1,0]
    v_pk_mul_f32 v[228:229], v[228:229], v[62:63] op_sel_hi:[1,0]
    v_pk_mul_f32 v[230:231], v[230:231], v[62:63] op_sel_hi:[1,0]
    v_pk_mul_f32 v[232:233], v[232:233], v[62:63] op_sel_hi:[1,0]
    v_pk_mul_f32 v[234:235], v[234:235], v[62:63] op_sel_hi:[1,0]
    v_pk_mul_f32 v[236:237], v[236:237], v[62:63] op_sel_hi:[1,0]
    v_pk_mul_f32 v[238:239], v[238:239], v[62:63] op_sel_hi:[1,0]
    v_pk_mul_f32 v[240:241], v[240:241], v[62:63] op_sel_hi:[1,0]
    v_pk_mul_f32 v[242:243], v[242:243], v[62:63] op_sel_hi:[1,0]
    v_pk_mul_f32 v[244:245], v[244:245], v[62:63] op_sel_hi:[1,0]
    v_pk_mul_f32 v[246:247], v[246:247], v[62:63] op_sel_hi:[1,0]
    v_pk_mul_f32 v[248:249], v[248:249], v[62:63] op_sel_hi:[1,0]
    v_pk_mul_f32 v[250:251], v[250:251], v[62:63] op_sel_hi:[1,0]
    v_pk_mul_f32 v[252:253], v[252:253], v[62:63] op_sel_hi:[1,0]
    v_pk_mul_f32 v[254:255], v[254:255], v[62:63] op_sel_hi:[1,0]
    v_mfma_f32_16x16x32_bf16 v[80:83], a[64:67], a[32:35], 0
    buffer_load_dwordx4 v25, s[20:23], s39 offen offset:1024 lds
    v_cvt_pk_bf16_f32 v224, v224, v225
    v_accvgpr_write_b32 a48, v224
    v_cvt_pk_bf16_f32 v226, v226, v227
    v_accvgpr_write_b32 a49, v226
    v_mfma_f32_16x16x32_bf16 v[80:83], a[68:71], a[36:39], v[80:83]
    v_cvt_pk_bf16_f32 v228, v228, v229
    v_accvgpr_write_b32 a50, v228
    v_cvt_pk_bf16_f32 v230, v230, v231
    v_accvgpr_write_b32 a51, v230
    v_mfma_f32_16x16x32_bf16 v[80:83], a[72:75], a[40:43], v[80:83]
    buffer_load_dwordx4 v24, s[20:23], s39 offen offset:2048 lds
    v_cvt_pk_bf16_f32 v232, v232, v233
    v_accvgpr_write_b32 a52, v232
    v_cvt_pk_bf16_f32 v234, v234, v235
    v_accvgpr_write_b32 a53, v234
    v_mfma_f32_16x16x32_bf16 v[80:83], a[76:79], a[44:47], v[80:83]
    v_cvt_pk_bf16_f32 v236, v236, v237
    v_accvgpr_write_b32 a54, v236
    v_cvt_pk_bf16_f32 v238, v238, v239
    v_accvgpr_write_b32 a55, v238
    v_mfma_f32_16x16x32_bf16 v[84:87], a[92:95], a[44:47], 0
    buffer_load_dwordx4 v25, s[20:23], s39 offen offset:3072 lds
    v_cvt_pk_bf16_f32 v240, v240, v241
    v_accvgpr_write_b32 a56, v240
    v_cvt_pk_bf16_f32 v242, v242, v243
    v_accvgpr_write_b32 a57, v242
    v_mfma_f32_16x16x32_bf16 v[84:87], a[88:91], a[40:43], v[84:87]
    v_cvt_pk_bf16_f32 v244, v244, v245
    v_accvgpr_write_b32 a58, v244
    v_cvt_pk_bf16_f32 v246, v246, v247
    v_accvgpr_write_b32 a59, v246
    v_mfma_f32_16x16x32_bf16 v[84:87], a[84:87], a[36:39], v[84:87]
    s_add_u32 s39, s39, 16384
    v_cvt_pk_bf16_f32 v248, v248, v249
    v_accvgpr_write_b32 a60, v248
    v_cvt_pk_bf16_f32 v250, v250, v251
    v_accvgpr_write_b32 a61, v250
    v_mfma_f32_16x16x32_bf16 v[84:87], a[80:83], a[32:35], v[84:87]
    v_cvt_pk_bf16_f32 v252, v252, v253
    v_accvgpr_write_b32 a62, v252
    v_cvt_pk_bf16_f32 v254, v254, v255
    v_accvgpr_write_b32 a63, v254
    v_max3_f32 v48, v64, v65, v66
    v_max3_f32 v48, v48, v67, v68
    v_mfma_f32_16x16x32_bf16 v[92:95], a[80:83], a[48:51], 0
    v_max3_f32 v48, v48, v69, v70
    v_max_f32 v48, v48, v71
    v_mfma_f32_16x16x32_bf16 v[92:95], a[84:87], a[52:55], v[92:95]
    v_max3_f32 v52, v72, v73, v74
    v_max3_f32 v52, v52, v75, v76
    v_mfma_f32_16x16x32_bf16 v[92:95], a[88:91], a[56:59], v[92:95]
    v_max3_f32 v52, v52, v77, v78
    v_max_f32 v52, v52, v79
    v_mfma_f32_16x16x32_bf16 v[92:95], a[92:95], a[60:63], v[92:95]
    v_max3_f32 v56, v80, v81, v82
    v_max3_f32 v56, v56, v83, v84
    v_mfma_f32_16x16x32_bf16 v[88:91], a[76:79], a[60:63], 0
    v_max3_f32 v56, v56, v85, v86
    v_max_f32 v56, v56, v87
    v_mfma_f32_16x16x32_bf16 v[88:91], a[72:75], a[56:59], v[88:91]
    v_mfma_f32_16x16x32_bf16 v[88:91], a[68:71], a[52:55], v[88:91]
    v_mfma_f32_16x16x32_bf16 v[88:91], a[64:67], a[48:51], v[88:91]
    ds_read_b128 a[92:95], v11 offset:12288
    ds_read_b128 a[88:91], v10 offset:12288
    ds_read_b128 a[84:87], v9 offset:12288
    ds_read_b128 a[80:83], v8 offset:12288
    ds_read_b128 a[76:79], v11 offset:8192
    ds_read_b128 a[72:75], v10 offset:8192
    ds_read_b128 a[68:71], v9 offset:8192
    ds_read_b128 a[64:67], v8 offset:8192
    v_max3_f32 v60, v88, v89, v90
    v_max3_f32 v60, v60, v91, v92
    v_max3_f32 v60, v60, v93, v94
    v_max_f32 v60, v60, v95
    v_mov_b32 v49, v48
    v_mov_b32 v53, v52
    v_mov_b32 v57, v56
    v_mov_b32 v61, v60
    v_permlane16_swap_b32 v48, v49
    v_permlane16_swap_b32 v52, v53
    v_permlane16_swap_b32 v56, v57
    v_permlane16_swap_b32 v60, v61
    v_max_f32 v48, v48, v49
    v_max_f32 v52, v52, v53
    v_max_f32 v56, v56, v57
    v_max_f32 v60, v60, v61
    v_mov_b32 v49, v48
    v_mov_b32 v53, v52
    v_mov_b32 v57, v56
    v_mov_b32 v61, v60
    v_permlane32_swap_b32 v48, v49
    v_permlane32_swap_b32 v52, v53
    v_permlane32_swap_b32 v56, v57
    v_permlane32_swap_b32 v60, v61
    v_max_f32 v48, v48, v49
    v_max_f32 v52, v52, v53
    v_max_f32 v56, v56, v57
    v_max_f32 v60, v60, v61
    v_pk_mul_f32 v[50:51], v[48:49], -1.0 op_sel_hi:[0,0]
    v_pk_mul_f32 v[48:49], v[48:49], -1.0 op_sel_hi:[0,0]
    v_pk_mul_f32 v[54:55], v[52:53], -1.0 op_sel_hi:[0,0]
    v_pk_mul_f32 v[52:53], v[52:53], -1.0 op_sel_hi:[0,0]
    v_pk_mul_f32 v[58:59], v[56:57], -1.0 op_sel_hi:[0,0]
    v_pk_mul_f32 v[56:57], v[56:57], -1.0 op_sel_hi:[0,0]
    v_pk_mul_f32 v[62:63], v[60:61], -1.0 op_sel_hi:[0,0]
    v_pk_mul_f32 v[60:61], v[60:61], -1.0 op_sel_hi:[0,0]
    v_pk_add_f32 v[64:65], v[64:65], v[48:49]
    v_pk_add_f32 v[66:67], v[66:67], v[48:49]
    v_pk_add_f32 v[68:69], v[68:69], v[48:49]
    v_pk_add_f32 v[70:71], v[70:71], v[48:49]
    v_pk_add_f32 v[72:73], v[72:73], v[52:53]
    v_pk_add_f32 v[74:75], v[74:75], v[52:53]
    v_pk_add_f32 v[76:77], v[76:77], v[52:53]
    v_pk_add_f32 v[78:79], v[78:79], v[52:53]
    v_pk_add_f32 v[80:81], v[80:81], v[56:57]
    v_pk_add_f32 v[82:83], v[82:83], v[56:57]
    v_pk_add_f32 v[84:85], v[84:85], v[56:57]
    v_pk_add_f32 v[86:87], v[86:87], v[56:57]
    v_pk_add_f32 v[88:89], v[88:89], v[60:61]
    v_pk_add_f32 v[90:91], v[90:91], v[60:61]
    v_pk_add_f32 v[92:93], v[92:93], v[60:61]
    v_pk_add_f32 v[94:95], v[94:95], v[60:61]
    s_waitcnt vmcnt(8)
    buffer_store_dwordx2 v[40:41], v34, s[24:27], s61 offen sc1
L_sm0:
    v_exp_f32 v40, v64
    v_exp_f32 v41, v65
    v_exp_f32 v42, v66
    v_exp_f32 v43, v67
    s_nop 0
    v_cvt_pk_bf16_f32 v96, v40, v41
    v_cvt_pk_bf16_f32 v97, v42, v43
    v_exp_f32 v44, v68
    v_exp_f32 v45, v69
    v_exp_f32 v46, v70
    v_exp_f32 v47, v71
    s_nop 0
    v_cvt_pk_bf16_f32 v98, v44, v45
    v_cvt_pk_bf16_f32 v99, v46, v47
    v_exp_f32 v40, v76
    v_exp_f32 v41, v77
    v_exp_f32 v42, v78
    v_exp_f32 v43, v79
    s_nop 0
    v_cvt_pk_bf16_f32 v102, v40, v41
    v_cvt_pk_bf16_f32 v103, v42, v43
    v_exp_f32 v44, v72
    v_exp_f32 v45, v73
    v_exp_f32 v46, v74
    v_exp_f32 v47, v75
    s_nop 0
    v_cvt_pk_bf16_f32 v100, v44, v45
    v_cvt_pk_bf16_f32 v101, v46, v47
    v_exp_f32 v40, v80
    v_exp_f32 v41, v81
    v_exp_f32 v42, v82
    v_exp_f32 v43, v83
    s_nop 0
    v_cvt_pk_bf16_f32 v104, v40, v41
    v_cvt_pk_bf16_f32 v105, v42, v43
    v_exp_f32 v44, v84
    v_exp_f32 v45, v85
    v_exp_f32 v46, v86
    v_exp_f32 v47, v87
    s_nop 0
    v_cvt_pk_bf16_f32 v106, v44, v45
    v_cvt_pk_bf16_f32 v107, v46, v47
    s_waitcnt vmcnt(18) lgkmcnt(0)
    s_barrier
    v_mfma_f32_16x16x32_bf16 v[64:67], a[64:67], a[0:3], v[48:51]
    s_add_u32 m0, s31, 49152
    v_exp_f32 v40, v92
    v_mfma_f32_16x16x32_bf16 v[64:67], a[68:71], a[4:7], v[64:67]
    v_exp_f32 v41, v93
    v_mfma_f32_16x16x32_bf16 v[64:67], a[72:75], a[8:11], v[64:67]
    v_exp_f32 v42, v94
    v_mfma_f32_16x16x32_bf16 v[64:67], a[76:79], a[12:15], v[64:67]
    v_exp_f32 v43, v95
    v_mfma_f32_16x16x32_bf16 v[68:71], a[92:95], a[12:15], v[48:51]
    v_cvt_pk_bf16_f32 v110, v40, v41
    v_cvt_pk_bf16_f32 v111, v42, v43
    v_mfma_f32_16x16x32_bf16 v[68:71], a[88:91], a[8:11], v[68:71]
    v_exp_f32 v44, v88
    v_mfma_f32_16x16x32_bf16 v[68:71], a[84:87], a[4:7], v[68:71]
    v_exp_f32 v45, v89
    v_mfma_f32_16x16x32_bf16 v[68:71], a[80:83], a[0:3], v[68:71]
    v_exp_f32 v46, v90
    v_mfma_f32_16x16x32_bf16 v[76:79], a[80:83], a[16:19], v[52:55]
    v_exp_f32 v47, v91
    v_mfma_f32_16x16x32_bf16 v[76:79], a[84:87], a[20:23], v[76:79]
    v_cvt_pk_bf16_f32 v108, v44, v45
    v_cvt_pk_bf16_f32 v109, v46, v47
    v_mfma_f32_16x16x32_bf16 v[76:79], a[88:91], a[24:27], v[76:79]
    v_exp_f32 v40, v64
    v_mfma_f32_16x16x32_bf16 v[76:79], a[92:95], a[28:31], v[76:79]
    v_exp_f32 v41, v65
    v_mfma_f32_16x16x32_bf16 v[72:75], a[76:79], a[28:31], v[52:55]
    v_exp_f32 v42, v66
    v_mfma_f32_16x16x32_bf16 v[72:75], a[72:75], a[24:27], v[72:75]
    v_exp_f32 v43, v67
    v_mfma_f32_16x16x32_bf16 v[72:75], a[68:71], a[20:23], v[72:75]
    v_cvt_pk_bf16_f32 v112, v40, v41
    v_cvt_pk_bf16_f32 v113, v42, v43
    v_mfma_f32_16x16x32_bf16 v[72:75], a[64:67], a[16:19], v[72:75]
    v_exp_f32 v44, v68
    v_mfma_f32_16x16x32_bf16 v[80:83], a[64:67], a[32:35], v[56:59]
L_pad3:
    s_cbranch_execz L_pad7
    v_exp_f32 v45, v69
    v_mfma_f32_16x16x32_bf16 v[80:83], a[68:71], a[36:39], v[80:83]
    v_exp_f32 v46, v70
    v_mfma_f32_16x16x32_bf16 v[80:83], a[72:75], a[40:43], v[80:83]
    v_exp_f32 v47, v71
    v_mfma_f32_16x16x32_bf16 v[80:83], a[76:79], a[44:47], v[80:83]
    v_cvt_pk_bf16_f32 v114, v44, v45
    v_cvt_pk_bf16_f32 v115, v46, v47
    v_mfma_f32_16x16x32_bf16 v[84:87], a[92:95], a[44:47], v[56:59]
    v_exp_f32 v40, v76
    v_mfma_f32_16x16x32_bf16 v[84:87], a[88:91], a[40:43], v[84:87]
    v_exp_f32 v41, v77
    v_mfma_f32_16x16x32_bf16 v[84:87], a[84:87], a[36:39], v[84:87]
    v_exp_f32 v42, v78
    v_mfma_f32_16x16x32_bf16 v[84:87], a[80:83], a[32:35], v[84:87]
    v_exp_f32 v43, v79
    v_mfma_f32_16x16x32_bf16 v[92:95], a[80:83], a[48:51], v[60:63]
    v_cvt_pk_bf16_f32 v118, v40, v41
    v_cvt_pk_bf16_f32 v119, v42, v43
    v_mfma_f32_16x16x32_bf16 v[92:95], a[84:87], a[52:55], v[92:95]
    v_exp_f32 v44, v72
    v_mfma_f32_16x16x32_bf16 v[92:95], a[88:91], a[56:59], v[92:95]
    v_exp_f32 v45, v73
    v_mfma_f32_16x16x32_bf16 v[92:95], a[92:95], a[60:63], v[92:95]
    v_exp_f32 v46, v74
    v_mfma_f32_16x16x32_bf16 v[88:91], a[76:79], a[60:63], v[60:63]
    v_exp_f32 v47, v75
    v_mfma_f32_16x16x32_bf16 v[88:91], a[72:75], a[56:59], v[88:91]
    v_cvt_pk_bf16_f32 v116, v44, v45
    v_cvt_pk_bf16_f32 v117, v46, v47
    v_mfma_f32_16x16x32_bf16 v[88:91], a[68:71], a[52:55], v[88:91]
    v_exp_f32 v40, v80
    v_mfma_f32_16x16x32_bf16 v[88:91], a[64:67], a[48:51], v[88:91]
    v_exp_f32 v41, v81
    v_smfmac_f32_16x16x64_bf16 a[132:135], a[136:139], v[104:111], v27
    ds_read_b128 a[92:95], v11 offset:20480
    ds_read_b128 a[88:91], v10 offset:20480
    ds_read_b128 a[84:87], v9 offset:20480
    ds_read_b128 a[80:83], v8 offset:20480
    buffer_load_dwordx4 v20, s[16:19], s32 offen offset:0 lds
    v_exp_f32 v42, v82
    v_exp_f32 v43, v83
    v_smfmac_f32_16x16x64_bf16 a[128:131], a[136:139], v[96:103], v27
    ds_read_b128 a[76:79], v11 offset:16384
    ds_read_b128 a[72:75], v10 offset:16384
    ds_read_b128 a[68:71], v9 offset:16384
    ds_read_b128 a[64:67], v8 offset:16384
    buffer_load_dwordx4 v21, s[16:19], s32 offen offset:1024 lds
    s_nop 0
    v_cvt_pk_bf16_f32 v120, v40, v41
    v_cvt_pk_bf16_f32 v121, v42, v43
    v_exp_f32 v44, v84
    v_exp_f32 v45, v85
    v_exp_f32 v46, v86
    v_exp_f32 v47, v87
    s_nop 0
    v_cvt_pk_bf16_f32 v122, v44, v45
    v_cvt_pk_bf16_f32 v123, v46, v47
    buffer_load_dwordx4 v22, s[16:19], s32 offen offset:2048 lds
    ds_read_b64_tr_b16 a[96:97], v12 offset:0
    ds_read_b64_tr_b16 a[98:99], v12 offset:4096
    ds_read_b64_tr_b16 a[100:101], v12 offset:8192
    ds_read_b64_tr_b16 a[102:103], v12 offset:12288
    v_exp_f32 v40, v92
    v_exp_f32 v41, v93
    v_exp_f32 v42, v94
    v_exp_f32 v43, v95
    s_nop 0
    v_cvt_pk_bf16_f32 v126, v40, v41
    v_cvt_pk_bf16_f32 v127, v42, v43
    buffer_load_dwordx4 v23, s[16:19], s32 offen offset:3072 lds
    ds_read_b64_tr_b16 a[104:105], v13 offset:0
    ds_read_b64_tr_b16 a[106:107], v13 offset:4096
    ds_read_b64_tr_b16 a[108:109], v13 offset:8192
    ds_read_b64_tr_b16 a[110:111], v13 offset:12288
    v_exp_f32 v44, v88
    v_exp_f32 v45, v89
    v_exp_f32 v46, v90
    v_exp_f32 v47, v91
    s_nop 0
    v_cvt_pk_bf16_f32 v124, v44, v45
    v_cvt_pk_bf16_f32 v125, v46, v47
    s_add_u32 s32, s32, 16384
    s_waitcnt lgkmcnt(0)
    v_mfma_f32_16x16x32_bf16 v[64:67], a[64:67], a[0:3], v[48:51]
    ds_read_b64_tr_b16 a[112:113], v14 offset:0
    v_lshrrev_b32 v6, 1, v1
    v_mfma_f32_16x16x32_bf16 v[64:67], a[68:71], a[4:7], v[64:67]
    ds_read_b64_tr_b16 a[114:115], v14 offset:4096
    v_mul_u32_u24 v6, 3584, v6
    v_mfma_f32_16x16x32_bf16 v[64:67], a[72:75], a[8:11], v[64:67]
    ds_read_b64_tr_b16 a[116:117], v14 offset:8192
    v_and_b32 v5, 1, v1
    v_mfma_f32_16x16x32_bf16 v[64:67], a[76:79], a[12:15], v[64:67]
    ds_read_b64_tr_b16 a[118:119], v14 offset:12288
    v_lshl_add_u32 v6, v5, 4, v6
    v_mfma_f32_16x16x32_bf16 v[68:71], a[92:95], a[12:15], v[48:51]
    ds_read_b64_tr_b16 a[120:121], v15 offset:0
    v_add_u32 v6, s70, v6
    v_mfma_f32_16x16x32_bf16 v[68:71], a[88:91], a[8:11], v[68:71]
    ds_read_b64_tr_b16 a[122:123], v15 offset:4096
    v_lshlrev_b32 v5, 6, v0
    v_mfma_f32_16x16x32_bf16 v[68:71], a[84:87], a[4:7], v[68:71]
    ds_read_b64_tr_b16 a[124:125], v15 offset:8192
    s_lshl_b32 s3, s2, 14
    v_mfma_f32_16x16x32_bf16 v[68:71], a[80:83], a[0:3], v[68:71]
    ds_read_b64_tr_b16 a[126:127], v15 offset:12288
    s_add_u32 s42, s62, 8388608
    v_mfma_f32_16x16x32_bf16 v[76:79], a[80:83], a[16:19], v[52:55]
    v_exp_f32 v40, v64
    v_mfma_f32_16x16x32_bf16 v[76:79], a[84:87], a[20:23], v[76:79]
    v_exp_f32 v41, v65
    v_mfma_f32_16x16x32_bf16 v[76:79], a[88:91], a[24:27], v[76:79]
    v_exp_f32 v42, v66
    v_mfma_f32_16x16x32_bf16 v[76:79], a[92:95], a[28:31], v[76:79]
    v_exp_f32 v43, v67
    v_mfma_f32_16x16x32_bf16 v[72:75], a[76:79], a[28:31], v[52:55]
    v_cvt_pk_bf16_f32 v128, v40, v41
    v_cvt_pk_bf16_f32 v129, v42, v43
    v_mfma_f32_16x16x32_bf16 v[72:75], a[72:75], a[24:27], v[72:75]
    v_exp_f32 v44, v68
    v_mfma_f32_16x16x32_bf16 v[72:75], a[68:71], a[20:23], v[72:75]
    v_exp_f32 v45, v69
    v_mfma_f32_16x16x32_bf16 v[72:75], a[64:67], a[16:19], v[72:75]
    v_exp_f32 v46, v70
    v_mfma_f32_16x16x32_bf16 v[80:83], a[64:67], a[32:35], v[56:59]
    v_exp_f32 v47, v71
    v_mfma_f32_16x16x32_bf16 v[80:83], a[68:71], a[36:39], v[80:83]
    v_cvt_pk_bf16_f32 v130, v44, v45
    v_cvt_pk_bf16_f32 v131, v46, v47
    v_mfma_f32_16x16x32_bf16 v[80:83], a[72:75], a[40:43], v[80:83]
    v_exp_f32 v40, v76
    v_mfma_f32_16x16x32_bf16 v[80:83], a[76:79], a[44:47], v[80:83]
    v_exp_f32 v41, v77
    v_mfma_f32_16x16x32_bf16 v[84:87], a[92:95], a[44:47], v[56:59]
    v_exp_f32 v42, v78
    v_mfma_f32_16x16x32_bf16 v[84:87], a[88:91], a[40:43], v[84:87]
    v_exp_f32 v43, v79
    v_mfma_f32_16x16x32_bf16 v[84:87], a[84:87], a[36:39], v[84:87]
    v_cvt_pk_bf16_f32 v134, v40, v41
    v_cvt_pk_bf16_f32 v135, v42, v43
    v_mfma_f32_16x16x32_bf16 v[84:87], a[80:83], a[32:35], v[84:87]
    v_exp_f32 v44, v72
    v_mfma_f32_16x16x32_bf16 v[92:95], a[80:83], a[48:51], v[60:63]
    v_exp_f32 v45, v73
    v_mfma_f32_16x16x32_bf16 v[92:95], a[84:87], a[52:55], v[92:95]
    v_exp_f32 v46, v74
    v_mfma_f32_16x16x32_bf16 v[92:95], a[88:91], a[56:59], v[92:95]
    v_exp_f32 v47, v75
    v_mfma_f32_16x16x32_bf16 v[92:95], a[92:95], a[60:63], v[92:95]
    v_cvt_pk_bf16_f32 v132, v44, v45
    v_cvt_pk_bf16_f32 v133, v46, v47
    v_mfma_f32_16x16x32_bf16 v[88:91], a[76:79], a[60:63], v[60:63]
    v_exp_f32 v40, v80
    v_mfma_f32_16x16x32_bf16 v[88:91], a[72:75], a[56:59], v[88:91]
    v_exp_f32 v41, v81
    v_mfma_f32_16x16x32_bf16 v[88:91], a[68:71], a[52:55], v[88:91]
    v_exp_f32 v42, v82
    v_mfma_f32_16x16x32_bf16 v[88:91], a[64:67], a[48:51], v[88:91]
    s_waitcnt lgkmcnt(0)
    v_exp_f32 v43, v83
    v_smfmac_f32_16x16x64_bf16 a[132:135], a[136:139], v[120:127], v27
    v_cvt_pk_bf16_f32 v136, v40, v41
    v_smfmac_f32_16x16x64_bf16 a[128:131], a[136:139], v[112:119], v27
    buffer_load_dword v26, v5, s[52:55], s3 offen
    v_mfma_f32_16x16x32_bf16 v[160:163], a[96:99], v[96:99], 0
    ds_read_b128 a[64:67], v8 offset:24576
    v_cvt_pk_bf16_f32 v137, v42, v43
    v_mfma_f32_16x16x32_bf16 v[160:163], a[100:103], v[112:115], v[160:163]
    buffer_load_dword v26, off, s[24:27], s42 sc1
    v_mfma_f32_16x16x32_bf16 v[184:187], a[100:103], v[116:119], 0
    s_add_u32 m0, s31, 98304
    v_exp_f32 v44, v84
    v_mfma_f32_16x16x32_bf16 v[184:187], a[96:99], v[100:103], v[184:187]
    buffer_load_dwordx4 v24, s[20:23], s39 offen offset:0 lds
    v_mfma_f32_16x16x32_bf16 v[208:211], a[96:99], v[104:107], 0
    v_exp_f32 v45, v85
    v_mfma_f32_16x16x32_bf16 v[208:211], a[100:103], v[120:123], v[208:211]
    ds_read_b128 a[68:71], v9 offset:24576
    v_cvt_pk_bf16_f32 v138, v44, v45
    v_mfma_f32_16x16x32_bf16 v[232:235], a[100:103], v[124:127], 0
    v_exp_f32 v46, v86
    v_mfma_f32_16x16x32_bf16 v[232:235], a[96:99], v[108:111], v[232:235]
    v_exp_f32 v47, v87
    v_mfma_f32_16x16x32_bf16 v[236:239], a[104:107], v[108:111], 0
    buffer_load_dwordx4 v25, s[20:23], s39 offen offset:1024 lds
    v_mfma_f32_16x16x32_bf16 v[236:239], a[108:111], v[124:127], v[236:239]
    ds_read_b128 a[72:75], v10 offset:24576
    v_cvt_pk_bf16_f32 v139, v46, v47
    v_mfma_f32_16x16x32_bf16 v[212:215], a[108:111], v[120:123], 0
    v_exp_f32 v40, v92
    v_mfma_f32_16x16x32_bf16 v[212:215], a[104:107], v[104:107], v[212:215]
    v_exp_f32 v41, v93
    v_mfma_f32_16x16x32_bf16 v[188:191], a[104:107], v[100:103], 0
    ds_read_b128 a[76:79], v11 offset:24576
    v_cvt_pk_bf16_f32 v142, v40, v41
    v_mfma_f32_16x16x32_bf16 v[188:191], a[108:111], v[116:119], v[188:191]
    buffer_load_dwordx4 v24, s[20:23], s39 offen offset:2048 lds
    v_mfma_f32_16x16x32_bf16 v[164:167], a[108:111], v[112:115], 0
    v_exp_f32 v42, v94
    v_mfma_f32_16x16x32_bf16 v[164:167], a[104:107], v[96:99], v[164:167]
    v_exp_f32 v43, v95
    v_mfma_f32_16x16x32_bf16 v[168:171], a[112:115], v[96:99], 0
    ds_read_b128 a[80:83], v8 offset:28672
    v_cvt_pk_bf16_f32 v143, v42, v43
    v_mfma_f32_16x16x32_bf16 v[168:171], a[116:119], v[112:115], v[168:171]
    v_exp_f32 v44, v88
    v_mfma_f32_16x16x32_bf16 v[192:195], a[116:119], v[116:119], 0
    buffer_load_dwordx4 v25, s[20:23], s39 offen offset:3072 lds
    v_mfma_f32_16x16x32_bf16 v[192:195], a[112:115], v[100:103], v[192:195]
    v_exp_f32 v45, v89
    v_mfma_f32_16x16x32_bf16 v[216:219], a[112:115], v[104:107], 0
    ds_read_b128 a[84:87], v9 offset:28672
    v_cvt_pk_bf16_f32 v140, v44, v45
    v_mfma_f32_16x16x32_bf16 v[216:219], a[116:119], v[120:123], v[216:219]
    v_exp_f32 v46, v90
    v_mfma_f32_16x16x32_bf16 v[240:243], a[116:119], v[124:127], 0
    v_exp_f32 v47, v91
    v_mfma_f32_16x16x32_bf16 v[240:243], a[112:115], v[108:111], v[240:243]
    ds_read_b128 a[88:91], v10 offset:28672
    v_cvt_pk_bf16_f32 v141, v46, v47
    v_mfma_f32_16x16x32_bf16 v[244:247], a[120:123], v[108:111], 0
    s_add_u32 s39, s39, 16384
    ds_read_b128 a[92:95], v11 offset:28672
    v_mfma_f32_16x16x32_bf16 v[244:247], a[124:127], v[124:127], v[244:247]
    ds_read_b64_tr_b16 a[96:97], v16 offset:0
    ds_read_b64_tr_b16 a[98:99], v16 offset:4096
    v_mfma_f32_16x16x32_bf16 v[220:223], a[124:127], v[120:123], 0
    ds_read_b64_tr_b16 a[100:101], v16 offset:8192
    ds_read_b64_tr_b16 a[102:103], v16 offset:12288
    v_mfma_f32_16x16x32_bf16 v[220:223], a[120:123], v[104:107], v[220:223]
    ds_read_b64_tr_b16 a[104:105], v17 offset:0
    ds_read_b64_tr_b16 a[106:107], v17 offset:4096
    v_mfma_f32_16x16x32_bf16 v[196:199], a[120:123], v[100:103], 0
    ds_read_b64_tr_b16 a[108:109], v17 offset:8192
    v_mfma_f32_16x16x32_bf16 v[196:199], a[124:127], v[116:119], v[196:199]
    ds_read_b64_tr_b16 a[110:111], v17 offset:12288
    v_mfma_f32_16x16x32_bf16 v[172:175], a[124:127], v[112:115], 0
    v_mfma_f32_16x16x32_bf16 v[172:175], a[120:123], v[96:99], v[172:175]
    s_waitcnt lgkmcnt(8)
    v_mfma_f32_16x16x32_bf16 v[64:67], a[64:67], a[0:3], v[48:51]
    ds_read_b64_tr_b16 a[112:113], v18 offset:0
    v_and_b32 v34, 7, v1
    v_mfma_f32_16x16x32_bf16 v[64:67], a[68:71], a[4:7], v[64:67]
    ds_read_b64_tr_b16 a[114:115], v18 offset:4096
    v_lshlrev_b32 v34, 2, v34
    v_mfma_f32_16x16x32_bf16 v[64:67], a[72:75], a[8:11], v[64:67]
    ds_read_b64_tr_b16 a[116:117], v18 offset:8192
    v_mfma_f32_16x16x32_bf16 v[64:67], a[76:79], a[12:15], v[64:67]
    ds_read_b64_tr_b16 a[118:119], v18 offset:12288
    v_mfma_f32_16x16x32_bf16 v[68:71], a[92:95], a[12:15], v[48:51]
    ds_read_b64_tr_b16 a[120:121], v19 offset:0
    v_mfma_f32_16x16x32_bf16 v[68:71], a[88:91], a[8:11], v[68:71]
    ds_read_b64_tr_b16 a[122:123], v19 offset:4096
    v_mfma_f32_16x16x32_bf16 v[68:71], a[84:87], a[4:7], v[68:71]
    ds_read_b64_tr_b16 a[124:125], v19 offset:8192
    v_mfma_f32_16x16x32_bf16 v[68:71], a[80:83], a[0:3], v[68:71]
    ds_read_b64_tr_b16 a[126:127], v19 offset:12288
    v_mfma_f32_16x16x32_bf16 v[76:79], a[80:83], a[16:19], v[52:55]
    v_exp_f32 v40, v64
    v_mfma_f32_16x16x32_bf16 v[76:79], a[84:87], a[20:23], v[76:79]
    v_exp_f32 v41, v65
    v_mfma_f32_16x16x32_bf16 v[76:79], a[88:91], a[24:27], v[76:79]
    s_add_u32 m0, s31, 131072
    v_exp_f32 v42, v66
    v_mfma_f32_16x16x32_bf16 v[76:79], a[92:95], a[28:31], v[76:79]
    buffer_load_dwordx4 v6, s[48:51], s91 offen lds
    v_mfma_f32_16x16x32_bf16 v[72:75], a[76:79], a[28:31], v[52:55]
    v_exp_f32 v43, v67
    v_mfma_f32_16x16x32_bf16 v[72:75], a[72:75], a[24:27], v[72:75]
    v_cvt_pk_bf16_f32 v144, v40, v41
    v_cvt_pk_bf16_f32 v145, v42, v43
    v_mfma_f32_16x16x32_bf16 v[72:75], a[68:71], a[20:23], v[72:75]
    v_exp_f32 v44, v68
    v_mfma_f32_16x16x32_bf16 v[72:75], a[64:67], a[16:19], v[72:75]
    v_exp_f32 v45, v69
    v_mfma_f32_16x16x32_bf16 v[80:83], a[64:67], a[32:35], v[56:59]
    v_exp_f32 v46, v70
    v_mfma_f32_16x16x32_bf16 v[80:83], a[68:71], a[36:39], v[80:83]
    v_exp_f32 v47, v71
    v_mfma_f32_16x16x32_bf16 v[80:83], a[72:75], a[40:43], v[80:83]
    s_add_u32 m0, s31, 147456
    v_cvt_pk_bf16_f32 v146, v44, v45
    v_cvt_pk_bf16_f32 v147, v46, v47
    v_mfma_f32_16x16x32_bf16 v[80:83], a[76:79], a[44:47], v[80:83]
    buffer_load_dwordx4 v6, s[12:15], s91 offen lds
    v_mfma_f32_16x16x32_bf16 v[84:87], a[92:95], a[44:47], v[56:59]
    v_exp_f32 v40, v76
    v_mfma_f32_16x16x32_bf16 v[84:87], a[88:91], a[40:43], v[84:87]
    v_exp_f32 v41, v77
    v_mfma_f32_16x16x32_bf16 v[84:87], a[84:87], a[36:39], v[84:87]
    v_exp_f32 v42, v78
    v_mfma_f32_16x16x32_bf16 v[84:87], a[80:83], a[32:35], v[84:87]
    v_exp_f32 v43, v79
    v_mfma_f32_16x16x32_bf16 v[92:95], a[80:83], a[48:51], v[60:63]
    v_cvt_pk_bf16_f32 v150, v40, v41
    v_cvt_pk_bf16_f32 v151, v42, v43
    v_mfma_f32_16x16x32_bf16 v[92:95], a[84:87], a[52:55], v[92:95]
    v_exp_f32 v44, v72
    v_mfma_f32_16x16x32_bf16 v[92:95], a[88:91], a[56:59], v[92:95]
    v_exp_f32 v45, v73
    v_mfma_f32_16x16x32_bf16 v[92:95], a[92:95], a[60:63], v[92:95]
    v_exp_f32 v46, v74
    v_mfma_f32_16x16x32_bf16 v[88:91], a[76:79], a[60:63], v[60:63]
    v_exp_f32 v47, v75
    v_mfma_f32_16x16x32_bf16 v[88:91], a[72:75], a[56:59], v[88:91]
    v_cvt_pk_bf16_f32 v148, v44, v45
    v_cvt_pk_bf16_f32 v149, v46, v47
    v_mfma_f32_16x16x32_bf16 v[88:91], a[68:71], a[52:55], v[88:91]
    v_exp_f32 v40, v80
    v_mfma_f32_16x16x32_bf16 v[88:91], a[64:67], a[48:51], v[88:91]
    s_waitcnt vmcnt(13) lgkmcnt(0)
    v_exp_f32 v41, v81
    v_smfmac_f32_16x16x64_bf16 a[132:135], a[136:139], v[136:143], v27
    s_barrier
    v_smfmac_f32_16x16x64_bf16 a[128:131], a[136:139], v[128:135], v27
    ds_read_b128 a[64:67], v8 offset:32768
    v_cvt_pk_bf16_f32 v152, v40, v41
    v_mfma_f32_16x16x32_bf16 v[176:179], a[96:99], v[96:99], 0
    v_exp_f32 v42, v82
    v_mfma_f32_16x16x32_bf16 v[176:179], a[100:103], v[112:115], v[176:179]
    s_add_u32 m0, s31, 0
    v_exp_f32 v43, v83
    v_mfma_f32_16x16x32_bf16 v[200:203], a[100:103], v[116:119], 0
    ds_read_b128 a[68:71], v9 offset:32768
    v_cvt_pk_bf16_f32 v153, v42, v43
    v_mfma_f32_16x16x32_bf16 v[200:203], a[96:99], v[100:103], v[200:203]
    buffer_load_dwordx4 v20, s[16:19], s32 offen offset:0 lds
    v_mfma_f32_16x16x32_bf16 v[224:227], a[96:99], v[104:107], 0
    v_exp_f32 v44, v84
    v_mfma_f32_16x16x32_bf16 v[224:227], a[100:103], v[120:123], v[224:227]
    v_exp_f32 v45, v85
    v_mfma_f32_16x16x32_bf16 v[248:251], a[100:103], v[124:127], 0
    ds_read_b128 a[72:75], v10 offset:32768
    v_cvt_pk_bf16_f32 v154, v44, v45
    v_mfma_f32_16x16x32_bf16 v[248:251], a[96:99], v[108:111], v[248:251]
    v_exp_f32 v46, v86
    v_mfma_f32_16x16x32_bf16 v[252:255], a[104:107], v[108:111], 0
    buffer_load_dwordx4 v21, s[16:19], s32 offen offset:1024 lds
    v_mfma_f32_16x16x32_bf16 v[252:255], a[108:111], v[124:127], v[252:255]
    v_exp_f32 v47, v87
    v_mfma_f32_16x16x32_bf16 v[228:231], a[108:111], v[120:123], 0
    ds_read_b128 a[76:79], v11 offset:32768
    v_cvt_pk_bf16_f32 v155, v46, v47
    v_mfma_f32_16x16x32_bf16 v[228:231], a[104:107], v[104:107], v[228:231]
    v_exp_f32 v40, v92
    v_mfma_f32_16x16x32_bf16 v[204:207], a[104:107], v[100:103], 0
    v_exp_f32 v41, v93
    v_mfma_f32_16x16x32_bf16 v[204:207], a[108:111], v[116:119], v[204:207]
    buffer_load_dwordx4 v22, s[16:19], s32 offen offset:2048 lds
    v_mfma_f32_16x16x32_bf16 v[180:183], a[108:111], v[112:115], 0
    ds_read_b128 a[80:83], v8 offset:36864
    v_cvt_pk_bf16_f32 v158, v40, v41
    v_mfma_f32_16x16x32_bf16 v[180:183], a[104:107], v[96:99], v[180:183]
    v_exp_f32 v42, v94
    v_mfma_f32_16x16x32_bf16 a[224:227], a[112:115], v[96:99], 0
    v_exp_f32 v43, v95
    v_mfma_f32_16x16x32_bf16 a[224:227], a[116:119], v[112:115], a[224:227]
    ds_read_b128 a[84:87], v9 offset:36864
    v_cvt_pk_bf16_f32 v159, v42, v43
    v_mfma_f32_16x16x32_bf16 a[232:235], a[116:119], v[116:119], 0
    buffer_load_dwordx4 v23, s[16:19], s32 offen offset:3072 lds
    v_mfma_f32_16x16x32_bf16 a[232:235], a[112:115], v[100:103], a[232:235]
    v_exp_f32 v44, v88
    v_mfma_f32_16x16x32_bf16 a[240:243], a[112:115], v[104:107], 0
    v_exp_f32 v45, v89
    v_mfma_f32_16x16x32_bf16 a[240:243], a[116:119], v[120:123], a[240:243]
    ds_read_b128 a[88:91], v10 offset:36864
    v_cvt_pk_bf16_f32 v156, v44, v45
    v_mfma_f32_16x16x32_bf16 a[248:251], a[116:119], v[124:127], 0
    v_exp_f32 v46, v90
    v_mfma_f32_16x16x32_bf16 a[248:251], a[112:115], v[108:111], a[248:251]
    s_add_u32 s32, s32, 16384
    v_exp_f32 v47, v91
    v_mfma_f32_16x16x32_bf16 a[252:255], a[120:123], v[108:111], 0
    ds_read_b128 a[92:95], v11 offset:36864
    v_cvt_pk_bf16_f32 v157, v46, v47
    v_mfma_f32_16x16x32_bf16 a[252:255], a[124:127], v[124:127], a[252:255]
    ds_read_b64_tr_b16 a[96:97], v12 offset:16384
    ds_read_b64_tr_b16 a[98:99], v12 offset:20480
    v_mfma_f32_16x16x32_bf16 a[244:247], a[124:127], v[120:123], 0
    ds_read_b64_tr_b16 a[100:101], v12 offset:24576
    ds_read_b64_tr_b16 a[102:103], v12 offset:28672
    v_mfma_f32_16x16x32_bf16 a[244:247], a[120:123], v[104:107], a[244:247]
    ds_read_b64_tr_b16 a[104:105], v13 offset:16384
    ds_read_b64_tr_b16 a[106:107], v13 offset:20480
    v_mfma_f32_16x16x32_bf16 a[236:239], a[120:123], v[100:103], 0
    ds_read_b64_tr_b16 a[108:109], v13 offset:24576
    v_mfma_f32_16x16x32_bf16 a[236:239], a[124:127], v[116:119], a[236:239]
    ds_read_b64_tr_b16 a[110:111], v13 offset:28672
    v_mfma_f32_16x16x32_bf16 a[228:231], a[124:127], v[112:115], 0
    v_mfma_f32_16x16x32_bf16 a[228:231], a[120:123], v[96:99], a[228:231]
    s_waitcnt lgkmcnt(8)
    v_mfma_f32_16x16x32_bf16 v[64:67], a[64:67], a[0:3], v[48:51]
    ds_read_b64_tr_b16 a[112:113], v14 offset:16384
    v_mfma_f32_16x16x32_bf16 v[64:67], a[68:71], a[4:7], v[64:67]
    ds_read_b64_tr_b16 a[114:115], v14 offset:20480
    v_mfma_f32_16x16x32_bf16 v[64:67], a[72:75], a[8:11], v[64:67]
    ds_read_b64_tr_b16 a[116:117], v14 offset:24576
    v_mfma_f32_16x16x32_bf16 v[64:67], a[76:79], a[12:15], v[64:67]
    ds_read_b64_tr_b16 a[118:119], v14 offset:28672
    v_mfma_f32_16x16x32_bf16 v[68:71], a[92:95], a[12:15], v[48:51]
    ds_read_b64_tr_b16 a[120:121], v15 offset:16384
    v_mfma_f32_16x16x32_bf16 v[68:71], a[88:91], a[8:11], v[68:71]
    ds_read_b64_tr_b16 a[122:123], v15 offset:20480
    v_mfma_f32_16x16x32_bf16 v[68:71], a[84:87], a[4:7], v[68:71]
    ds_read_b64_tr_b16 a[124:125], v15 offset:24576
    v_mfma_f32_16x16x32_bf16 v[68:71], a[80:83], a[0:3], v[68:71]
    ds_read_b64_tr_b16 a[126:127], v15 offset:28672
    v_mfma_f32_16x16x32_bf16 v[76:79], a[80:83], a[16:19], v[52:55]
    v_exp_f32 v40, v64
    v_mfma_f32_16x16x32_bf16 v[76:79], a[84:87], a[20:23], v[76:79]
    s_add_u32 s91, s91, 114688
    v_exp_f32 v41, v65
    v_mfma_f32_16x16x32_bf16 v[76:79], a[88:91], a[24:27], v[76:79]
    s_add_u32 m0, s31, 132096
    v_exp_f32 v42, v66
    v_mfma_f32_16x16x32_bf16 v[76:79], a[92:95], a[28:31], v[76:79]
    buffer_load_dwordx4 v6, s[48:51], s91 offen lds
    v_mfma_f32_16x16x32_bf16 v[72:75], a[76:79], a[28:31], v[52:55]
    v_exp_f32 v43, v67
    v_mfma_f32_16x16x32_bf16 v[72:75], a[72:75], a[24:27], v[72:75]
    v_cvt_pk_bf16_f32 v96, v40, v41
    v_cvt_pk_bf16_f32 v97, v42, v43
    v_mfma_f32_16x16x32_bf16 v[72:75], a[68:71], a[20:23], v[72:75]
    v_exp_f32 v44, v68
    v_mfma_f32_16x16x32_bf16 v[72:75], a[64:67], a[16:19], v[72:75]
    v_exp_f32 v45, v69
    v_mfma_f32_16x16x32_bf16 v[80:83], a[64:67], a[32:35], v[56:59]
    v_exp_f32 v46, v70
    v_mfma_f32_16x16x32_bf16 v[80:83], a[68:71], a[36:39], v[80:83]
    v_exp_f32 v47, v71
    v_mfma_f32_16x16x32_bf16 v[80:83], a[72:75], a[40:43], v[80:83]
    s_add_u32 m0, s31, 148480
    v_cvt_pk_bf16_f32 v98, v44, v45
    v_cvt_pk_bf16_f32 v99, v46, v47
    v_mfma_f32_16x16x32_bf16 v[80:83], a[76:79], a[44:47], v[80:83]
    buffer_load_dwordx4 v6, s[12:15], s91 offen lds
    v_mfma_f32_16x16x32_bf16 v[84:87], a[92:95], a[44:47], v[56:59]
    v_exp_f32 v40, v76
    v_mfma_f32_16x16x32_bf16 v[84:87], a[88:91], a[40:43], v[84:87]
    v_exp_f32 v41, v77
    v_mfma_f32_16x16x32_bf16 v[84:87], a[84:87], a[36:39], v[84:87]
    v_exp_f32 v42, v78
    v_mfma_f32_16x16x32_bf16 v[84:87], a[80:83], a[32:35], v[84:87]
    v_exp_f32 v43, v79
    v_mfma_f32_16x16x32_bf16 v[92:95], a[80:83], a[48:51], v[60:63]
    v_cvt_pk_bf16_f32 v102, v40, v41
    v_cvt_pk_bf16_f32 v103, v42, v43
    v_mfma_f32_16x16x32_bf16 v[92:95], a[84:87], a[52:55], v[92:95]
    v_exp_f32 v44, v72
    v_mfma_f32_16x16x32_bf16 v[92:95], a[88:91], a[56:59], v[92:95]
    v_exp_f32 v45, v73
    v_mfma_f32_16x16x32_bf16 v[92:95], a[92:95], a[60:63], v[92:95]
    v_exp_f32 v46, v74
    v_mfma_f32_16x16x32_bf16 v[88:91], a[76:79], a[60:63], v[60:63]
    v_exp_f32 v47, v75
    v_mfma_f32_16x16x32_bf16 v[88:91], a[72:75], a[56:59], v[88:91]
    v_cvt_pk_bf16_f32 v100, v44, v45
    v_cvt_pk_bf16_f32 v101, v46, v47
    v_mfma_f32_16x16x32_bf16 v[88:91], a[68:71], a[52:55], v[88:91]
    v_exp_f32 v40, v80
    v_mfma_f32_16x16x32_bf16 v[88:91], a[64:67], a[48:51], v[88:91]
    s_waitcnt lgkmcnt(0)
    v_exp_f32 v41, v81
    v_smfmac_f32_16x16x64_bf16 a[132:135], a[136:139], v[152:159], v27
    v_cvt_pk_bf16_f32 v104, v40, v41
    v_smfmac_f32_16x16x64_bf16 a[128:131], a[136:139], v[144:151], v27
    ds_read_b128 a[64:67], v8 offset:40960
    v_mfma_f32_16x16x32_bf16 v[160:163], a[96:99], v[128:131], v[160:163]
    v_exp_f32 v42, v82
    v_mfma_f32_16x16x32_bf16 v[160:163], a[100:103], v[144:147], v[160:163]
    s_add_u32 m0, s31, 114688
    v_exp_f32 v43, v83
    v_mfma_f32_16x16x32_bf16 v[184:187], a[100:103], v[148:151], v[184:187]
    ds_read_b128 a[68:71], v9 offset:40960
    v_cvt_pk_bf16_f32 v105, v42, v43
    v_mfma_f32_16x16x32_bf16 v[184:187], a[96:99], v[132:135], v[184:187]
    buffer_load_dwordx4 v24, s[20:23], s39 offen offset:0 lds
    v_mfma_f32_16x16x32_bf16 v[208:211], a[96:99], v[136:139], v[208:211]
    v_exp_f32 v44, v84
    v_mfma_f32_16x16x32_bf16 v[208:211], a[100:103], v[152:155], v[208:211]
    v_exp_f32 v45, v85
    v_mfma_f32_16x16x32_bf16 v[232:235], a[100:103], v[156:159], v[232:235]
    ds_read_b128 a[72:75], v10 offset:40960
    v_cvt_pk_bf16_f32 v106, v44, v45
    v_mfma_f32_16x16x32_bf16 v[232:235], a[96:99], v[140:143], v[232:235]
    v_exp_f32 v46, v86
    v_mfma_f32_16x16x32_bf16 v[236:239], a[104:107], v[140:143], v[236:239]
    buffer_load_dwordx4 v25, s[20:23], s39 offen offset:1024 lds
    v_mfma_f32_16x16x32_bf16 v[236:239], a[108:111], v[156:159], v[236:239]
    v_exp_f32 v47, v87
    v_mfma_f32_16x16x32_bf16 v[212:215], a[108:111], v[152:155], v[212:215]
    ds_read_b128 a[76:79], v11 offset:40960
    v_cvt_pk_bf16_f32 v107, v46, v47
    v_mfma_f32_16x16x32_bf16 v[212:215], a[104:107], v[136:139], v[212:215]
    v_exp_f32 v40, v92
    v_mfma_f32_16x16x32_bf16 v[188:191], a[104:107], v[132:135], v[188:191]
    v_exp_f32 v41, v93
    v_mfma_f32_16x16x32_bf16 v[188:191], a[108:111], v[148:151], v[188:191]
    buffer_load_dwordx4 v24, s[20:23], s39 offen offset:2048 lds
    v_mfma_f32_16x16x32_bf16 v[164:167], a[108:111], v[144:147], v[164:167]
    ds_read_b128 a[80:83], v8 offset:45056
    v_cvt_pk_bf16_f32 v110, v40, v41
    v_mfma_f32_16x16x32_bf16 v[164:167], a[104:107], v[128:131], v[164:167]
    v_exp_f32 v42, v94
    v_mfma_f32_16x16x32_bf16 v[168:171], a[112:115], v[128:131], v[168:171]
    v_exp_f32 v43, v95
    v_mfma_f32_16x16x32_bf16 v[168:171], a[116:119], v[144:147], v[168:171]
    ds_read_b128 a[84:87], v9 offset:45056
    v_cvt_pk_bf16_f32 v111, v42, v43
    v_mfma_f32_16x16x32_bf16 v[192:195], a[116:119], v[148:151], v[192:195]
    buffer_load_dwordx4 v25, s[20:23], s39 offen offset:3072 lds
    v_mfma_f32_16x16x32_bf16 v[192:195], a[112:115], v[132:135], v[192:195]
    v_exp_f32 v44, v88
    v_mfma_f32_16x16x32_bf16 v[216:219], a[112:115], v[136:139], v[216:219]
    v_exp_f32 v45, v89
    v_mfma_f32_16x16x32_bf16 v[216:219], a[116:119], v[152:155], v[216:219]
    ds_read_b128 a[88:91], v10 offset:45056
    v_cvt_pk_bf16_f32 v108, v44, v45
    v_mfma_f32_16x16x32_bf16 v[240:243], a[116:119], v[156:159], v[240:243]
    v_exp_f32 v46, v90
    v_mfma_f32_16x16x32_bf16 v[240:243], a[112:115], v[140:143], v[240:243]
    s_add_u32 s39, s39, 16384
    v_exp_f32 v47, v91
    v_mfma_f32_16x16x32_bf16 v[244:247], a[120:123], v[140:143], v[244:247]
    ds_read_b128 a[92:95], v11 offset:45056
    v_cvt_pk_bf16_f32 v109, v46, v47
    v_mfma_f32_16x16x32_bf16 v[244:247], a[124:127], v[156:159], v[244:247]
    ds_read_b64_tr_b16 a[96:97], v16 offset:16384
    ds_read_b64_tr_b16 a[98:99], v16 offset:20480
    v_mfma_f32_16x16x32_bf16 v[220:223], a[124:127], v[152:155], v[220:223]
    ds_read_b64_tr_b16 a[100:101], v16 offset:24576
    ds_read_b64_tr_b16 a[102:103], v16 offset:28672
    v_mfma_f32_16x16x32_bf16 v[220:223], a[120:123], v[136:139], v[220:223]
    ds_read_b64_tr_b16 a[104:105], v17 offset:16384
    ds_read_b64_tr_b16 a[106:107], v17 offset:20480
    v_mfma_f32_16x16x32_bf16 v[196:199], a[120:123], v[132:135], v[196:199]
    ds_read_b64_tr_b16 a[108:109], v17 offset:24576
    v_mfma_f32_16x16x32_bf16 v[196:199], a[124:127], v[148:151], v[196:199]
    ds_read_b64_tr_b16 a[110:111], v17 offset:28672
    v_mfma_f32_16x16x32_bf16 v[172:175], a[124:127], v[144:147], v[172:175]
    v_mfma_f32_16x16x32_bf16 v[172:175], a[120:123], v[128:131], v[172:175]
    s_waitcnt lgkmcnt(8)
    v_mfma_f32_16x16x32_bf16 v[64:67], a[64:67], a[0:3], v[48:51]
    ds_read_b64_tr_b16 a[112:113], v18 offset:16384
    v_mfma_f32_16x16x32_bf16 v[64:67], a[68:71], a[4:7], v[64:67]
    ds_read_b64_tr_b16 a[114:115], v18 offset:20480
    v_mfma_f32_16x16x32_bf16 v[64:67], a[72:75], a[8:11], v[64:67]
    ds_read_b64_tr_b16 a[116:117], v18 offset:24576
    v_mfma_f32_16x16x32_bf16 v[64:67], a[76:79], a[12:15], v[64:67]
    ds_read_b64_tr_b16 a[118:119], v18 offset:28672
    v_mfma_f32_16x16x32_bf16 v[68:71], a[92:95], a[12:15], v[48:51]
    ds_read_b64_tr_b16 a[120:121], v19 offset:16384
    v_mfma_f32_16x16x32_bf16 v[68:71], a[88:91], a[8:11], v[68:71]
    ds_read_b64_tr_b16 a[122:123], v19 offset:20480
    v_mfma_f32_16x16x32_bf16 v[68:71], a[84:87], a[4:7], v[68:71]
    ds_read_b64_tr_b16 a[124:125], v19 offset:24576
    v_mfma_f32_16x16x32_bf16 v[68:71], a[80:83], a[0:3], v[68:71]
    ds_read_b64_tr_b16 a[126:127], v19 offset:28672
    v_mfma_f32_16x16x32_bf16 v[76:79], a[80:83], a[16:19], v[52:55]
    v_exp_f32 v40, v64
    v_mfma_f32_16x16x32_bf16 v[76:79], a[84:87], a[20:23], v[76:79]
    v_exp_f32 v41, v65
    v_mfma_f32_16x16x32_bf16 v[76:79], a[88:91], a[24:27], v[76:79]
    v_exp_f32 v42, v66
    v_mfma_f32_16x16x32_bf16 v[76:79], a[92:95], a[28:31], v[76:79]
    v_exp_f32 v43, v67
    v_mfma_f32_16x16x32_bf16 v[72:75], a[76:79], a[28:31], v[52:55]
    v_cvt_pk_bf16_f32 v112, v40, v41
    v_cvt_pk_bf16_f32 v113, v42, v43
    v_mfma_f32_16x16x32_bf16 v[72:75], a[72:75], a[24:27], v[72:75]
    v_exp_f32 v44, v68
    v_mfma_f32_16x16x32_bf16 v[72:75], a[68:71], a[20:23], v[72:75]
    v_exp_f32 v45, v69
    v_mfma_f32_16x16x32_bf16 v[72:75], a[64:67], a[16:19], v[72:75]
    v_exp_f32 v46, v70
    v_mfma_f32_16x16x32_bf16 v[80:83], a[64:67], a[32:35], v[56:59]
    v_exp_f32 v47, v71
    v_mfma_f32_16x16x32_bf16 v[80:83], a[68:71], a[36:39], v[80:83]
    v_cvt_pk_bf16_f32 v114, v44, v45
    v_cvt_pk_bf16_f32 v115, v46, v47
    v_mfma_f32_16x16x32_bf16 v[80:83], a[72:75], a[40:43], v[80:83]
    v_exp_f32 v40, v76
    v_mfma_f32_16x16x32_bf16 v[80:83], a[76:79], a[44:47], v[80:83]
    v_exp_f32 v41, v77
    v_mfma_f32_16x16x32_bf16 v[84:87], a[92:95], a[44:47], v[56:59]
    v_exp_f32 v42, v78
    v_mfma_f32_16x16x32_bf16 v[84:87], a[88:91], a[40:43], v[84:87]
L_pad4:
    s_cbranch_execz L_pad8
    v_exp_f32 v43, v79
    v_mfma_f32_16x16x32_bf16 v[84:87], a[84:87], a[36:39], v[84:87]
    v_cvt_pk_bf16_f32 v118, v40, v41
    v_cvt_pk_bf16_f32 v119, v42, v43
    v_mfma_f32_16x16x32_bf16 v[84:87], a[80:83], a[32:35], v[84:87]
    v_exp_f32 v44, v72
    v_mfma_f32_16x16x32_bf16 v[92:95], a[80:83], a[48:51], v[60:63]
    v_exp_f32 v45, v73
    v_mfma_f32_16x16x32_bf16 v[92:95], a[84:87], a[52:55], v[92:95]
    v_exp_f32 v46, v74
    v_mfma_f32_16x16x32_bf16 v[92:95], a[88:91], a[56:59], v[92:95]
    v_exp_f32 v47, v75
    v_mfma_f32_16x16x32_bf16 v[92:95], a[92:95], a[60:63], v[92:95]
    v_cvt_pk_bf16_f32 v116, v44, v45
    v_cvt_pk_bf16_f32 v117, v46, v47
    v_mfma_f32_16x16x32_bf16 v[88:91], a[76:79], a[60:63], v[60:63]
    v_exp_f32 v40, v80
    v_mfma_f32_16x16x32_bf16 v[88:91], a[72:75], a[56:59], v[88:91]
    v_exp_f32 v41, v81
    v_mfma_f32_16x16x32_bf16 v[88:91], a[68:71], a[52:55], v[88:91]
    v_exp_f32 v42, v82
    v_mfma_f32_16x16x32_bf16 v[88:91], a[64:67], a[48:51], v[88:91]
    s_waitcnt vmcnt(12) lgkmcnt(0)
    v_exp_f32 v43, v83
    v_smfmac_f32_16x16x64_bf16 a[132:135], a[136:139], v[104:111], v27
    s_barrier
    v_smfmac_f32_16x16x64_bf16 a[128:131], a[136:139], v[96:103], v27
    ds_read_b128 a[64:67], v8 offset:49152
    v_cvt_pk_bf16_f32 v120, v40, v41
    v_mfma_f32_16x16x32_bf16 v[176:179], a[96:99], v[128:131], v[176:179]
    ds_read_b128 a[68:71], v9 offset:49152
    v_cvt_pk_bf16_f32 v121, v42, v43
    v_mfma_f32_16x16x32_bf16 v[176:179], a[100:103], v[144:147], v[176:179]
    v_exp_f32 v44, v84
    v_mfma_f32_16x16x32_bf16 v[200:203], a[100:103], v[148:151], v[200:203]
    s_add_u32 m0, s31, 16384
    v_exp_f32 v45, v85
    v_mfma_f32_16x16x32_bf16 v[200:203], a[96:99], v[132:135], v[200:203]
    buffer_load_dwordx4 v20, s[16:19], s32 offen offset:0 lds
    v_mfma_f32_16x16x32_bf16 v[224:227], a[96:99], v[136:139], v[224:227]
    ds_read_b128 a[72:75], v10 offset:49152
    v_cvt_pk_bf16_f32 v122, v44, v45
    v_mfma_f32_16x16x32_bf16 v[224:227], a[100:103], v[152:155], v[224:227]
    v_exp_f32 v46, v86
    v_mfma_f32_16x16x32_bf16 v[248:251], a[100:103], v[156:159], v[248:251]
    v_exp_f32 v47, v87
    v_mfma_f32_16x16x32_bf16 v[248:251], a[96:99], v[140:143], v[248:251]
    ds_read_b128 a[76:79], v11 offset:49152
    v_cvt_pk_bf16_f32 v123, v46, v47
    v_mfma_f32_16x16x32_bf16 v[252:255], a[104:107], v[140:143], v[252:255]
    buffer_load_dwordx4 v21, s[16:19], s32 offen offset:1024 lds
    v_mfma_f32_16x16x32_bf16 v[252:255], a[108:111], v[156:159], v[252:255]
    v_exp_f32 v40, v92
    v_mfma_f32_16x16x32_bf16 v[228:231], a[108:111], v[152:155], v[228:231]
    v_exp_f32 v41, v93
    v_mfma_f32_16x16x32_bf16 v[228:231], a[104:107], v[136:139], v[228:231]
    ds_read_b128 a[80:83], v8 offset:53248
    v_cvt_pk_bf16_f32 v126, v40, v41
    v_mfma_f32_16x16x32_bf16 v[204:207], a[104:107], v[132:135], v[204:207]
    v_exp_f32 v42, v94
    v_mfma_f32_16x16x32_bf16 v[204:207], a[108:111], v[148:151], v[204:207]
    buffer_load_dwordx4 v22, s[16:19], s32 offen offset:2048 lds
    v_mfma_f32_16x16x32_bf16 v[180:183], a[108:111], v[144:147], v[180:183]
    v_exp_f32 v43, v95
    v_mfma_f32_16x16x32_bf16 v[180:183], a[104:107], v[128:131], v[180:183]
    ds_read_b128 a[84:87], v9 offset:53248
    v_cvt_pk_bf16_f32 v127, v42, v43
    v_mfma_f32_16x16x32_bf16 a[224:227], a[112:115], v[128:131], a[224:227]
    v_exp_f32 v44, v88
    v_mfma_f32_16x16x32_bf16 a[224:227], a[116:119], v[144:147], a[224:227]
    v_exp_f32 v45, v89
    v_mfma_f32_16x16x32_bf16 a[232:235], a[116:119], v[148:151], a[232:235]
    buffer_load_dwordx4 v23, s[16:19], s32 offen offset:3072 lds
    v_mfma_f32_16x16x32_bf16 a[232:235], a[112:115], v[132:135], a[232:235]
    ds_read_b128 a[88:91], v10 offset:53248
    v_cvt_pk_bf16_f32 v124, v44, v45
    v_mfma_f32_16x16x32_bf16 a[240:243], a[112:115], v[136:139], a[240:243]
    v_exp_f32 v46, v90
    v_mfma_f32_16x16x32_bf16 a[240:243], a[116:119], v[152:155], a[240:243]
    v_exp_f32 v47, v91
    v_mfma_f32_16x16x32_bf16 a[248:251], a[116:119], v[156:159], a[248:251]
    ds_read_b128 a[92:95], v11 offset:53248
    v_cvt_pk_bf16_f32 v125, v46, v47
    v_mfma_f32_16x16x32_bf16 a[248:251], a[112:115], v[140:143], a[248:251]
    ds_read_b64_tr_b16 a[96:97], v12 offset:32768
    ds_read_b64_tr_b16 a[98:99], v12 offset:36864
    v_mfma_f32_16x16x32_bf16 a[252:255], a[120:123], v[140:143], a[252:255]
    ds_read_b64_tr_b16 a[100:101], v12 offset:40960
    v_mfma_f32_16x16x32_bf16 a[252:255], a[124:127], v[156:159], a[252:255]
    ds_read_b64_tr_b16 a[102:103], v12 offset:45056
    v_mfma_f32_16x16x32_bf16 a[244:247], a[124:127], v[152:155], a[244:247]
    s_add_u32 s32, s32, 16384
    ds_read_b64_tr_b16 a[104:105], v13 offset:32768
    v_mfma_f32_16x16x32_bf16 a[244:247], a[120:123], v[136:139], a[244:247]
    ds_read_b64_tr_b16 a[106:107], v13 offset:36864
    v_mfma_f32_16x16x32_bf16 a[236:239], a[120:123], v[132:135], a[236:239]
    ds_read_b64_tr_b16 a[108:109], v13 offset:40960
    v_mfma_f32_16x16x32_bf16 a[236:239], a[124:127], v[148:151], a[236:239]
    ds_read_b64_tr_b16 a[110:111], v13 offset:45056
    v_mfma_f32_16x16x32_bf16 a[228:231], a[124:127], v[144:147], a[228:231]
    v_mfma_f32_16x16x32_bf16 a[228:231], a[120:123], v[128:131], a[228:231]
    s_waitcnt lgkmcnt(8)
    v_mfma_f32_16x16x32_bf16 v[64:67], a[64:67], a[0:3], v[48:51]
    ds_read_b64_tr_b16 a[112:113], v14 offset:32768
    v_mfma_f32_16x16x32_bf16 v[64:67], a[68:71], a[4:7], v[64:67]
    ds_read_b64_tr_b16 a[114:115], v14 offset:36864
    v_mfma_f32_16x16x32_bf16 v[64:67], a[72:75], a[8:11], v[64:67]
    ds_read_b64_tr_b16 a[116:117], v14 offset:40960
    v_mfma_f32_16x16x32_bf16 v[64:67], a[76:79], a[12:15], v[64:67]
    ds_read_b64_tr_b16 a[118:119], v14 offset:45056
    v_mfma_f32_16x16x32_bf16 v[68:71], a[92:95], a[12:15], v[48:51]
    ds_read_b64_tr_b16 a[120:121], v15 offset:32768
    v_mfma_f32_16x16x32_bf16 v[68:71], a[88:91], a[8:11], v[68:71]
    ds_read_b64_tr_b16 a[122:123], v15 offset:36864
    v_mfma_f32_16x16x32_bf16 v[68:71], a[84:87], a[4:7], v[68:71]
    ds_read_b64_tr_b16 a[124:125], v15 offset:40960
    v_mfma_f32_16x16x32_bf16 v[68:71], a[80:83], a[0:3], v[68:71]
    ds_read_b64_tr_b16 a[126:127], v15 offset:45056
    v_mfma_f32_16x16x32_bf16 v[76:79], a[80:83], a[16:19], v[52:55]
    v_exp_f32 v40, v64
    v_mfma_f32_16x16x32_bf16 v[76:79], a[84:87], a[20:23], v[76:79]
    s_add_u32 s91, s91, 114688
    v_exp_f32 v41, v65
    v_mfma_f32_16x16x32_bf16 v[76:79], a[88:91], a[24:27], v[76:79]
    s_add_u32 m0, s31, 133120
    v_exp_f32 v42, v66
    v_mfma_f32_16x16x32_bf16 v[76:79], a[92:95], a[28:31], v[76:79]
    buffer_load_dwordx4 v6, s[48:51], s91 offen lds
    v_mfma_f32_16x16x32_bf16 v[72:75], a[76:79], a[28:31], v[52:55]
    v_exp_f32 v43, v67
    v_mfma_f32_16x16x32_bf16 v[72:75], a[72:75], a[24:27], v[72:75]
    v_cvt_pk_bf16_f32 v128, v40, v41
    v_cvt_pk_bf16_f32 v129, v42, v43
    v_mfma_f32_16x16x32_bf16 v[72:75], a[68:71], a[20:23], v[72:75]
    v_exp_f32 v44, v68
    v_mfma_f32_16x16x32_bf16 v[72:75], a[64:67], a[16:19], v[72:75]
    v_exp_f32 v45, v69
    v_mfma_f32_16x16x32_bf16 v[80:83], a[64:67], a[32:35], v[56:59]
    v_exp_f32 v46, v70
    v_mfma_f32_16x16x32_bf16 v[80:83], a[68:71], a[36:39], v[80:83]
    v_exp_f32 v47, v71
    v_mfma_f32_16x16x32_bf16 v[80:83], a[72:75], a[40:43], v[80:83]
    s_add_u32 m0, s31, 149504
    v_cvt_pk_bf16_f32 v130, v44, v45
    v_cvt_pk_bf16_f32 v131, v46, v47
    v_mfma_f32_16x16x32_bf16 v[80:83], a[76:79], a[44:47], v[80:83]
    buffer_load_dwordx4 v6, s[12:15], s91 offen lds
    v_mfma_f32_16x16x32_bf16 v[84:87], a[92:95], a[44:47], v[56:59]
    v_exp_f32 v40, v76
    v_mfma_f32_16x16x32_bf16 v[84:87], a[88:91], a[40:43], v[84:87]
    v_exp_f32 v41, v77
    v_mfma_f32_16x16x32_bf16 v[84:87], a[84:87], a[36:39], v[84:87]
    v_exp_f32 v42, v78
    v_mfma_f32_16x16x32_bf16 v[84:87], a[80:83], a[32:35], v[84:87]
    v_exp_f32 v43, v79
    v_mfma_f32_16x16x32_bf16 v[92:95], a[80:83], a[48:51], v[60:63]
    v_cvt_pk_bf16_f32 v134, v40, v41
    v_cvt_pk_bf16_f32 v135, v42, v43
    v_mfma_f32_16x16x32_bf16 v[92:95], a[84:87], a[52:55], v[92:95]
    v_exp_f32 v44, v72
    v_mfma_f32_16x16x32_bf16 v[92:95], a[88:91], a[56:59], v[92:95]
    v_exp_f32 v45, v73
    v_mfma_f32_16x16x32_bf16 v[92:95], a[92:95], a[60:63], v[92:95]
    v_exp_f32 v46, v74
    v_mfma_f32_16x16x32_bf16 v[88:91], a[76:79], a[60:63], v[60:63]
    v_exp_f32 v47, v75
    v_mfma_f32_16x16x32_bf16 v[88:91], a[72:75], a[56:59], v[88:91]
    v_cvt_pk_bf16_f32 v132, v44, v45
    v_cvt_pk_bf16_f32 v133, v46, v47
    v_mfma_f32_16x16x32_bf16 v[88:91], a[68:71], a[52:55], v[88:91]
    v_exp_f32 v40, v80
    v_mfma_f32_16x16x32_bf16 v[88:91], a[64:67], a[48:51], v[88:91]
    s_waitcnt lgkmcnt(0)
    v_exp_f32 v41, v81
    v_smfmac_f32_16x16x64_bf16 a[132:135], a[136:139], v[120:127], v27
    v_cvt_pk_bf16_f32 v136, v40, v41
    v_smfmac_f32_16x16x64_bf16 a[128:131], a[136:139], v[112:119], v27
    ds_read_b128 a[64:67], v8 offset:57344
    v_mfma_f32_16x16x32_bf16 v[160:163], a[96:99], v[96:99], v[160:163]
    v_exp_f32 v42, v82
    v_mfma_f32_16x16x32_bf16 v[160:163], a[100:103], v[112:115], v[160:163]
    s_add_u32 m0, s31, 65536
    v_exp_f32 v43, v83
    v_mfma_f32_16x16x32_bf16 v[184:187], a[100:103], v[116:119], v[184:187]
    ds_read_b128 a[68:71], v9 offset:57344
    v_cvt_pk_bf16_f32 v137, v42, v43
    v_mfma_f32_16x16x32_bf16 v[184:187], a[96:99], v[100:103], v[184:187]
    buffer_load_dwordx4 v24, s[20:23], s39 offen offset:0 lds
    v_mfma_f32_16x16x32_bf16 v[208:211], a[96:99], v[104:107], v[208:211]
    v_exp_f32 v44, v84
    v_mfma_f32_16x16x32_bf16 v[208:211], a[100:103], v[120:123], v[208:211]
    v_exp_f32 v45, v85
    v_mfma_f32_16x16x32_bf16 v[232:235], a[100:103], v[124:127], v[232:235]
    ds_read_b128 a[72:75], v10 offset:57344
    v_cvt_pk_bf16_f32 v138, v44, v45
    v_mfma_f32_16x16x32_bf16 v[232:235], a[96:99], v[108:111], v[232:235]
    v_exp_f32 v46, v86
    v_mfma_f32_16x16x32_bf16 v[236:239], a[104:107], v[108:111], v[236:239]
    buffer_load_dwordx4 v25, s[20:23], s39 offen offset:1024 lds
    v_mfma_f32_16x16x32_bf16 v[236:239], a[108:111], v[124:127], v[236:239]
    v_exp_f32 v47, v87
    v_mfma_f32_16x16x32_bf16 v[212:215], a[108:111], v[120:123], v[212:215]
    ds_read_b128 a[76:79], v11 offset:57344
    v_cvt_pk_bf16_f32 v139, v46, v47
    v_mfma_f32_16x16x32_bf16 v[212:215], a[104:107], v[104:107], v[212:215]
    v_exp_f32 v40, v92
    v_mfma_f32_16x16x32_bf16 v[188:191], a[104:107], v[100:103], v[188:191]
    v_exp_f32 v41, v93
    v_mfma_f32_16x16x32_bf16 v[188:191], a[108:111], v[116:119], v[188:191]
    buffer_load_dwordx4 v24, s[20:23], s39 offen offset:2048 lds
    v_mfma_f32_16x16x32_bf16 v[164:167], a[108:111], v[112:115], v[164:167]
    ds_read_b128 a[80:83], v8 offset:61440
    v_cvt_pk_bf16_f32 v142, v40, v41
    v_mfma_f32_16x16x32_bf16 v[164:167], a[104:107], v[96:99], v[164:167]
    v_exp_f32 v42, v94
    v_mfma_f32_16x16x32_bf16 v[168:171], a[112:115], v[96:99], v[168:171]
    v_exp_f32 v43, v95
    v_mfma_f32_16x16x32_bf16 v[168:171], a[116:119], v[112:115], v[168:171]
    ds_read_b128 a[84:87], v9 offset:61440
    v_cvt_pk_bf16_f32 v143, v42, v43
    v_mfma_f32_16x16x32_bf16 v[192:195], a[116:119], v[116:119], v[192:195]
    buffer_load_dwordx4 v25, s[20:23], s39 offen offset:3072 lds
    v_mfma_f32_16x16x32_bf16 v[192:195], a[112:115], v[100:103], v[192:195]
    v_exp_f32 v44, v88
    v_mfma_f32_16x16x32_bf16 v[216:219], a[112:115], v[104:107], v[216:219]
    v_exp_f32 v45, v89
    v_mfma_f32_16x16x32_bf16 v[216:219], a[116:119], v[120:123], v[216:219]
    ds_read_b128 a[88:91], v10 offset:61440
    v_cvt_pk_bf16_f32 v140, v44, v45
    v_mfma_f32_16x16x32_bf16 v[240:243], a[116:119], v[124:127], v[240:243]
    v_exp_f32 v46, v90
    v_mfma_f32_16x16x32_bf16 v[240:243], a[112:115], v[108:111], v[240:243]
    s_add_u32 s39, s39, 16384
    v_exp_f32 v47, v91
    v_mfma_f32_16x16x32_bf16 v[244:247], a[120:123], v[108:111], v[244:247]
    ds_read_b128 a[92:95], v11 offset:61440
    v_cvt_pk_bf16_f32 v141, v46, v47
    v_mfma_f32_16x16x32_bf16 v[244:247], a[124:127], v[124:127], v[244:247]
    ds_read_b64_tr_b16 a[96:97], v16 offset:32768
    ds_read_b64_tr_b16 a[98:99], v16 offset:36864
    v_mfma_f32_16x16x32_bf16 v[220:223], a[124:127], v[120:123], v[220:223]
    ds_read_b64_tr_b16 a[100:101], v16 offset:40960
    ds_read_b64_tr_b16 a[102:103], v16 offset:45056
    v_mfma_f32_16x16x32_bf16 v[220:223], a[120:123], v[104:107], v[220:223]
    ds_read_b64_tr_b16 a[104:105], v17 offset:32768
    ds_read_b64_tr_b16 a[106:107], v17 offset:36864
    v_mfma_f32_16x16x32_bf16 v[196:199], a[120:123], v[100:103], v[196:199]
    ds_read_b64_tr_b16 a[108:109], v17 offset:40960
    v_mfma_f32_16x16x32_bf16 v[196:199], a[124:127], v[116:119], v[196:199]
    ds_read_b64_tr_b16 a[110:111], v17 offset:45056
    v_mfma_f32_16x16x32_bf16 v[172:175], a[124:127], v[112:115], v[172:175]
    v_mfma_f32_16x16x32_bf16 v[172:175], a[120:123], v[96:99], v[172:175]
    s_waitcnt lgkmcnt(8)
    v_mfma_f32_16x16x32_bf16 v[64:67], a[64:67], a[0:3], v[48:51]
    ds_read_b64_tr_b16 a[112:113], v18 offset:32768
    v_mfma_f32_16x16x32_bf16 v[64:67], a[68:71], a[4:7], v[64:67]
    ds_read_b64_tr_b16 a[114:115], v18 offset:36864
    v_mfma_f32_16x16x32_bf16 v[64:67], a[72:75], a[8:11], v[64:67]
    ds_read_b64_tr_b16 a[116:117], v18 offset:40960
    v_mfma_f32_16x16x32_bf16 v[64:67], a[76:79], a[12:15], v[64:67]
    ds_read_b64_tr_b16 a[118:119], v18 offset:45056
    v_mfma_f32_16x16x32_bf16 v[68:71], a[92:95], a[12:15], v[48:51]
    ds_read_b64_tr_b16 a[120:121], v19 offset:32768
    v_mfma_f32_16x16x32_bf16 v[68:71], a[88:91], a[8:11], v[68:71]
    ds_read_b64_tr_b16 a[122:123], v19 offset:36864
    v_mfma_f32_16x16x32_bf16 v[68:71], a[84:87], a[4:7], v[68:71]
    ds_read_b64_tr_b16 a[124:125], v19 offset:40960
    v_mfma_f32_16x16x32_bf16 v[68:71], a[80:83], a[0:3], v[68:71]
    ds_read_b64_tr_b16 a[126:127], v19 offset:45056
    v_mfma_f32_16x16x32_bf16 v[76:79], a[80:83], a[16:19], v[52:55]
    v_exp_f32 v40, v64
    v_mfma_f32_16x16x32_bf16 v[76:79], a[84:87], a[20:23], v[76:79]
    s_add_u32 s91, s91, 114688
    v_exp_f32 v41, v65
    v_mfma_f32_16x16x32_bf16 v[76:79], a[88:91], a[24:27], v[76:79]
    s_add_u32 m0, s31, 134144
    v_exp_f32 v42, v66
    v_mfma_f32_16x16x32_bf16 v[76:79], a[92:95], a[28:31], v[76:79]
    buffer_load_dwordx4 v6, s[48:51], s91 offen lds
    v_mfma_f32_16x16x32_bf16 v[72:75], a[76:79], a[28:31], v[52:55]
    v_exp_f32 v43, v67
    v_mfma_f32_16x16x32_bf16 v[72:75], a[72:75], a[24:27], v[72:75]
    v_cvt_pk_bf16_f32 v144, v40, v41
    v_cvt_pk_bf16_f32 v145, v42, v43
    v_mfma_f32_16x16x32_bf16 v[72:75], a[68:71], a[20:23], v[72:75]
    v_exp_f32 v44, v68
    v_mfma_f32_16x16x32_bf16 v[72:75], a[64:67], a[16:19], v[72:75]
    v_exp_f32 v45, v69
    v_mfma_f32_16x16x32_bf16 v[80:83], a[64:67], a[32:35], v[56:59]
    v_exp_f32 v46, v70
    v_mfma_f32_16x16x32_bf16 v[80:83], a[68:71], a[36:39], v[80:83]
    v_exp_f32 v47, v71
    v_mfma_f32_16x16x32_bf16 v[80:83], a[72:75], a[40:43], v[80:83]
    s_add_u32 m0, s31, 150528
    v_cvt_pk_bf16_f32 v146, v44, v45
    v_cvt_pk_bf16_f32 v147, v46, v47
    v_mfma_f32_16x16x32_bf16 v[80:83], a[76:79], a[44:47], v[80:83]
    buffer_load_dwordx4 v6, s[12:15], s91 offen lds
    v_mfma_f32_16x16x32_bf16 v[84:87], a[92:95], a[44:47], v[56:59]
    v_exp_f32 v40, v76
    v_mfma_f32_16x16x32_bf16 v[84:87], a[88:91], a[40:43], v[84:87]
    v_exp_f32 v41, v77
    v_mfma_f32_16x16x32_bf16 v[84:87], a[84:87], a[36:39], v[84:87]
    v_exp_f32 v42, v78
    v_mfma_f32_16x16x32_bf16 v[84:87], a[80:83], a[32:35], v[84:87]
    v_exp_f32 v43, v79
    v_mfma_f32_16x16x32_bf16 v[92:95], a[80:83], a[48:51], v[60:63]
    v_cvt_pk_bf16_f32 v150, v40, v41
    v_cvt_pk_bf16_f32 v151, v42, v43
    v_mfma_f32_16x16x32_bf16 v[92:95], a[84:87], a[52:55], v[92:95]
    v_exp_f32 v44, v72
    v_mfma_f32_16x16x32_bf16 v[92:95], a[88:91], a[56:59], v[92:95]
    v_exp_f32 v45, v73
    v_mfma_f32_16x16x32_bf16 v[92:95], a[92:95], a[60:63], v[92:95]
    v_exp_f32 v46, v74
    v_mfma_f32_16x16x32_bf16 v[88:91], a[76:79], a[60:63], v[60:63]
    v_exp_f32 v47, v75
    v_mfma_f32_16x16x32_bf16 v[88:91], a[72:75], a[56:59], v[88:91]
    v_cvt_pk_bf16_f32 v148, v44, v45
    v_cvt_pk_bf16_f32 v149, v46, v47
    v_mfma_f32_16x16x32_bf16 v[88:91], a[68:71], a[52:55], v[88:91]
    v_exp_f32 v40, v80
    v_mfma_f32_16x16x32_bf16 v[88:91], a[64:67], a[48:51], v[88:91]
    s_waitcnt vmcnt(12) lgkmcnt(0)
    v_exp_f32 v41, v81
    v_smfmac_f32_16x16x64_bf16 a[132:135], a[136:139], v[136:143], v27
    s_barrier
    v_smfmac_f32_16x16x64_bf16 a[128:131], a[136:139], v[128:135], v27
    ds_read_b128 a[64:67], v8 offset:0
    v_cvt_pk_bf16_f32 v152, v40, v41
    v_mfma_f32_16x16x32_bf16 v[176:179], a[96:99], v[96:99], v[176:179]
    v_exp_f32 v42, v82
    v_mfma_f32_16x16x32_bf16 v[176:179], a[100:103], v[112:115], v[176:179]
    s_add_u32 m0, s31, 32768
    v_exp_f32 v43, v83
    v_mfma_f32_16x16x32_bf16 v[200:203], a[100:103], v[116:119], v[200:203]
    ds_read_b128 a[68:71], v9 offset:0
    v_cvt_pk_bf16_f32 v153, v42, v43
    v_mfma_f32_16x16x32_bf16 v[200:203], a[96:99], v[100:103], v[200:203]
    buffer_load_dwordx4 v20, s[16:19], s32 offen offset:0 lds
    v_mfma_f32_16x16x32_bf16 v[224:227], a[96:99], v[104:107], v[224:227]
    v_exp_f32 v44, v84
    v_mfma_f32_16x16x32_bf16 v[224:227], a[100:103], v[120:123], v[224:227]
    v_exp_f32 v45, v85
    v_mfma_f32_16x16x32_bf16 v[248:251], a[100:103], v[124:127], v[248:251]
    ds_read_b128 a[72:75], v10 offset:0
    v_cvt_pk_bf16_f32 v154, v44, v45
    v_mfma_f32_16x16x32_bf16 v[248:251], a[96:99], v[108:111], v[248:251]
    v_exp_f32 v46, v86
    v_mfma_f32_16x16x32_bf16 v[252:255], a[104:107], v[108:111], v[252:255]
    buffer_load_dwordx4 v21, s[16:19], s32 offen offset:1024 lds
    v_mfma_f32_16x16x32_bf16 v[252:255], a[108:111], v[124:127], v[252:255]
    v_exp_f32 v47, v87
    v_mfma_f32_16x16x32_bf16 v[228:231], a[108:111], v[120:123], v[228:231]
    ds_read_b128 a[76:79], v11 offset:0
    v_cvt_pk_bf16_f32 v155, v46, v47
    v_mfma_f32_16x16x32_bf16 v[228:231], a[104:107], v[104:107], v[228:231]
    v_exp_f32 v40, v92
    v_mfma_f32_16x16x32_bf16 v[204:207], a[104:107], v[100:103], v[204:207]
    v_exp_f32 v41, v93
    v_mfma_f32_16x16x32_bf16 v[204:207], a[108:111], v[116:119], v[204:207]
    buffer_load_dwordx4 v22, s[16:19], s32 offen offset:2048 lds
    v_mfma_f32_16x16x32_bf16 v[180:183], a[108:111], v[112:115], v[180:183]
    ds_read_b128 a[80:83], v8 offset:4096
    v_cvt_pk_bf16_f32 v158, v40, v41
    v_mfma_f32_16x16x32_bf16 v[180:183], a[104:107], v[96:99], v[180:183]
    v_exp_f32 v42, v94
    v_mfma_f32_16x16x32_bf16 a[224:227], a[112:115], v[96:99], a[224:227]
    v_exp_f32 v43, v95
    v_mfma_f32_16x16x32_bf16 a[224:227], a[116:119], v[112:115], a[224:227]
    ds_read_b128 a[84:87], v9 offset:4096
    v_cvt_pk_bf16_f32 v159, v42, v43
    v_mfma_f32_16x16x32_bf16 a[232:235], a[116:119], v[116:119], a[232:235]
    buffer_load_dwordx4 v23, s[16:19], s32 offen offset:3072 lds
    v_mfma_f32_16x16x32_bf16 a[232:235], a[112:115], v[100:103], a[232:235]
    v_exp_f32 v44, v88
    v_mfma_f32_16x16x32_bf16 a[240:243], a[112:115], v[104:107], a[240:243]
    v_exp_f32 v45, v89
    v_mfma_f32_16x16x32_bf16 a[240:243], a[116:119], v[120:123], a[240:243]
    ds_read_b128 a[88:91], v10 offset:4096
    v_cvt_pk_bf16_f32 v156, v44, v45
    v_mfma_f32_16x16x32_bf16 a[248:251], a[116:119], v[124:127], a[248:251]
    v_exp_f32 v46, v90
    v_mfma_f32_16x16x32_bf16 a[248:251], a[112:115], v[108:111], a[248:251]
    s_add_u32 s32, s32, 16384
    v_exp_f32 v47, v91
    v_mfma_f32_16x16x32_bf16 a[252:255], a[120:123], v[108:111], a[252:255]
    ds_read_b128 a[92:95], v11 offset:4096
    v_cvt_pk_bf16_f32 v157, v46, v47
    v_mfma_f32_16x16x32_bf16 a[252:255], a[124:127], v[124:127], a[252:255]
    ds_read_b64_tr_b16 a[96:97], v12 offset:49152
    ds_read_b64_tr_b16 a[98:99], v12 offset:53248
    v_mfma_f32_16x16x32_bf16 a[244:247], a[124:127], v[120:123], a[244:247]
    ds_read_b64_tr_b16 a[100:101], v12 offset:57344
    ds_read_b64_tr_b16 a[102:103], v12 offset:61440
    v_mfma_f32_16x16x32_bf16 a[244:247], a[120:123], v[104:107], a[244:247]
    ds_read_b64_tr_b16 a[104:105], v13 offset:49152
    ds_read_b64_tr_b16 a[106:107], v13 offset:53248
    v_mfma_f32_16x16x32_bf16 a[236:239], a[120:123], v[100:103], a[236:239]
    ds_read_b64_tr_b16 a[108:109], v13 offset:57344
    v_mfma_f32_16x16x32_bf16 a[236:239], a[124:127], v[116:119], a[236:239]
    ds_read_b64_tr_b16 a[110:111], v13 offset:61440
    v_mfma_f32_16x16x32_bf16 a[228:231], a[124:127], v[112:115], a[228:231]
    s_add_u32 s38, s38, s38
    v_mfma_f32_16x16x32_bf16 a[228:231], a[120:123], v[96:99], a[228:231]
    s_waitcnt lgkmcnt(8)
    s_cbranch_scc1 L_hookB
L_loop:
    v_mfma_f32_16x16x32_bf16 v[64:67], a[64:67], a[0:3], v[48:51]
    ds_read_b64_tr_b16 a[112:113], v14 offset:49152
    v_mfma_f32_16x16x32_bf16 v[64:67], a[68:71], a[4:7], v[64:67]
    ds_read_b64_tr_b16 a[114:115], v14 offset:53248
    v_mfma_f32_16x16x32_bf16 v[64:67], a[72:75], a[8:11], v[64:67]
    ds_read_b64_tr_b16 a[116:117], v14 offset:57344
    v_mfma_f32_16x16x32_bf16 v[64:67], a[76:79], a[12:15], v[64:67]
    ds_read_b64_tr_b16 a[118:119], v14 offset:61440
    v_mfma_f32_16x16x32_bf16 v[68:71], a[92:95], a[12:15], v[48:51]
    ds_read_b64_tr_b16 a[120:121], v15 offset:49152
    v_mfma_f32_16x16x32_bf16 v[68:71], a[88:91], a[8:11], v[68:71]
    ds_read_b64_tr_b16 a[122:123], v15 offset:53248
    v_mfma_f32_16x16x32_bf16 v[68:71], a[84:87], a[4:7], v[68:71]
    ds_read_b64_tr_b16 a[124:125], v15 offset:57344
    v_mfma_f32_16x16x32_bf16 v[68:71], a[80:83], a[0:3], v[68:71]
    ds_read_b64_tr_b16 a[126:127], v15 offset:61440
    v_mfma_f32_16x16x32_bf16 v[76:79], a[80:83], a[16:19], v[52:55]
    v_exp_f32 v40, v64
    v_mfma_f32_16x16x32_bf16 v[76:79], a[84:87], a[20:23], v[76:79]
    v_exp_f32 v41, v65
    v_mfma_f32_16x16x32_bf16 v[76:79], a[88:91], a[24:27], v[76:79]
    v_exp_f32 v42, v66
    v_mfma_f32_16x16x32_bf16 v[76:79], a[92:95], a[28:31], v[76:79]
    v_exp_f32 v43, v67
    v_mfma_f32_16x16x32_bf16 v[72:75], a[76:79], a[28:31], v[52:55]
    v_cvt_pk_bf16_f32 v96, v40, v41
    v_cvt_pk_bf16_f32 v97, v42, v43
    v_mfma_f32_16x16x32_bf16 v[72:75], a[72:75], a[24:27], v[72:75]
    v_exp_f32 v44, v68
    v_mfma_f32_16x16x32_bf16 v[72:75], a[68:71], a[20:23], v[72:75]
    v_exp_f32 v45, v69
    v_mfma_f32_16x16x32_bf16 v[72:75], a[64:67], a[16:19], v[72:75]
    v_exp_f32 v46, v70
    v_mfma_f32_16x16x32_bf16 v[80:83], a[64:67], a[32:35], v[56:59]
    v_exp_f32 v47, v71
    v_mfma_f32_16x16x32_bf16 v[80:83], a[68:71], a[36:39], v[80:83]
    v_cvt_pk_bf16_f32 v98, v44, v45
    v_cvt_pk_bf16_f32 v99, v46, v47
    v_mfma_f32_16x16x32_bf16 v[80:83], a[72:75], a[40:43], v[80:83]
    v_exp_f32 v40, v76
    v_mfma_f32_16x16x32_bf16 v[80:83], a[76:79], a[44:47], v[80:83]
    v_exp_f32 v41, v77
    v_mfma_f32_16x16x32_bf16 v[84:87], a[92:95], a[44:47], v[56:59]
    v_exp_f32 v42, v78
    v_mfma_f32_16x16x32_bf16 v[84:87], a[88:91], a[40:43], v[84:87]
    v_exp_f32 v43, v79
    v_mfma_f32_16x16x32_bf16 v[84:87], a[84:87], a[36:39], v[84:87]
    v_cvt_pk_bf16_f32 v102, v40, v41
    v_cvt_pk_bf16_f32 v103, v42, v43
    v_mfma_f32_16x16x32_bf16 v[84:87], a[80:83], a[32:35], v[84:87]
    v_exp_f32 v44, v72
    v_mfma_f32_16x16x32_bf16 v[92:95], a[80:83], a[48:51], v[60:63]
    v_exp_f32 v45, v73
    v_mfma_f32_16x16x32_bf16 v[92:95], a[84:87], a[52:55], v[92:95]
    v_exp_f32 v46, v74
    v_mfma_f32_16x16x32_bf16 v[92:95], a[88:91], a[56:59], v[92:95]
    v_exp_f32 v47, v75
    v_mfma_f32_16x16x32_bf16 v[92:95], a[92:95], a[60:63], v[92:95]
    v_cvt_pk_bf16_f32 v100, v44, v45
    v_cvt_pk_bf16_f32 v101, v46, v47
    v_mfma_f32_16x16x32_bf16 v[88:91], a[76:79], a[60:63], v[60:63]
    v_exp_f32 v40, v80
    v_mfma_f32_16x16x32_bf16 v[88:91], a[72:75], a[56:59], v[88:91]
    v_exp_f32 v41, v81
    v_mfma_f32_16x16x32_bf16 v[88:91], a[68:71], a[52:55], v[88:91]
    v_exp_f32 v42, v82
    v_mfma_f32_16x16x32_bf16 v[88:91], a[64:67], a[48:51], v[88:91]
    s_waitcnt lgkmcnt(0)
    v_exp_f32 v43, v83
    v_smfmac_f32_16x16x64_bf16 a[132:135], a[136:139], v[152:159], v27
    v_cvt_pk_bf16_f32 v104, v40, v41
    v_smfmac_f32_16x16x64_bf16 a[128:131], a[136:139], v[144:151], v27
    ds_read_b128 a[64:67], v8 offset:8192
    v_cvt_pk_bf16_f32 v105, v42, v43
    v_mfma_f32_16x16x32_bf16 v[160:163], a[96:99], v[128:131], v[160:163]
    v_exp_f32 v44, v84
    v_mfma_f32_16x16x32_bf16 v[160:163], a[100:103], v[144:147], v[160:163]
    s_add_u32 m0, s31, 81920
    v_exp_f32 v45, v85
    v_mfma_f32_16x16x32_bf16 v[184:187], a[100:103], v[148:151], v[184:187]
    ds_read_b128 a[68:71], v9 offset:8192
    v_cvt_pk_bf16_f32 v106, v44, v45
    v_mfma_f32_16x16x32_bf16 v[184:187], a[96:99], v[132:135], v[184:187]
    buffer_load_dwordx4 v24, s[20:23], s39 offen offset:0 lds
    v_mfma_f32_16x16x32_bf16 v[208:211], a[96:99], v[136:139], v[208:211]
    v_exp_f32 v46, v86
    v_mfma_f32_16x16x32_bf16 v[208:211], a[100:103], v[152:155], v[208:211]
    v_exp_f32 v47, v87
    v_mfma_f32_16x16x32_bf16 v[232:235], a[100:103], v[156:159], v[232:235]
    ds_read_b128 a[72:75], v10 offset:8192
    v_cvt_pk_bf16_f32 v107, v46, v47
    v_mfma_f32_16x16x32_bf16 v[232:235], a[96:99], v[140:143], v[232:235]
    v_exp_f32 v40, v92
    v_mfma_f32_16x16x32_bf16 v[236:239], a[104:107], v[140:143], v[236:239]
    buffer_load_dwordx4 v25, s[20:23], s39 offen offset:1024 lds
    v_mfma_f32_16x16x32_bf16 v[236:239], a[108:111], v[156:159], v[236:239]
    v_exp_f32 v41, v93
    v_mfma_f32_16x16x32_bf16 v[212:215], a[108:111], v[152:155], v[212:215]
    ds_read_b128 a[76:79], v11 offset:8192
    v_cvt_pk_bf16_f32 v110, v40, v41
    v_mfma_f32_16x16x32_bf16 v[212:215], a[104:107], v[136:139], v[212:215]
    v_exp_f32 v42, v94
    v_mfma_f32_16x16x32_bf16 v[188:191], a[104:107], v[132:135], v[188:191]
    v_exp_f32 v43, v95
    v_mfma_f32_16x16x32_bf16 v[188:191], a[108:111], v[148:151], v[188:191]
    buffer_load_dwordx4 v24, s[20:23], s39 offen offset:2048 lds
    v_mfma_f32_16x16x32_bf16 v[164:167], a[108:111], v[144:147], v[164:167]
    ds_read_b128 a[80:83], v8 offset:12288
    v_cvt_pk_bf16_f32 v111, v42, v43
    v_mfma_f32_16x16x32_bf16 v[164:167], a[104:107], v[128:131], v[164:167]
    v_exp_f32 v44, v88
    v_mfma_f32_16x16x32_bf16 v[168:171], a[112:115], v[128:131], v[168:171]
    v_exp_f32 v45, v89
    v_mfma_f32_16x16x32_bf16 v[168:171], a[116:119], v[144:147], v[168:171]
    ds_read_b128 a[84:87], v9 offset:12288
    v_cvt_pk_bf16_f32 v108, v44, v45
    v_mfma_f32_16x16x32_bf16 v[192:195], a[116:119], v[148:151], v[192:195]
    buffer_load_dwordx4 v25, s[20:23], s39 offen offset:3072 lds
    v_mfma_f32_16x16x32_bf16 v[192:195], a[112:115], v[132:135], v[192:195]
    v_exp_f32 v46, v90
    v_mfma_f32_16x16x32_bf16 v[216:219], a[112:115], v[136:139], v[216:219]
    v_exp_f32 v47, v91
    v_mfma_f32_16x16x32_bf16 v[216:219], a[116:119], v[152:155], v[216:219]
    ds_read_b128 a[88:91], v10 offset:12288
    v_cvt_pk_bf16_f32 v109, v46, v47
    v_mfma_f32_16x16x32_bf16 v[240:243], a[116:119], v[156:159], v[240:243]
    ds_read_b128 a[92:95], v11 offset:12288
    v_mfma_f32_16x16x32_bf16 v[240:243], a[112:115], v[140:143], v[240:243]
    ds_read_b64_tr_b16 a[96:97], v16 offset:49152
    ds_read_b64_tr_b16 a[98:99], v16 offset:53248
    v_mfma_f32_16x16x32_bf16 v[244:247], a[120:123], v[140:143], v[244:247]
    ds_read_b64_tr_b16 a[100:101], v16 offset:57344
    v_mfma_f32_16x16x32_bf16 v[244:247], a[124:127], v[156:159], v[244:247]
    ds_read_b64_tr_b16 a[102:103], v16 offset:61440
    v_mfma_f32_16x16x32_bf16 v[220:223], a[124:127], v[152:155], v[220:223]
    s_add_u32 s39, s39, 16384
    ds_read_b64_tr_b16 a[104:105], v17 offset:49152
    v_mfma_f32_16x16x32_bf16 v[220:223], a[120:123], v[136:139], v[220:223]
    ds_read_b64_tr_b16 a[106:107], v17 offset:53248
    v_mfma_f32_16x16x32_bf16 v[196:199], a[120:123], v[132:135], v[196:199]
    ds_read_b64_tr_b16 a[108:109], v17 offset:57344
    v_mfma_f32_16x16x32_bf16 v[196:199], a[124:127], v[148:151], v[196:199]
    ds_read_b64_tr_b16 a[110:111], v17 offset:61440
    v_mfma_f32_16x16x32_bf16 v[172:175], a[124:127], v[144:147], v[172:175]
    v_mfma_f32_16x16x32_bf16 v[172:175], a[120:123], v[128:131], v[172:175]
    s_waitcnt lgkmcnt(8)
    v_mfma_f32_16x16x32_bf16 v[64:67], a[64:67], a[0:3], v[48:51]
    ds_read_b64_tr_b16 a[112:113], v18 offset:49152
    v_mfma_f32_16x16x32_bf16 v[64:67], a[68:71], a[4:7], v[64:67]
    ds_read_b64_tr_b16 a[114:115], v18 offset:53248
    v_mfma_f32_16x16x32_bf16 v[64:67], a[72:75], a[8:11], v[64:67]
    ds_read_b64_tr_b16 a[116:117], v18 offset:57344
    v_mfma_f32_16x16x32_bf16 v[64:67], a[76:79], a[12:15], v[64:67]
    ds_read_b64_tr_b16 a[118:119], v18 offset:61440
    v_mfma_f32_16x16x32_bf16 v[68:71], a[92:95], a[12:15], v[48:51]
    ds_read_b64_tr_b16 a[120:121], v19 offset:49152
    v_mfma_f32_16x16x32_bf16 v[68:71], a[88:91], a[8:11], v[68:71]
    ds_read_b64_tr_b16 a[122:123], v19 offset:53248
    v_mfma_f32_16x16x32_bf16 v[68:71], a[84:87], a[4:7], v[68:71]
    ds_read_b64_tr_b16 a[124:125], v19 offset:57344
    v_mfma_f32_16x16x32_bf16 v[68:71], a[80:83], a[0:3], v[68:71]
    ds_read_b64_tr_b16 a[126:127], v19 offset:61440
    v_mfma_f32_16x16x32_bf16 v[76:79], a[80:83], a[16:19], v[52:55]
    v_exp_f32 v40, v64
    v_mfma_f32_16x16x32_bf16 v[76:79], a[84:87], a[20:23], v[76:79]
    v_exp_f32 v41, v65
    v_mfma_f32_16x16x32_bf16 v[76:79], a[88:91], a[24:27], v[76:79]
    v_exp_f32 v42, v66
    v_mfma_f32_16x16x32_bf16 v[76:79], a[92:95], a[28:31], v[76:79]
    v_exp_f32 v43, v67
    v_mfma_f32_16x16x32_bf16 v[72:75], a[76:79], a[28:31], v[52:55]
L_pad5:
    s_cbranch_execz L_pad9
    v_cvt_pk_bf16_f32 v112, v40, v41
    v_cvt_pk_bf16_f32 v113, v42, v43
    v_mfma_f32_16x16x32_bf16 v[72:75], a[72:75], a[24:27], v[72:75]
    v_exp_f32 v44, v68
    v_mfma_f32_16x16x32_bf16 v[72:75], a[68:71], a[20:23], v[72:75]
    v_exp_f32 v45, v69
    v_mfma_f32_16x16x32_bf16 v[72:75], a[64:67], a[16:19], v[72:75]
    v_exp_f32 v46, v70
    v_mfma_f32_16x16x32_bf16 v[80:83], a[64:67], a[32:35], v[56:59]
    v_exp_f32 v47, v71
    v_mfma_f32_16x16x32_bf16 v[80:83], a[68:71], a[36:39], v[80:83]
    v_cvt_pk_bf16_f32 v114, v44, v45
    v_cvt_pk_bf16_f32 v115, v46, v47
    v_mfma_f32_16x16x32_bf16 v[80:83], a[72:75], a[40:43], v[80:83]
    v_exp_f32 v40, v76
    v_mfma_f32_16x16x32_bf16 v[80:83], a[76:79], a[44:47], v[80:83]
    v_exp_f32 v41, v77
    v_mfma_f32_16x16x32_bf16 v[84:87], a[92:95], a[44:47], v[56:59]
    v_exp_f32 v42, v78
    v_mfma_f32_16x16x32_bf16 v[84:87], a[88:91], a[40:43], v[84:87]
    v_exp_f32 v43, v79
    v_mfma_f32_16x16x32_bf16 v[84:87], a[84:87], a[36:39], v[84:87]
    v_cvt_pk_bf16_f32 v118, v40, v41
    v_cvt_pk_bf16_f32 v119, v42, v43
    v_mfma_f32_16x16x32_bf16 v[84:87], a[80:83], a[32:35], v[84:87]
    v_exp_f32 v44, v72
    v_mfma_f32_16x16x32_bf16 v[92:95], a[80:83], a[48:51], v[60:63]
    v_exp_f32 v45, v73
    v_mfma_f32_16x16x32_bf16 v[92:95], a[84:87], a[52:55], v[92:95]
    v_exp_f32 v46, v74
    v_mfma_f32_16x16x32_bf16 v[92:95], a[88:91], a[56:59], v[92:95]
    v_exp_f32 v47, v75
    v_mfma_f32_16x16x32_bf16 v[92:95], a[92:95], a[60:63], v[92:95]
    v_cvt_pk_bf16_f32 v116, v44, v45
    v_cvt_pk_bf16_f32 v117, v46, v47
    v_mfma_f32_16x16x32_bf16 v[88:91], a[76:79], a[60:63], v[60:63]
    v_exp_f32 v40, v80
    v_mfma_f32_16x16x32_bf16 v[88:91], a[72:75], a[56:59], v[88:91]
    v_exp_f32 v41, v81
    v_mfma_f32_16x16x32_bf16 v[88:91], a[68:71], a[52:55], v[88:91]
    s_add_u32 m0, s31, 49152
    v_exp_f32 v42, v82
    v_mfma_f32_16x16x32_bf16 v[88:91], a[64:67], a[48:51], v[88:91]
    s_waitcnt vmcnt(8) lgkmcnt(0)
    v_exp_f32 v43, v83
    v_smfmac_f32_16x16x64_bf16 a[132:135], a[136:139], v[104:111], v27
    s_barrier
    v_smfmac_f32_16x16x64_bf16 a[128:131], a[136:139], v[96:103], v27
    global_load_dword v6, v[28:29], off sc1
    v_mfma_f32_16x16x32_bf16 v[176:179], a[96:99], v[128:131], v[176:179]
    ds_read_b128 a[64:67], v8 offset:16384
    v_cvt_pk_bf16_f32 v120, v40, v41
    v_mfma_f32_16x16x32_bf16 v[176:179], a[100:103], v[144:147], v[176:179]
    buffer_load_dword v26, v34, s[44:47], 0 offen offset:32 sc1
    v_mfma_f32_16x16x32_bf16 v[200:203], a[100:103], v[148:151], v[200:203]
    ds_read_b128 a[68:71], v9 offset:16384
    v_cvt_pk_bf16_f32 v121, v42, v43
    v_mfma_f32_16x16x32_bf16 v[200:203], a[96:99], v[132:135], v[200:203]
    buffer_load_dwordx4 v20, s[16:19], s32 offen offset:0 lds
    v_mfma_f32_16x16x32_bf16 v[224:227], a[96:99], v[136:139], v[224:227]
    v_exp_f32 v44, v84
    v_mfma_f32_16x16x32_bf16 v[224:227], a[100:103], v[152:155], v[224:227]
    v_exp_f32 v45, v85
    v_mfma_f32_16x16x32_bf16 v[248:251], a[100:103], v[156:159], v[248:251]
    ds_read_b128 a[72:75], v10 offset:16384
    v_cvt_pk_bf16_f32 v122, v44, v45
    v_mfma_f32_16x16x32_bf16 v[248:251], a[96:99], v[140:143], v[248:251]
    v_exp_f32 v46, v86
    v_mfma_f32_16x16x32_bf16 v[252:255], a[104:107], v[140:143], v[252:255]
    buffer_load_dwordx4 v21, s[16:19], s32 offen offset:1024 lds
    v_mfma_f32_16x16x32_bf16 v[252:255], a[108:111], v[156:159], v[252:255]
    v_exp_f32 v47, v87
    v_mfma_f32_16x16x32_bf16 v[228:231], a[108:111], v[152:155], v[228:231]
    ds_read_b128 a[76:79], v11 offset:16384
    v_cvt_pk_bf16_f32 v123, v46, v47
    v_mfma_f32_16x16x32_bf16 v[228:231], a[104:107], v[136:139], v[228:231]
    v_exp_f32 v40, v92
    v_mfma_f32_16x16x32_bf16 v[204:207], a[104:107], v[132:135], v[204:207]
    v_exp_f32 v41, v93
    v_mfma_f32_16x16x32_bf16 v[204:207], a[108:111], v[148:151], v[204:207]
    buffer_load_dwordx4 v22, s[16:19], s32 offen offset:2048 lds
    v_mfma_f32_16x16x32_bf16 v[180:183], a[108:111], v[144:147], v[180:183]
    ds_read_b128 a[80:83], v8 offset:20480
    v_cvt_pk_bf16_f32 v126, v40, v41
    v_mfma_f32_16x16x32_bf16 v[180:183], a[104:107], v[128:131], v[180:183]
    v_exp_f32 v42, v94
    v_mfma_f32_16x16x32_bf16 a[224:227], a[112:115], v[128:131], a[224:227]
    v_exp_f32 v43, v95
    v_mfma_f32_16x16x32_bf16 a[224:227], a[116:119], v[144:147], a[224:227]
    ds_read_b128 a[84:87], v9 offset:20480
    v_cvt_pk_bf16_f32 v127, v42, v43
    v_mfma_f32_16x16x32_bf16 a[232:235], a[116:119], v[148:151], a[232:235]
    buffer_load_dwordx4 v23, s[16:19], s32 offen offset:3072 lds
    v_mfma_f32_16x16x32_bf16 a[232:235], a[112:115], v[132:135], a[232:235]
    v_exp_f32 v44, v88
    v_mfma_f32_16x16x32_bf16 a[240:243], a[112:115], v[136:139], a[240:243]
    v_exp_f32 v45, v89
    v_mfma_f32_16x16x32_bf16 a[240:243], a[116:119], v[152:155], a[240:243]
    ds_read_b128 a[88:91], v10 offset:20480
    v_cvt_pk_bf16_f32 v124, v44, v45
    v_mfma_f32_16x16x32_bf16 a[248:251], a[116:119], v[156:159], a[248:251]
    v_exp_f32 v46, v90
    v_mfma_f32_16x16x32_bf16 a[248:251], a[112:115], v[140:143], a[248:251]
    s_add_u32 s32, s32, 16384
    v_exp_f32 v47, v91
    v_mfma_f32_16x16x32_bf16 a[252:255], a[120:123], v[140:143], a[252:255]
    ds_read_b128 a[92:95], v11 offset:20480
    v_cvt_pk_bf16_f32 v125, v46, v47
    v_mfma_f32_16x16x32_bf16 a[252:255], a[124:127], v[156:159], a[252:255]
    ds_read_b64_tr_b16 a[96:97], v12 offset:0
    ds_read_b64_tr_b16 a[98:99], v12 offset:4096
    v_mfma_f32_16x16x32_bf16 a[244:247], a[124:127], v[152:155], a[244:247]
    ds_read_b64_tr_b16 a[100:101], v12 offset:8192
    ds_read_b64_tr_b16 a[102:103], v12 offset:12288
    v_mfma_f32_16x16x32_bf16 a[244:247], a[120:123], v[136:139], a[244:247]
    ds_read_b64_tr_b16 a[104:105], v13 offset:0
    ds_read_b64_tr_b16 a[106:107], v13 offset:4096
    v_mfma_f32_16x16x32_bf16 a[236:239], a[120:123], v[132:135], a[236:239]
    ds_read_b64_tr_b16 a[108:109], v13 offset:8192
    v_mfma_f32_16x16x32_bf16 a[236:239], a[124:127], v[148:151], a[236:239]
    ds_read_b64_tr_b16 a[110:111], v13 offset:12288
    v_mfma_f32_16x16x32_bf16 a[228:231], a[124:127], v[144:147], a[228:231]
    v_mfma_f32_16x16x32_bf16 a[228:231], a[120:123], v[128:131], a[228:231]
    s_waitcnt lgkmcnt(8)
    v_mfma_f32_16x16x32_bf16 v[64:67], a[64:67], a[0:3], v[48:51]
    ds_read_b64_tr_b16 a[112:113], v14 offset:0
    v_mfma_f32_16x16x32_bf16 v[64:67], a[68:71], a[4:7], v[64:67]
    ds_read_b64_tr_b16 a[114:115], v14 offset:4096
    v_mfma_f32_16x16x32_bf16 v[64:67], a[72:75], a[8:11], v[64:67]
    ds_read_b64_tr_b16 a[116:117], v14 offset:8192
    v_mfma_f32_16x16x32_bf16 v[64:67], a[76:79], a[12:15], v[64:67]
    ds_read_b64_tr_b16 a[118:119], v14 offset:12288
    v_mfma_f32_16x16x32_bf16 v[68:71], a[92:95], a[12:15], v[48:51]
    ds_read_b64_tr_b16 a[120:121], v15 offset:0
    v_mfma_f32_16x16x32_bf16 v[68:71], a[88:91], a[8:11], v[68:71]
    ds_read_b64_tr_b16 a[122:123], v15 offset:4096
    v_mfma_f32_16x16x32_bf16 v[68:71], a[84:87], a[4:7], v[68:71]
    ds_read_b64_tr_b16 a[124:125], v15 offset:8192
    v_mfma_f32_16x16x32_bf16 v[68:71], a[80:83], a[0:3], v[68:71]
    ds_read_b64_tr_b16 a[126:127], v15 offset:12288
    v_mfma_f32_16x16x32_bf16 v[76:79], a[80:83], a[16:19], v[52:55]
    v_exp_f32 v40, v64
    v_mfma_f32_16x16x32_bf16 v[76:79], a[84:87], a[20:23], v[76:79]
    v_exp_f32 v41, v65
    v_mfma_f32_16x16x32_bf16 v[76:79], a[88:91], a[24:27], v[76:79]
    v_exp_f32 v42, v66
    v_mfma_f32_16x16x32_bf16 v[76:79], a[92:95], a[28:31], v[76:79]
    v_exp_f32 v43, v67
    v_mfma_f32_16x16x32_bf16 v[72:75], a[76:79], a[28:31], v[52:55]
    v_cvt_pk_bf16_f32 v128, v40, v41
    v_cvt_pk_bf16_f32 v129, v42, v43
    v_mfma_f32_16x16x32_bf16 v[72:75], a[72:75], a[24:27], v[72:75]
    v_exp_f32 v44, v68
    v_mfma_f32_16x16x32_bf16 v[72:75], a[68:71], a[20:23], v[72:75]
    v_exp_f32 v45, v69
    v_mfma_f32_16x16x32_bf16 v[72:75], a[64:67], a[16:19], v[72:75]
    v_exp_f32 v46, v70
    v_mfma_f32_16x16x32_bf16 v[80:83], a[64:67], a[32:35], v[56:59]
    v_exp_f32 v47, v71
    v_mfma_f32_16x16x32_bf16 v[80:83], a[68:71], a[36:39], v[80:83]
    v_cvt_pk_bf16_f32 v130, v44, v45
    v_cvt_pk_bf16_f32 v131, v46, v47
    v_mfma_f32_16x16x32_bf16 v[80:83], a[72:75], a[40:43], v[80:83]
    v_exp_f32 v40, v76
    v_mfma_f32_16x16x32_bf16 v[80:83], a[76:79], a[44:47], v[80:83]
    v_exp_f32 v41, v77
    v_mfma_f32_16x16x32_bf16 v[84:87], a[92:95], a[44:47], v[56:59]
    v_exp_f32 v42, v78
    v_mfma_f32_16x16x32_bf16 v[84:87], a[88:91], a[40:43], v[84:87]
    v_exp_f32 v43, v79
    v_mfma_f32_16x16x32_bf16 v[84:87], a[84:87], a[36:39], v[84:87]
    v_cvt_pk_bf16_f32 v134, v40, v41
    v_cvt_pk_bf16_f32 v135, v42, v43
    v_mfma_f32_16x16x32_bf16 v[84:87], a[80:83], a[32:35], v[84:87]
    v_exp_f32 v44, v72
    v_mfma_f32_16x16x32_bf16 v[92:95], a[80:83], a[48:51], v[60:63]
    v_exp_f32 v45, v73
    v_mfma_f32_16x16x32_bf16 v[92:95], a[84:87], a[52:55], v[92:95]
    v_exp_f32 v46, v74
    v_mfma_f32_16x16x32_bf16 v[92:95], a[88:91], a[56:59], v[92:95]
    v_exp_f32 v47, v75
    v_mfma_f32_16x16x32_bf16 v[92:95], a[92:95], a[60:63], v[92:95]
    v_cvt_pk_bf16_f32 v132, v44, v45
    v_cvt_pk_bf16_f32 v133, v46, v47
    v_mfma_f32_16x16x32_bf16 v[88:91], a[76:79], a[60:63], v[60:63]
    v_exp_f32 v40, v80
    v_mfma_f32_16x16x32_bf16 v[88:91], a[72:75], a[56:59], v[88:91]
    v_exp_f32 v41, v81
    v_mfma_f32_16x16x32_bf16 v[88:91], a[68:71], a[52:55], v[88:91]
    v_exp_f32 v42, v82
    v_mfma_f32_16x16x32_bf16 v[88:91], a[64:67], a[48:51], v[88:91]
    s_waitcnt lgkmcnt(0)
    v_exp_f32 v43, v83
    v_smfmac_f32_16x16x64_bf16 a[132:135], a[136:139], v[120:127], v27
    v_cvt_pk_bf16_f32 v136, v40, v41
    v_smfmac_f32_16x16x64_bf16 a[128:131], a[136:139], v[112:119], v27
    ds_read_b128 a[64:67], v8 offset:24576
    v_cvt_pk_bf16_f32 v137, v42, v43
    v_mfma_f32_16x16x32_bf16 v[160:163], a[96:99], v[96:99], v[160:163]
    v_exp_f32 v44, v84
    v_mfma_f32_16x16x32_bf16 v[160:163], a[100:103], v[112:115], v[160:163]
    s_add_u32 m0, s31, 98304
    v_exp_f32 v45, v85
    v_mfma_f32_16x16x32_bf16 v[184:187], a[100:103], v[116:119], v[184:187]
    ds_read_b128 a[68:71], v9 offset:24576
    v_cvt_pk_bf16_f32 v138, v44, v45
    v_mfma_f32_16x16x32_bf16 v[184:187], a[96:99], v[100:103], v[184:187]
    buffer_load_dwordx4 v24, s[20:23], s39 offen offset:0 lds
    v_mfma_f32_16x16x32_bf16 v[208:211], a[96:99], v[104:107], v[208:211]
    v_exp_f32 v46, v86
    v_mfma_f32_16x16x32_bf16 v[208:211], a[100:103], v[120:123], v[208:211]
    v_exp_f32 v47, v87
    v_mfma_f32_16x16x32_bf16 v[232:235], a[100:103], v[124:127], v[232:235]
    ds_read_b128 a[72:75], v10 offset:24576
    v_cvt_pk_bf16_f32 v139, v46, v47
    v_mfma_f32_16x16x32_bf16 v[232:235], a[96:99], v[108:111], v[232:235]
    v_exp_f32 v40, v92
    v_mfma_f32_16x16x32_bf16 v[236:239], a[104:107], v[108:111], v[236:239]
    buffer_load_dwordx4 v25, s[20:23], s39 offen offset:1024 lds
    v_mfma_f32_16x16x32_bf16 v[236:239], a[108:111], v[124:127], v[236:239]
    v_exp_f32 v41, v93
    v_mfma_f32_16x16x32_bf16 v[212:215], a[108:111], v[120:123], v[212:215]
    ds_read_b128 a[76:79], v11 offset:24576
    v_cvt_pk_bf16_f32 v142, v40, v41
    v_mfma_f32_16x16x32_bf16 v[212:215], a[104:107], v[104:107], v[212:215]
    v_exp_f32 v42, v94
    v_mfma_f32_16x16x32_bf16 v[188:191], a[104:107], v[100:103], v[188:191]
    v_exp_f32 v43, v95
    v_mfma_f32_16x16x32_bf16 v[188:191], a[108:111], v[116:119], v[188:191]
    buffer_load_dwordx4 v24, s[20:23], s39 offen offset:2048 lds
    v_mfma_f32_16x16x32_bf16 v[164:167], a[108:111], v[112:115], v[164:167]
    ds_read_b128 a[80:83], v8 offset:28672
    v_cvt_pk_bf16_f32 v143, v42, v43
    v_mfma_f32_16x16x32_bf16 v[164:167], a[104:107], v[96:99], v[164:167]
    v_exp_f32 v44, v88
    v_mfma_f32_16x16x32_bf16 v[168:171], a[112:115], v[96:99], v[168:171]
    v_exp_f32 v45, v89
    v_mfma_f32_16x16x32_bf16 v[168:171], a[116:119], v[112:115], v[168:171]
    ds_read_b128 a[84:87], v9 offset:28672
    v_cvt_pk_bf16_f32 v140, v44, v45
    v_mfma_f32_16x16x32_bf16 v[192:195], a[116:119], v[116:119], v[192:195]
    buffer_load_dwordx4 v25, s[20:23], s39 offen offset:3072 lds
    v_mfma_f32_16x16x32_bf16 v[192:195], a[112:115], v[100:103], v[192:195]
    v_exp_f32 v46, v90
    v_mfma_f32_16x16x32_bf16 v[216:219], a[112:115], v[104:107], v[216:219]
    v_exp_f32 v47, v91
    v_mfma_f32_16x16x32_bf16 v[216:219], a[116:119], v[120:123], v[216:219]
    ds_read_b128 a[88:91], v10 offset:28672
    v_cvt_pk_bf16_f32 v141, v46, v47
    v_mfma_f32_16x16x32_bf16 v[240:243], a[116:119], v[124:127], v[240:243]
    ds_read_b128 a[92:95], v11 offset:28672
    v_mfma_f32_16x16x32_bf16 v[240:243], a[112:115], v[108:111], v[240:243]
    ds_read_b64_tr_b16 a[96:97], v16 offset:0
    ds_read_b64_tr_b16 a[98:99], v16 offset:4096
    v_mfma_f32_16x16x32_bf16 v[244:247], a[120:123], v[108:111], v[244:247]
    ds_read_b64_tr_b16 a[100:101], v16 offset:8192
    v_mfma_f32_16x16x32_bf16 v[244:247], a[124:127], v[124:127], v[244:247]
    ds_read_b64_tr_b16 a[102:103], v16 offset:12288
    v_mfma_f32_16x16x32_bf16 v[220:223], a[124:127], v[120:123], v[220:223]
    s_add_u32 s39, s39, 16384
    ds_read_b64_tr_b16 a[104:105], v17 offset:0
    v_mfma_f32_16x16x32_bf16 v[220:223], a[120:123], v[104:107], v[220:223]
    ds_read_b64_tr_b16 a[106:107], v17 offset:4096
    v_mfma_f32_16x16x32_bf16 v[196:199], a[120:123], v[100:103], v[196:199]
    ds_read_b64_tr_b16 a[108:109], v17 offset:8192
    v_mfma_f32_16x16x32_bf16 v[196:199], a[124:127], v[116:119], v[196:199]
    ds_read_b64_tr_b16 a[110:111], v17 offset:12288
    v_mfma_f32_16x16x32_bf16 v[172:175], a[124:127], v[112:115], v[172:175]
    v_mfma_f32_16x16x32_bf16 v[172:175], a[120:123], v[96:99], v[172:175]
    s_waitcnt lgkmcnt(8)
    v_mfma_f32_16x16x32_bf16 v[64:67], a[64:67], a[0:3], v[48:51]
    ds_read_b64_tr_b16 a[112:113], v18 offset:0
    v_mfma_f32_16x16x32_bf16 v[64:67], a[68:71], a[4:7], v[64:67]
    ds_read_b64_tr_b16 a[114:115], v18 offset:4096
    v_mfma_f32_16x16x32_bf16 v[64:67], a[72:75], a[8:11], v[64:67]
    ds_read_b64_tr_b16 a[116:117], v18 offset:8192
    v_mfma_f32_16x16x32_bf16 v[64:67], a[76:79], a[12:15], v[64:67]
    ds_read_b64_tr_b16 a[118:119], v18 offset:12288
    v_mfma_f32_16x16x32_bf16 v[68:71], a[92:95], a[12:15], v[48:51]
    ds_read_b64_tr_b16 a[120:121], v19 offset:0
    v_mfma_f32_16x16x32_bf16 v[68:71], a[88:91], a[8:11], v[68:71]
    ds_read_b64_tr_b16 a[122:123], v19 offset:4096
    v_mfma_f32_16x16x32_bf16 v[68:71], a[84:87], a[4:7], v[68:71]
    ds_read_b64_tr_b16 a[124:125], v19 offset:8192
    v_mfma_f32_16x16x32_bf16 v[68:71], a[80:83], a[0:3], v[68:71]
    ds_read_b64_tr_b16 a[126:127], v19 offset:12288
    v_mfma_f32_16x16x32_bf16 v[76:79], a[80:83], a[16:19], v[52:55]
    v_exp_f32 v40, v64
    v_mfma_f32_16x16x32_bf16 v[76:79], a[84:87], a[20:23], v[76:79]
    v_exp_f32 v41, v65
    v_mfma_f32_16x16x32_bf16 v[76:79], a[88:91], a[24:27], v[76:79]
    v_exp_f32 v42, v66
    v_mfma_f32_16x16x32_bf16 v[76:79], a[92:95], a[28:31], v[76:79]
    v_exp_f32 v43, v67
    v_mfma_f32_16x16x32_bf16 v[72:75], a[76:79], a[28:31], v[52:55]
    v_cvt_pk_bf16_f32 v144, v40, v41
    v_cvt_pk_bf16_f32 v145, v42, v43
    v_mfma_f32_16x16x32_bf16 v[72:75], a[72:75], a[24:27], v[72:75]
    v_exp_f32 v44, v68
    v_mfma_f32_16x16x32_bf16 v[72:75], a[68:71], a[20:23], v[72:75]
    v_exp_f32 v45, v69
    v_mfma_f32_16x16x32_bf16 v[72:75], a[64:67], a[16:19], v[72:75]
    v_exp_f32 v46, v70
    v_mfma_f32_16x16x32_bf16 v[80:83], a[64:67], a[32:35], v[56:59]
    v_exp_f32 v47, v71
    v_mfma_f32_16x16x32_bf16 v[80:83], a[68:71], a[36:39], v[80:83]
    v_cvt_pk_bf16_f32 v146, v44, v45
    v_cvt_pk_bf16_f32 v147, v46, v47
    v_mfma_f32_16x16x32_bf16 v[80:83], a[72:75], a[40:43], v[80:83]
    v_exp_f32 v40, v76
    v_mfma_f32_16x16x32_bf16 v[80:83], a[76:79], a[44:47], v[80:83]
    v_exp_f32 v41, v77
    v_mfma_f32_16x16x32_bf16 v[84:87], a[92:95], a[44:47], v[56:59]
    v_exp_f32 v42, v78
    v_mfma_f32_16x16x32_bf16 v[84:87], a[88:91], a[40:43], v[84:87]
    v_exp_f32 v43, v79
    v_mfma_f32_16x16x32_bf16 v[84:87], a[84:87], a[36:39], v[84:87]
    v_cvt_pk_bf16_f32 v150, v40, v41
    v_cvt_pk_bf16_f32 v151, v42, v43
    v_mfma_f32_16x16x32_bf16 v[84:87], a[80:83], a[32:35], v[84:87]
    v_exp_f32 v44, v72
    v_mfma_f32_16x16x32_bf16 v[92:95], a[80:83], a[48:51], v[60:63]
    v_exp_f32 v45, v73
    v_mfma_f32_16x16x32_bf16 v[92:95], a[84:87], a[52:55], v[92:95]
    v_exp_f32 v46, v74
    v_mfma_f32_16x16x32_bf16 v[92:95], a[88:91], a[56:59], v[92:95]
    v_exp_f32 v47, v75
    v_mfma_f32_16x16x32_bf16 v[92:95], a[92:95], a[60:63], v[92:95]
    v_cvt_pk_bf16_f32 v148, v44, v45
    v_cvt_pk_bf16_f32 v149, v46, v47
    v_mfma_f32_16x16x32_bf16 v[88:91], a[76:79], a[60:63], v[60:63]
    v_exp_f32 v40, v80
    v_mfma_f32_16x16x32_bf16 v[88:91], a[72:75], a[56:59], v[88:91]
    v_exp_f32 v41, v81
    v_mfma_f32_16x16x32_bf16 v[88:91], a[68:71], a[52:55], v[88:91]
    v_exp_f32 v42, v82
    v_mfma_f32_16x16x32_bf16 v[88:91], a[64:67], a[48:51], v[88:91]
    s_waitcnt vmcnt(8) lgkmcnt(0)
    v_exp_f32 v43, v83
    v_smfmac_f32_16x16x64_bf16 a[132:135], a[136:139], v[136:143], v27
    s_barrier
    v_smfmac_f32_16x16x64_bf16 a[128:131], a[136:139], v[128:135], v27
    ds_read_b128 a[64:67], v8 offset:32768
    v_cvt_pk_bf16_f32 v152, v40, v41
    v_mfma_f32_16x16x32_bf16 v[176:179], a[96:99], v[96:99], v[176:179]
    ds_read_b128 a[68:71], v9 offset:32768
    v_cvt_pk_bf16_f32 v153, v42, v43
    v_mfma_f32_16x16x32_bf16 v[176:179], a[100:103], v[112:115], v[176:179]
    v_exp_f32 v44, v84
    v_mfma_f32_16x16x32_bf16 v[200:203], a[100:103], v[116:119], v[200:203]
    s_add_u32 m0, s31, 0
    v_exp_f32 v45, v85
    v_mfma_f32_16x16x32_bf16 v[200:203], a[96:99], v[100:103], v[200:203]
    buffer_load_dwordx4 v20, s[16:19], s32 offen offset:0 lds
    v_mfma_f32_16x16x32_bf16 v[224:227], a[96:99], v[104:107], v[224:227]
    ds_read_b128 a[72:75], v10 offset:32768
    v_cvt_pk_bf16_f32 v154, v44, v45
    v_mfma_f32_16x16x32_bf16 v[224:227], a[100:103], v[120:123], v[224:227]
    v_exp_f32 v46, v86
    v_mfma_f32_16x16x32_bf16 v[248:251], a[100:103], v[124:127], v[248:251]
    v_exp_f32 v47, v87
    v_mfma_f32_16x16x32_bf16 v[248:251], a[96:99], v[108:111], v[248:251]
    ds_read_b128 a[76:79], v11 offset:32768
    v_cvt_pk_bf16_f32 v155, v46, v47
    v_mfma_f32_16x16x32_bf16 v[252:255], a[104:107], v[108:111], v[252:255]
    buffer_load_dwordx4 v21, s[16:19], s32 offen offset:1024 lds
    v_mfma_f32_16x16x32_bf16 v[252:255], a[108:111], v[124:127], v[252:255]
    v_exp_f32 v40, v92
    v_mfma_f32_16x16x32_bf16 v[228:231], a[108:111], v[120:123], v[228:231]
    v_exp_f32 v41, v93
    v_mfma_f32_16x16x32_bf16 v[228:231], a[104:107], v[104:107], v[228:231]
    ds_read_b128 a[80:83], v8 offset:36864
    v_cvt_pk_bf16_f32 v158, v40, v41
    v_mfma_f32_16x16x32_bf16 v[204:207], a[104:107], v[100:103], v[204:207]
    v_exp_f32 v42, v94
    v_mfma_f32_16x16x32_bf16 v[204:207], a[108:111], v[116:119], v[204:207]
    buffer_load_dwordx4 v22, s[16:19], s32 offen offset:2048 lds
    v_mfma_f32_16x16x32_bf16 v[180:183], a[108:111], v[112:115], v[180:183]
    v_exp_f32 v43, v95
    v_mfma_f32_16x16x32_bf16 v[180:183], a[104:107], v[96:99], v[180:183]
    ds_read_b128 a[84:87], v9 offset:36864
    v_cvt_pk_bf16_f32 v159, v42, v43
    v_mfma_f32_16x16x32_bf16 a[224:227], a[112:115], v[96:99], a[224:227]
    v_exp_f32 v44, v88
    v_mfma_f32_16x16x32_bf16 a[224:227], a[116:119], v[112:115], a[224:227]
    v_exp_f32 v45, v89
    v_mfma_f32_16x16x32_bf16 a[232:235], a[116:119], v[116:119], a[232:235]
    buffer_load_dwordx4 v23, s[16:19], s32 offen offset:3072 lds
    v_mfma_f32_16x16x32_bf16 a[232:235], a[112:115], v[100:103], a[232:235]
    ds_read_b128 a[88:91], v10 offset:36864
    v_cvt_pk_bf16_f32 v156, v44, v45
    v_mfma_f32_16x16x32_bf16 a[240:243], a[112:115], v[104:107], a[240:243]
    v_exp_f32 v46, v90
    v_mfma_f32_16x16x32_bf16 a[240:243], a[116:119], v[120:123], a[240:243]
    v_exp_f32 v47, v91
    v_mfma_f32_16x16x32_bf16 a[248:251], a[116:119], v[124:127], a[248:251]
    ds_read_b128 a[92:95], v11 offset:36864
    v_cvt_pk_bf16_f32 v157, v46, v47
    v_mfma_f32_16x16x32_bf16 a[248:251], a[112:115], v[108:111], a[248:251]
    ds_read_b64_tr_b16 a[96:97], v12 offset:16384
    ds_read_b64_tr_b16 a[98:99], v12 offset:20480
    v_mfma_f32_16x16x32_bf16 a[252:255], a[120:123], v[108:111], a[252:255]
    ds_read_b64_tr_b16 a[100:101], v12 offset:24576
    v_mfma_f32_16x16x32_bf16 a[252:255], a[124:127], v[124:127], a[252:255]
    ds_read_b64_tr_b16 a[102:103], v12 offset:28672
    v_mfma_f32_16x16x32_bf16 a[244:247], a[124:127], v[120:123], a[244:247]
    s_add_u32 s32, s32, 16384
    ds_read_b64_tr_b16 a[104:105], v13 offset:16384
    v_mfma_f32_16x16x32_bf16 a[244:247], a[120:123], v[104:107], a[244:247]
    ds_read_b64_tr_b16 a[106:107], v13 offset:20480
    v_mfma_f32_16x16x32_bf16 a[236:239], a[120:123], v[100:103], a[236:239]
    ds_read_b64_tr_b16 a[108:109], v13 offset:24576
    v_mfma_f32_16x16x32_bf16 a[236:239], a[124:127], v[116:119], a[236:239]
    ds_read_b64_tr_b16 a[110:111], v13 offset:28672
    v_mfma_f32_16x16x32_bf16 a[228:231], a[124:127], v[112:115], a[228:231]
    s_add_u32 s38, s38, s38
    v_mfma_f32_16x16x32_bf16 a[228:231], a[120:123], v[96:99], a[228:231]
    s_waitcnt lgkmcnt(8)
    s_cbranch_scc1 L_hookA
L_retA:
    v_mfma_f32_16x16x32_bf16 v[64:67], a[64:67], a[0:3], v[48:51]
    ds_read_b64_tr_b16 a[112:113], v14 offset:16384
    v_mfma_f32_16x16x32_bf16 v[64:67], a[68:71], a[4:7], v[64:67]
    ds_read_b64_tr_b16 a[114:115], v14 offset:20480
    v_mfma_f32_16x16x32_bf16 v[64:67], a[72:75], a[8:11], v[64:67]
    ds_read_b64_tr_b16 a[116:117], v14 offset:24576
    v_mfma_f32_16x16x32_bf16 v[64:67], a[76:79], a[12:15], v[64:67]
    ds_read_b64_tr_b16 a[118:119], v14 offset:28672
    v_mfma_f32_16x16x32_bf16 v[68:71], a[92:95], a[12:15], v[48:51]
    ds_read_b64_tr_b16 a[120:121], v15 offset:16384
    v_mfma_f32_16x16x32_bf16 v[68:71], a[88:91], a[8:11], v[68:71]
    ds_read_b64_tr_b16 a[122:123], v15 offset:20480
    v_mfma_f32_16x16x32_bf16 v[68:71], a[84:87], a[4:7], v[68:71]
    ds_read_b64_tr_b16 a[124:125], v15 offset:24576
    v_mfma_f32_16x16x32_bf16 v[68:71], a[80:83], a[0:3], v[68:71]
    ds_read_b64_tr_b16 a[126:127], v15 offset:28672
    v_mfma_f32_16x16x32_bf16 v[76:79], a[80:83], a[16:19], v[52:55]
    v_exp_f32 v40, v64
    v_mfma_f32_16x16x32_bf16 v[76:79], a[84:87], a[20:23], v[76:79]
    v_exp_f32 v41, v65
    v_mfma_f32_16x16x32_bf16 v[76:79], a[88:91], a[24:27], v[76:79]
    v_exp_f32 v42, v66
    v_mfma_f32_16x16x32_bf16 v[76:79], a[92:95], a[28:31], v[76:79]
    v_exp_f32 v43, v67
    v_mfma_f32_16x16x32_bf16 v[72:75], a[76:79], a[28:31], v[52:55]
    v_cvt_pk_bf16_f32 v96, v40, v41
    v_cvt_pk_bf16_f32 v97, v42, v43
    v_mfma_f32_16x16x32_bf16 v[72:75], a[72:75], a[24:27], v[72:75]
    v_exp_f32 v44, v68
    v_mfma_f32_16x16x32_bf16 v[72:75], a[68:71], a[20:23], v[72:75]
    v_exp_f32 v45, v69
    v_mfma_f32_16x16x32_bf16 v[72:75], a[64:67], a[16:19], v[72:75]
    v_exp_f32 v46, v70
    v_mfma_f32_16x16x32_bf16 v[80:83], a[64:67], a[32:35], v[56:59]
    v_exp_f32 v47, v71
    v_mfma_f32_16x16x32_bf16 v[80:83], a[68:71], a[36:39], v[80:83]
    v_cvt_pk_bf16_f32 v98, v44, v45
    v_cvt_pk_bf16_f32 v99, v46, v47
    v_mfma_f32_16x16x32_bf16 v[80:83], a[72:75], a[40:43], v[80:83]
    v_exp_f32 v40, v76
    v_mfma_f32_16x16x32_bf16 v[80:83], a[76:79], a[44:47], v[80:83]
    v_exp_f32 v41, v77
    v_mfma_f32_16x16x32_bf16 v[84:87], a[92:95], a[44:47], v[56:59]
    v_exp_f32 v42, v78
    v_mfma_f32_16x16x32_bf16 v[84:87], a[88:91], a[40:43], v[84:87]
    v_exp_f32 v43, v79
    v_mfma_f32_16x16x32_bf16 v[84:87], a[84:87], a[36:39], v[84:87]
    v_cvt_pk_bf16_f32 v102, v40, v41
    v_cvt_pk_bf16_f32 v103, v42, v43
    v_mfma_f32_16x16x32_bf16 v[84:87], a[80:83], a[32:35], v[84:87]
    v_exp_f32 v44, v72
    v_mfma_f32_16x16x32_bf16 v[92:95], a[80:83], a[48:51], v[60:63]
    v_exp_f32 v45, v73
    v_mfma_f32_16x16x32_bf16 v[92:95], a[84:87], a[52:55], v[92:95]
    v_exp_f32 v46, v74
    v_mfma_f32_16x16x32_bf16 v[92:95], a[88:91], a[56:59], v[92:95]
    v_exp_f32 v47, v75
    v_mfma_f32_16x16x32_bf16 v[92:95], a[92:95], a[60:63], v[92:95]
    v_cvt_pk_bf16_f32 v100, v44, v45
    v_cvt_pk_bf16_f32 v101, v46, v47
    v_mfma_f32_16x16x32_bf16 v[88:91], a[76:79], a[60:63], v[60:63]
    v_exp_f32 v40, v80
    v_mfma_f32_16x16x32_bf16 v[88:91], a[72:75], a[56:59], v[88:91]
    v_exp_f32 v41, v81
    v_mfma_f32_16x16x32_bf16 v[88:91], a[68:71], a[52:55], v[88:91]
    v_exp_f32 v42, v82
    v_mfma_f32_16x16x32_bf16 v[88:91], a[64:67], a[48:51], v[88:91]
    s_waitcnt lgkmcnt(0)
    v_exp_f32 v43, v83
    v_smfmac_f32_16x16x64_bf16 a[132:135], a[136:139], v[152:159], v27
    v_cvt_pk_bf16_f32 v104, v40, v41
    v_smfmac_f32_16x16x64_bf16 a[128:131], a[136:139], v[144:151], v27
    ds_read_b128 a[64:67], v8 offset:40960
    v_cvt_pk_bf16_f32 v105, v42, v43
    v_mfma_f32_16x16x32_bf16 v[160:163], a[96:99], v[128:131], v[160:163]
    v_exp_f32 v44, v84
    v_mfma_f32_16x16x32_bf16 v[160:163], a[100:103], v[144:147], v[160:163]
    s_add_u32 m0, s31, 114688
    v_exp_f32 v45, v85
    v_mfma_f32_16x16x32_bf16 v[184:187], a[100:103], v[148:151], v[184:187]
    ds_read_b128 a[68:71], v9 offset:40960
    v_cvt_pk_bf16_f32 v106, v44, v45
    v_mfma_f32_16x16x32_bf16 v[184:187], a[96:99], v[132:135], v[184:187]
    buffer_load_dwordx4 v24, s[20:23], s39 offen offset:0 lds
    v_mfma_f32_16x16x32_bf16 v[208:211], a[96:99], v[136:139], v[208:211]
    v_exp_f32 v46, v86
    v_mfma_f32_16x16x32_bf16 v[208:211], a[100:103], v[152:155], v[208:211]
    v_exp_f32 v47, v87
    v_mfma_f32_16x16x32_bf16 v[232:235], a[100:103], v[156:159], v[232:235]
    ds_read_b128 a[72:75], v10 offset:40960
    v_cvt_pk_bf16_f32 v107, v46, v47
    v_mfma_f32_16x16x32_bf16 v[232:235], a[96:99], v[140:143], v[232:235]
    v_exp_f32 v40, v92
    v_mfma_f32_16x16x32_bf16 v[236:239], a[104:107], v[140:143], v[236:239]
    buffer_load_dwordx4 v25, s[20:23], s39 offen offset:1024 lds
    v_mfma_f32_16x16x32_bf16 v[236:239], a[108:111], v[156:159], v[236:239]
    v_exp_f32 v41, v93
    v_mfma_f32_16x16x32_bf16 v[212:215], a[108:111], v[152:155], v[212:215]
    ds_read_b128 a[76:79], v11 offset:40960
    v_cvt_pk_bf16_f32 v110, v40, v41
    v_mfma_f32_16x16x32_bf16 v[212:215], a[104:107], v[136:139], v[212:215]
    v_exp_f32 v42, v94
    v_mfma_f32_16x16x32_bf16 v[188:191], a[104:107], v[132:135], v[188:191]
    v_exp_f32 v43, v95
    v_mfma_f32_16x16x32_bf16 v[188:191], a[108:111], v[148:151], v[188:191]
    buffer_load_dwordx4 v24, s[20:23], s39 offen offset:2048 lds
    v_mfma_f32_16x16x32_bf16 v[164:167], a[108:111], v[144:147], v[164:167]
    ds_read_b128 a[80:83], v8 offset:45056
    v_cvt_pk_bf16_f32 v111, v42, v43
    v_mfma_f32_16x16x32_bf16 v[164:167], a[104:107], v[128:131], v[164:167]
    v_exp_f32 v44, v88
    v_mfma_f32_16x16x32_bf16 v[168:171], a[112:115], v[128:131], v[168:171]
    v_exp_f32 v45, v89
    v_mfma_f32_16x16x32_bf16 v[168:171], a[116:119], v[144:147], v[168:171]
    ds_read_b128 a[84:87], v9 offset:45056
    v_cvt_pk_bf16_f32 v108, v44, v45
    v_mfma_f32_16x16x32_bf16 v[192:195], a[116:119], v[148:151], v[192:195]
    buffer_load_dwordx4 v25, s[20:23], s39 offen offset:3072 lds
    v_mfma_f32_16x16x32_bf16 v[192:195], a[112:115], v[132:135], v[192:195]
    v_exp_f32 v46, v90
    v_mfma_f32_16x16x32_bf16 v[216:219], a[112:115], v[136:139], v[216:219]
    v_exp_f32 v47, v91
    v_mfma_f32_16x16x32_bf16 v[216:219], a[116:119], v[152:155], v[216:219]
    ds_read_b128 a[88:91], v10 offset:45056
    v_cvt_pk_bf16_f32 v109, v46, v47
    v_mfma_f32_16x16x32_bf16 v[240:243], a[116:119], v[156:159], v[240:243]
    ds_read_b128 a[92:95], v11 offset:45056
    v_mfma_f32_16x16x32_bf16 v[240:243], a[112:115], v[140:143], v[240:243]
    ds_read_b64_tr_b16 a[96:97], v16 offset:16384
    ds_read_b64_tr_b16 a[98:99], v16 offset:20480
    v_mfma_f32_16x16x32_bf16 v[244:247], a[120:123], v[140:143], v[244:247]
    ds_read_b64_tr_b16 a[100:101], v16 offset:24576
    v_mfma_f32_16x16x32_bf16 v[244:247], a[124:127], v[156:159], v[244:247]
    ds_read_b64_tr_b16 a[102:103], v16 offset:28672
    v_mfma_f32_16x16x32_bf16 v[220:223], a[124:127], v[152:155], v[220:223]
    s_add_u32 s39, s39, 16384
    ds_read_b64_tr_b16 a[104:105], v17 offset:16384
    v_mfma_f32_16x16x32_bf16 v[220:223], a[120:123], v[136:139], v[220:223]
    ds_read_b64_tr_b16 a[106:107], v17 offset:20480
    v_mfma_f32_16x16x32_bf16 v[196:199], a[120:123], v[132:135], v[196:199]
    ds_read_b64_tr_b16 a[108:109], v17 offset:24576
    v_mfma_f32_16x16x32_bf16 v[196:199], a[124:127], v[148:151], v[196:199]
    ds_read_b64_tr_b16 a[110:111], v17 offset:28672
    v_mfma_f32_16x16x32_bf16 v[172:175], a[124:127], v[144:147], v[172:175]
    v_mfma_f32_16x16x32_bf16 v[172:175], a[120:123], v[128:131], v[172:175]
    s_waitcnt lgkmcnt(8)
    v_mfma_f32_16x16x32_bf16 v[64:67], a[64:67], a[0:3], v[48:51]
    ds_read_b64_tr_b16 a[112:113], v18 offset:16384
    v_mfma_f32_16x16x32_bf16 v[64:67], a[68:71], a[4:7], v[64:67]
    ds_read_b64_tr_b16 a[114:115], v18 offset:20480
    v_mfma_f32_16x16x32_bf16 v[64:67], a[72:75], a[8:11], v[64:67]
    ds_read_b64_tr_b16 a[116:117], v18 offset:24576
    v_mfma_f32_16x16x32_bf16 v[64:67], a[76:79], a[12:15], v[64:67]
    ds_read_b64_tr_b16 a[118:119], v18 offset:28672
    v_mfma_f32_16x16x32_bf16 v[68:71], a[92:95], a[12:15], v[48:51]
    ds_read_b64_tr_b16 a[120:121], v19 offset:16384
    v_mfma_f32_16x16x32_bf16 v[68:71], a[88:91], a[8:11], v[68:71]
    ds_read_b64_tr_b16 a[122:123], v19 offset:20480
    v_mfma_f32_16x16x32_bf16 v[68:71], a[84:87], a[4:7], v[68:71]
    ds_read_b64_tr_b16 a[124:125], v19 offset:24576
    v_mfma_f32_16x16x32_bf16 v[68:71], a[80:83], a[0:3], v[68:71]
L_pad6:
    s_cbranch_execz L_pad10
    ds_read_b64_tr_b16 a[126:127], v19 offset:28672
    v_mfma_f32_16x16x32_bf16 v[76:79], a[80:83], a[16:19], v[52:55]
    v_exp_f32 v40, v64
    v_mfma_f32_16x16x32_bf16 v[76:79], a[84:87], a[20:23], v[76:79]
    v_exp_f32 v41, v65
    v_mfma_f32_16x16x32_bf16 v[76:79], a[88:91], a[24:27], v[76:79]
    v_exp_f32 v42, v66
    v_mfma_f32_16x16x32_bf16 v[76:79], a[92:95], a[28:31], v[76:79]
    v_exp_f32 v43, v67
    v_mfma_f32_16x16x32_bf16 v[72:75], a[76:79], a[28:31], v[52:55]
    v_cvt_pk_bf16_f32 v112, v40, v41
    v_cvt_pk_bf16_f32 v113, v42, v43
    v_mfma_f32_16x16x32_bf16 v[72:75], a[72:75], a[24:27], v[72:75]
    v_exp_f32 v44, v68
    v_mfma_f32_16x16x32_bf16 v[72:75], a[68:71], a[20:23], v[72:75]
    v_exp_f32 v45, v69
    v_mfma_f32_16x16x32_bf16 v[72:75], a[64:67], a[16:19], v[72:75]
    v_exp_f32 v46, v70
    v_mfma_f32_16x16x32_bf16 v[80:83], a[64:67], a[32:35], v[56:59]
    v_exp_f32 v47, v71
    v_mfma_f32_16x16x32_bf16 v[80:83], a[68:71], a[36:39], v[80:83]
    v_cvt_pk_bf16_f32 v114, v44, v45
    v_cvt_pk_bf16_f32 v115, v46, v47
    v_mfma_f32_16x16x32_bf16 v[80:83], a[72:75], a[40:43], v[80:83]
    v_exp_f32 v40, v76
    v_mfma_f32_16x16x32_bf16 v[80:83], a[76:79], a[44:47], v[80:83]
    v_exp_f32 v41, v77
    v_mfma_f32_16x16x32_bf16 v[84:87], a[92:95], a[44:47], v[56:59]
    v_exp_f32 v42, v78
    v_mfma_f32_16x16x32_bf16 v[84:87], a[88:91], a[40:43], v[84:87]
    v_exp_f32 v43, v79
    v_mfma_f32_16x16x32_bf16 v[84:87], a[84:87], a[36:39], v[84:87]
    v_cvt_pk_bf16_f32 v118, v40, v41
    v_cvt_pk_bf16_f32 v119, v42, v43
    v_mfma_f32_16x16x32_bf16 v[84:87], a[80:83], a[32:35], v[84:87]
    v_exp_f32 v44, v72
    v_mfma_f32_16x16x32_bf16 v[92:95], a[80:83], a[48:51], v[60:63]
    v_exp_f32 v45, v73
    v_mfma_f32_16x16x32_bf16 v[92:95], a[84:87], a[52:55], v[92:95]
    v_exp_f32 v46, v74
    v_mfma_f32_16x16x32_bf16 v[92:95], a[88:91], a[56:59], v[92:95]
    v_exp_f32 v47, v75
    v_mfma_f32_16x16x32_bf16 v[92:95], a[92:95], a[60:63], v[92:95]
    v_cvt_pk_bf16_f32 v116, v44, v45
    v_cvt_pk_bf16_f32 v117, v46, v47
    v_mfma_f32_16x16x32_bf16 v[88:91], a[76:79], a[60:63], v[60:63]
    v_exp_f32 v40, v80
    v_mfma_f32_16x16x32_bf16 v[88:91], a[72:75], a[56:59], v[88:91]
    v_exp_f32 v41, v81
    v_mfma_f32_16x16x32_bf16 v[88:91], a[68:71], a[52:55], v[88:91]
    v_exp_f32 v42, v82
    v_mfma_f32_16x16x32_bf16 v[88:91], a[64:67], a[48:51], v[88:91]
    s_waitcnt vmcnt(8) lgkmcnt(0)
    v_exp_f32 v43, v83
    v_smfmac_f32_16x16x64_bf16 a[132:135], a[136:139], v[104:111], v27
    s_barrier
    v_smfmac_f32_16x16x64_bf16 a[128:131], a[136:139], v[96:103], v27
    ds_read_b128 a[64:67], v8 offset:49152
    v_cvt_pk_bf16_f32 v120, v40, v41
    v_mfma_f32_16x16x32_bf16 v[176:179], a[96:99], v[128:131], v[176:179]
    ds_read_b128 a[68:71], v9 offset:49152
    v_cvt_pk_bf16_f32 v121, v42, v43
    v_mfma_f32_16x16x32_bf16 v[176:179], a[100:103], v[144:147], v[176:179]
    v_exp_f32 v44, v84
    v_mfma_f32_16x16x32_bf16 v[200:203], a[100:103], v[148:151], v[200:203]
    s_add_u32 m0, s31, 16384
    v_exp_f32 v45, v85
    v_mfma_f32_16x16x32_bf16 v[200:203], a[96:99], v[132:135], v[200:203]
    buffer_load_dwordx4 v20, s[16:19], s32 offen offset:0 lds
    v_mfma_f32_16x16x32_bf16 v[224:227], a[96:99], v[136:139], v[224:227]
    ds_read_b128 a[72:75], v10 offset:49152
    v_cvt_pk_bf16_f32 v122, v44, v45
    v_mfma_f32_16x16x32_bf16 v[224:227], a[100:103], v[152:155], v[224:227]
    v_exp_f32 v46, v86
    v_mfma_f32_16x16x32_bf16 v[248:251], a[100:103], v[156:159], v[248:251]
    v_exp_f32 v47, v87
    v_mfma_f32_16x16x32_bf16 v[248:251], a[96:99], v[140:143], v[248:251]
    ds_read_b128 a[76:79], v11 offset:49152
    v_cvt_pk_bf16_f32 v123, v46, v47
    v_mfma_f32_16x16x32_bf16 v[252:255], a[104:107], v[140:143], v[252:255]
    buffer_load_dwordx4 v21, s[16:19], s32 offen offset:1024 lds
    v_mfma_f32_16x16x32_bf16 v[252:255], a[108:111], v[156:159], v[252:255]
    v_exp_f32 v40, v92
    v_mfma_f32_16x16x32_bf16 v[228:231], a[108:111], v[152:155], v[228:231]
    v_exp_f32 v41, v93
    v_mfma_f32_16x16x32_bf16 v[228:231], a[104:107], v[136:139], v[228:231]
    ds_read_b128 a[80:83], v8 offset:53248
    v_cvt_pk_bf16_f32 v126, v40, v41
    v_mfma_f32_16x16x32_bf16 v[204:207], a[104:107], v[132:135], v[204:207]
    v_exp_f32 v42, v94
    v_mfma_f32_16x16x32_bf16 v[204:207], a[108:111], v[148:151], v[204:207]
    buffer_load_dwordx4 v22, s[16:19], s32 offen offset:2048 lds
    v_mfma_f32_16x16x32_bf16 v[180:183], a[108:111], v[144:147], v[180:183]
    v_exp_f32 v43, v95
    v_mfma_f32_16x16x32_bf16 v[180:183], a[104:107], v[128:131], v[180:183]
    ds_read_b128 a[84:87], v9 offset:53248
    v_cvt_pk_bf16_f32 v127, v42, v43
    v_mfma_f32_16x16x32_bf16 a[224:227], a[112:115], v[128:131], a[224:227]
    v_exp_f32 v44, v88
    v_mfma_f32_16x16x32_bf16 a[224:227], a[116:119], v[144:147], a[224:227]
    v_exp_f32 v45, v89
    v_mfma_f32_16x16x32_bf16 a[232:235], a[116:119], v[148:151], a[232:235]
    buffer_load_dwordx4 v23, s[16:19], s32 offen offset:3072 lds
    v_mfma_f32_16x16x32_bf16 a[232:235], a[112:115], v[132:135], a[232:235]
    ds_read_b128 a[88:91], v10 offset:53248
    v_cvt_pk_bf16_f32 v124, v44, v45
    v_mfma_f32_16x16x32_bf16 a[240:243], a[112:115], v[136:139], a[240:243]
    v_exp_f32 v46, v90
    v_mfma_f32_16x16x32_bf16 a[240:243], a[116:119], v[152:155], a[240:243]
    v_exp_f32 v47, v91
    v_mfma_f32_16x16x32_bf16 a[248:251], a[116:119], v[156:159], a[248:251]
    ds_read_b128 a[92:95], v11 offset:53248
    v_cvt_pk_bf16_f32 v125, v46, v47
    v_mfma_f32_16x16x32_bf16 a[248:251], a[112:115], v[140:143], a[248:251]
    ds_read_b64_tr_b16 a[96:97], v12 offset:32768
    ds_read_b64_tr_b16 a[98:99], v12 offset:36864
    v_mfma_f32_16x16x32_bf16 a[252:255], a[120:123], v[140:143], a[252:255]
    ds_read_b64_tr_b16 a[100:101], v12 offset:40960
    v_mfma_f32_16x16x32_bf16 a[252:255], a[124:127], v[156:159], a[252:255]
    ds_read_b64_tr_b16 a[102:103], v12 offset:45056
    v_mfma_f32_16x16x32_bf16 a[244:247], a[124:127], v[152:155], a[244:247]
    s_add_u32 s32, s32, 16384
    ds_read_b64_tr_b16 a[104:105], v13 offset:32768
    v_mfma_f32_16x16x32_bf16 a[244:247], a[120:123], v[136:139], a[244:247]
    ds_read_b64_tr_b16 a[106:107], v13 offset:36864
    v_mfma_f32_16x16x32_bf16 a[236:239], a[120:123], v[132:135], a[236:239]
    ds_read_b64_tr_b16 a[108:109], v13 offset:40960
    v_mfma_f32_16x16x32_bf16 a[236:239], a[124:127], v[148:151], a[236:239]
    ds_read_b64_tr_b16 a[110:111], v13 offset:45056
    v_mfma_f32_16x16x32_bf16 a[228:231], a[124:127], v[144:147], a[228:231]
    v_mfma_f32_16x16x32_bf16 a[228:231], a[120:123], v[128:131], a[228:231]
    s_waitcnt lgkmcnt(8)
    v_mfma_f32_16x16x32_bf16 v[64:67], a[64:67], a[0:3], v[48:51]
    ds_read_b64_tr_b16 a[112:113], v14 offset:32768
    v_mfma_f32_16x16x32_bf16 v[64:67], a[68:71], a[4:7], v[64:67]
    ds_read_b64_tr_b16 a[114:115], v14 offset:36864
    v_mfma_f32_16x16x32_bf16 v[64:67], a[72:75], a[8:11], v[64:67]
    ds_read_b64_tr_b16 a[116:117], v14 offset:40960
    v_mfma_f32_16x16x32_bf16 v[64:67], a[76:79], a[12:15], v[64:67]
    ds_read_b64_tr_b16 a[118:119], v14 offset:45056
    v_mfma_f32_16x16x32_bf16 v[68:71], a[92:95], a[12:15], v[48:51]
    ds_read_b64_tr_b16 a[120:121], v15 offset:32768
    v_mfma_f32_16x16x32_bf16 v[68:71], a[88:91], a[8:11], v[68:71]
    ds_read_b64_tr_b16 a[122:123], v15 offset:36864
    v_mfma_f32_16x16x32_bf16 v[68:71], a[84:87], a[4:7], v[68:71]
    ds_read_b64_tr_b16 a[124:125], v15 offset:40960
    v_mfma_f32_16x16x32_bf16 v[68:71], a[80:83], a[0:3], v[68:71]
    ds_read_b64_tr_b16 a[126:127], v15 offset:45056
    v_mfma_f32_16x16x32_bf16 v[76:79], a[80:83], a[16:19], v[52:55]
    v_exp_f32 v40, v64
    v_mfma_f32_16x16x32_bf16 v[76:79], a[84:87], a[20:23], v[76:79]
    v_exp_f32 v41, v65
    v_mfma_f32_16x16x32_bf16 v[76:79], a[88:91], a[24:27], v[76:79]
    v_exp_f32 v42, v66
    v_mfma_f32_16x16x32_bf16 v[76:79], a[92:95], a[28:31], v[76:79]
    v_exp_f32 v43, v67
    v_mfma_f32_16x16x32_bf16 v[72:75], a[76:79], a[28:31], v[52:55]
    v_cvt_pk_bf16_f32 v128, v40, v41
    v_cvt_pk_bf16_f32 v129, v42, v43
    v_mfma_f32_16x16x32_bf16 v[72:75], a[72:75], a[24:27], v[72:75]
    v_exp_f32 v44, v68
    v_mfma_f32_16x16x32_bf16 v[72:75], a[68:71], a[20:23], v[72:75]
    v_exp_f32 v45, v69
    v_mfma_f32_16x16x32_bf16 v[72:75], a[64:67], a[16:19], v[72:75]
    v_exp_f32 v46, v70
    v_mfma_f32_16x16x32_bf16 v[80:83], a[64:67], a[32:35], v[56:59]
    v_exp_f32 v47, v71
    v_mfma_f32_16x16x32_bf16 v[80:83], a[68:71], a[36:39], v[80:83]
    v_cvt_pk_bf16_f32 v130, v44, v45
    v_cvt_pk_bf16_f32 v131, v46, v47
    v_mfma_f32_16x16x32_bf16 v[80:83], a[72:75], a[40:43], v[80:83]
    v_exp_f32 v40, v76
    v_mfma_f32_16x16x32_bf16 v[80:83], a[76:79], a[44:47], v[80:83]
    v_exp_f32 v41, v77
    v_mfma_f32_16x16x32_bf16 v[84:87], a[92:95], a[44:47], v[56:59]
    v_exp_f32 v42, v78
    v_mfma_f32_16x16x32_bf16 v[84:87], a[88:91], a[40:43], v[84:87]
    v_exp_f32 v43, v79
    v_mfma_f32_16x16x32_bf16 v[84:87], a[84:87], a[36:39], v[84:87]
    v_cvt_pk_bf16_f32 v134, v40, v41
    v_cvt_pk_bf16_f32 v135, v42, v43
    v_mfma_f32_16x16x32_bf16 v[84:87], a[80:83], a[32:35], v[84:87]
    v_exp_f32 v44, v72
    v_mfma_f32_16x16x32_bf16 v[92:95], a[80:83], a[48:51], v[60:63]
    v_exp_f32 v45, v73
    v_mfma_f32_16x16x32_bf16 v[92:95], a[84:87], a[52:55], v[92:95]
    v_exp_f32 v46, v74
    v_mfma_f32_16x16x32_bf16 v[92:95], a[88:91], a[56:59], v[92:95]
    v_exp_f32 v47, v75
    v_mfma_f32_16x16x32_bf16 v[92:95], a[92:95], a[60:63], v[92:95]
    v_cvt_pk_bf16_f32 v132, v44, v45
    v_cvt_pk_bf16_f32 v133, v46, v47
    v_mfma_f32_16x16x32_bf16 v[88:91], a[76:79], a[60:63], v[60:63]
    v_exp_f32 v40, v80
    v_mfma_f32_16x16x32_bf16 v[88:91], a[72:75], a[56:59], v[88:91]
    v_exp_f32 v41, v81
    v_mfma_f32_16x16x32_bf16 v[88:91], a[68:71], a[52:55], v[88:91]
    v_exp_f32 v42, v82
    v_mfma_f32_16x16x32_bf16 v[88:91], a[64:67], a[48:51], v[88:91]
    s_waitcnt lgkmcnt(0)
    v_exp_f32 v43, v83
    v_smfmac_f32_16x16x64_bf16 a[132:135], a[136:139], v[120:127], v27
    v_cvt_pk_bf16_f32 v136, v40, v41
    v_smfmac_f32_16x16x64_bf16 a[128:131], a[136:139], v[112:119], v27
    ds_read_b128 a[64:67], v8 offset:57344
    v_cvt_pk_bf16_f32 v137, v42, v43
    v_mfma_f32_16x16x32_bf16 v[160:163], a[96:99], v[96:99], v[160:163]
    v_exp_f32 v44, v84
    v_mfma_f32_16x16x32_bf16 v[160:163], a[100:103], v[112:115], v[160:163]
    s_add_u32 m0, s31, 65536
    v_exp_f32 v45, v85
    v_mfma_f32_16x16x32_bf16 v[184:187], a[100:103], v[116:119], v[184:187]
    ds_read_b128 a[68:71], v9 offset:57344
    v_cvt_pk_bf16_f32 v138, v44, v45
    v_mfma_f32_16x16x32_bf16 v[184:187], a[96:99], v[100:103], v[184:187]
    buffer_load_dwordx4 v24, s[20:23], s39 offen offset:0 lds
    v_mfma_f32_16x16x32_bf16 v[208:211], a[96:99], v[104:107], v[208:211]
    v_exp_f32 v46, v86
    v_mfma_f32_16x16x32_bf16 v[208:211], a[100:103], v[120:123], v[208:211]
    v_exp_f32 v47, v87
    v_mfma_f32_16x16x32_bf16 v[232:235], a[100:103], v[124:127], v[232:235]
    ds_read_b128 a[72:75], v10 offset:57344
    v_cvt_pk_bf16_f32 v139, v46, v47
    v_mfma_f32_16x16x32_bf16 v[232:235], a[96:99], v[108:111], v[232:235]
    v_exp_f32 v40, v92
    v_mfma_f32_16x16x32_bf16 v[236:239], a[104:107], v[108:111], v[236:239]
    buffer_load_dwordx4 v25, s[20:23], s39 offen offset:1024 lds
    v_mfma_f32_16x16x32_bf16 v[236:239], a[108:111], v[124:127], v[236:239]
    v_exp_f32 v41, v93
    v_mfma_f32_16x16x32_bf16 v[212:215], a[108:111], v[120:123], v[212:215]
    ds_read_b128 a[76:79], v11 offset:57344
    v_cvt_pk_bf16_f32 v142, v40, v41
    v_mfma_f32_16x16x32_bf16 v[212:215], a[104:107], v[104:107], v[212:215]
    v_exp_f32 v42, v94
    v_mfma_f32_16x16x32_bf16 v[188:191], a[104:107], v[100:103], v[188:191]
    v_exp_f32 v43, v95
    v_mfma_f32_16x16x32_bf16 v[188:191], a[108:111], v[116:119], v[188:191]
    buffer_load_dwordx4 v24, s[20:23], s39 offen offset:2048 lds
    v_mfma_f32_16x16x32_bf16 v[164:167], a[108:111], v[112:115], v[164:167]
    ds_read_b128 a[80:83], v8 offset:61440
    v_cvt_pk_bf16_f32 v143, v42, v43
    v_mfma_f32_16x16x32_bf16 v[164:167], a[104:107], v[96:99], v[164:167]
    v_exp_f32 v44, v88
    v_mfma_f32_16x16x32_bf16 v[168:171], a[112:115], v[96:99], v[168:171]
    v_exp_f32 v45, v89
    v_mfma_f32_16x16x32_bf16 v[168:171], a[116:119], v[112:115], v[168:171]
    ds_read_b128 a[84:87], v9 offset:61440
    v_cvt_pk_bf16_f32 v140, v44, v45
    v_mfma_f32_16x16x32_bf16 v[192:195], a[116:119], v[116:119], v[192:195]
    buffer_load_dwordx4 v25, s[20:23], s39 offen offset:3072 lds
    v_mfma_f32_16x16x32_bf16 v[192:195], a[112:115], v[100:103], v[192:195]
    v_exp_f32 v46, v90
    v_mfma_f32_16x16x32_bf16 v[216:219], a[112:115], v[104:107], v[216:219]
    v_exp_f32 v47, v91
    v_mfma_f32_16x16x32_bf16 v[216:219], a[116:119], v[120:123], v[216:219]
    ds_read_b128 a[88:91], v10 offset:61440
    v_cvt_pk_bf16_f32 v141, v46, v47
    v_mfma_f32_16x16x32_bf16 v[240:243], a[116:119], v[124:127], v[240:243]
    ds_read_b128 a[92:95], v11 offset:61440
    v_mfma_f32_16x16x32_bf16 v[240:243], a[112:115], v[108:111], v[240:243]
    ds_read_b64_tr_b16 a[96:97], v16 offset:32768
    ds_read_b64_tr_b16 a[98:99], v16 offset:36864
    v_mfma_f32_16x16x32_bf16 v[244:247], a[120:123], v[108:111], v[244:247]
    ds_read_b64_tr_b16 a[100:101], v16 offset:40960
    v_mfma_f32_16x16x32_bf16 v[244:247], a[124:127], v[124:127], v[244:247]
    ds_read_b64_tr_b16 a[102:103], v16 offset:45056
    v_mfma_f32_16x16x32_bf16 v[220:223], a[124:127], v[120:123], v[220:223]
    s_add_u32 s39, s39, 16384
    ds_read_b64_tr_b16 a[104:105], v17 offset:32768
    v_mfma_f32_16x16x32_bf16 v[220:223], a[120:123], v[104:107], v[220:223]
    ds_read_b64_tr_b16 a[106:107], v17 offset:36864
    v_mfma_f32_16x16x32_bf16 v[196:199], a[120:123], v[100:103], v[196:199]
    ds_read_b64_tr_b16 a[108:109], v17 offset:40960
    v_mfma_f32_16x16x32_bf16 v[196:199], a[124:127], v[116:119], v[196:199]
    ds_read_b64_tr_b16 a[110:111], v17 offset:45056
    v_mfma_f32_16x16x32_bf16 v[172:175], a[124:127], v[112:115], v[172:175]
    v_mfma_f32_16x16x32_bf16 v[172:175], a[120:123], v[96:99], v[172:175]
    s_waitcnt lgkmcnt(8)
    v_mfma_f32_16x16x32_bf16 v[64:67], a[64:67], a[0:3], v[48:51]
    ds_read_b64_tr_b16 a[112:113], v18 offset:32768
    v_mfma_f32_16x16x32_bf16 v[64:67], a[68:71], a[4:7], v[64:67]
    ds_read_b64_tr_b16 a[114:115], v18 offset:36864
    v_mfma_f32_16x16x32_bf16 v[64:67], a[72:75], a[8:11], v[64:67]
    ds_read_b64_tr_b16 a[116:117], v18 offset:40960
    v_mfma_f32_16x16x32_bf16 v[64:67], a[76:79], a[12:15], v[64:67]
    ds_read_b64_tr_b16 a[118:119], v18 offset:45056
    v_mfma_f32_16x16x32_bf16 v[68:71], a[92:95], a[12:15], v[48:51]
    ds_read_b64_tr_b16 a[120:121], v19 offset:32768
    v_mfma_f32_16x16x32_bf16 v[68:71], a[88:91], a[8:11], v[68:71]
    ds_read_b64_tr_b16 a[122:123], v19 offset:36864
    v_mfma_f32_16x16x32_bf16 v[68:71], a[84:87], a[4:7], v[68:71]
    ds_read_b64_tr_b16 a[124:125], v19 offset:40960
    v_mfma_f32_16x16x32_bf16 v[68:71], a[80:83], a[0:3], v[68:71]
    ds_read_b64_tr_b16 a[126:127], v19 offset:45056
    v_mfma_f32_16x16x32_bf16 v[76:79], a[80:83], a[16:19], v[52:55]
    v_exp_f32 v40, v64
    v_mfma_f32_16x16x32_bf16 v[76:79], a[84:87], a[20:23], v[76:79]
    v_exp_f32 v41, v65
    v_mfma_f32_16x16x32_bf16 v[76:79], a[88:91], a[24:27], v[76:79]
    v_exp_f32 v42, v66
    v_mfma_f32_16x16x32_bf16 v[76:79], a[92:95], a[28:31], v[76:79]
    v_exp_f32 v43, v67
    v_mfma_f32_16x16x32_bf16 v[72:75], a[76:79], a[28:31], v[52:55]
    v_cvt_pk_bf16_f32 v144, v40, v41
    v_cvt_pk_bf16_f32 v145, v42, v43
    v_mfma_f32_16x16x32_bf16 v[72:75], a[72:75], a[24:27], v[72:75]
    v_exp_f32 v44, v68
    v_mfma_f32_16x16x32_bf16 v[72:75], a[68:71], a[20:23], v[72:75]
    v_exp_f32 v45, v69
    v_mfma_f32_16x16x32_bf16 v[72:75], a[64:67], a[16:19], v[72:75]
    v_exp_f32 v46, v70
    v_mfma_f32_16x16x32_bf16 v[80:83], a[64:67], a[32:35], v[56:59]
    v_exp_f32 v47, v71
    v_mfma_f32_16x16x32_bf16 v[80:83], a[68:71], a[36:39], v[80:83]
    v_cvt_pk_bf16_f32 v146, v44, v45
    v_cvt_pk_bf16_f32 v147, v46, v47
    v_mfma_f32_16x16x32_bf16 v[80:83], a[72:75], a[40:43], v[80:83]
    v_exp_f32 v40, v76
    v_mfma_f32_16x16x32_bf16 v[80:83], a[76:79], a[44:47], v[80:83]
    v_exp_f32 v41, v77
    v_mfma_f32_16x16x32_bf16 v[84:87], a[92:95], a[44:47], v[56:59]
    v_exp_f32 v42, v78
    v_mfma_f32_16x16x32_bf16 v[84:87], a[88:91], a[40:43], v[84:87]
    v_exp_f32 v43, v79
    v_mfma_f32_16x16x32_bf16 v[84:87], a[84:87], a[36:39], v[84:87]
    v_cvt_pk_bf16_f32 v150, v40, v41
    v_cvt_pk_bf16_f32 v151, v42, v43
    v_mfma_f32_16x16x32_bf16 v[84:87], a[80:83], a[32:35], v[84:87]
    v_exp_f32 v44, v72
    v_mfma_f32_16x16x32_bf16 v[92:95], a[80:83], a[48:51], v[60:63]
    v_exp_f32 v45, v73
    v_mfma_f32_16x16x32_bf16 v[92:95], a[84:87], a[52:55], v[92:95]
    v_exp_f32 v46, v74
    v_mfma_f32_16x16x32_bf16 v[92:95], a[88:91], a[56:59], v[92:95]
    v_exp_f32 v47, v75
    v_mfma_f32_16x16x32_bf16 v[92:95], a[92:95], a[60:63], v[92:95]
    v_cvt_pk_bf16_f32 v148, v44, v45
    v_cvt_pk_bf16_f32 v149, v46, v47
    v_mfma_f32_16x16x32_bf16 v[88:91], a[76:79], a[60:63], v[60:63]
    v_exp_f32 v40, v80
    v_mfma_f32_16x16x32_bf16 v[88:91], a[72:75], a[56:59], v[88:91]
    v_exp_f32 v41, v81
    v_mfma_f32_16x16x32_bf16 v[88:91], a[68:71], a[52:55], v[88:91]
    v_exp_f32 v42, v82
    v_mfma_f32_16x16x32_bf16 v[88:91], a[64:67], a[48:51], v[88:91]
    s_waitcnt vmcnt(8) lgkmcnt(0)
    v_exp_f32 v43, v83
    v_smfmac_f32_16x16x64_bf16 a[132:135], a[136:139], v[136:143], v27
    s_barrier
    v_smfmac_f32_16x16x64_bf16 a[128:131], a[136:139], v[128:135], v27
    ds_read_b128 a[64:67], v8 offset:0
    v_cvt_pk_bf16_f32 v152, v40, v41
    v_mfma_f32_16x16x32_bf16 v[176:179], a[96:99], v[96:99], v[176:179]
    ds_read_b128 a[68:71], v9 offset:0
    v_cvt_pk_bf16_f32 v153, v42, v43
    v_mfma_f32_16x16x32_bf16 v[176:179], a[100:103], v[112:115], v[176:179]
    v_exp_f32 v44, v84
    v_mfma_f32_16x16x32_bf16 v[200:203], a[100:103], v[116:119], v[200:203]
    s_add_u32 m0, s31, 32768
    v_exp_f32 v45, v85
    v_mfma_f32_16x16x32_bf16 v[200:203], a[96:99], v[100:103], v[200:203]
    buffer_load_dwordx4 v20, s[16:19], s32 offen offset:0 lds
    v_mfma_f32_16x16x32_bf16 v[224:227], a[96:99], v[104:107], v[224:227]
    ds_read_b128 a[72:75], v10 offset:0
    v_cvt_pk_bf16_f32 v154, v44, v45
    v_mfma_f32_16x16x32_bf16 v[224:227], a[100:103], v[120:123], v[224:227]
    v_exp_f32 v46, v86
    v_mfma_f32_16x16x32_bf16 v[248:251], a[100:103], v[124:127], v[248:251]
    v_exp_f32 v47, v87
    v_mfma_f32_16x16x32_bf16 v[248:251], a[96:99], v[108:111], v[248:251]
    ds_read_b128 a[76:79], v11 offset:0
    v_cvt_pk_bf16_f32 v155, v46, v47
    v_mfma_f32_16x16x32_bf16 v[252:255], a[104:107], v[108:111], v[252:255]
    buffer_load_dwordx4 v21, s[16:19], s32 offen offset:1024 lds
    v_mfma_f32_16x16x32_bf16 v[252:255], a[108:111], v[124:127], v[252:255]
    v_exp_f32 v40, v92
    v_mfma_f32_16x16x32_bf16 v[228:231], a[108:111], v[120:123], v[228:231]
    v_exp_f32 v41, v93
    v_mfma_f32_16x16x32_bf16 v[228:231], a[104:107], v[104:107], v[228:231]
    ds_read_b128 a[80:83], v8 offset:4096
    v_cvt_pk_bf16_f32 v158, v40, v41
    v_mfma_f32_16x16x32_bf16 v[204:207], a[104:107], v[100:103], v[204:207]
    v_exp_f32 v42, v94
    v_mfma_f32_16x16x32_bf16 v[204:207], a[108:111], v[116:119], v[204:207]
    buffer_load_dwordx4 v22, s[16:19], s32 offen offset:2048 lds
    v_mfma_f32_16x16x32_bf16 v[180:183], a[108:111], v[112:115], v[180:183]
    v_exp_f32 v43, v95
    v_mfma_f32_16x16x32_bf16 v[180:183], a[104:107], v[96:99], v[180:183]
    ds_read_b128 a[84:87], v9 offset:4096
    v_cvt_pk_bf16_f32 v159, v42, v43
    v_mfma_f32_16x16x32_bf16 a[224:227], a[112:115], v[96:99], a[224:227]
    v_exp_f32 v44, v88
    v_mfma_f32_16x16x32_bf16 a[224:227], a[116:119], v[112:115], a[224:227]
    v_exp_f32 v45, v89
    v_mfma_f32_16x16x32_bf16 a[232:235], a[116:119], v[116:119], a[232:235]
    buffer_load_dwordx4 v23, s[16:19], s32 offen offset:3072 lds
    v_mfma_f32_16x16x32_bf16 a[232:235], a[112:115], v[100:103], a[232:235]
    ds_read_b128 a[88:91], v10 offset:4096
    v_cvt_pk_bf16_f32 v156, v44, v45
    v_mfma_f32_16x16x32_bf16 a[240:243], a[112:115], v[104:107], a[240:243]
    v_exp_f32 v46, v90
    v_mfma_f32_16x16x32_bf16 a[240:243], a[116:119], v[120:123], a[240:243]
    v_exp_f32 v47, v91
    v_mfma_f32_16x16x32_bf16 a[248:251], a[116:119], v[124:127], a[248:251]
    ds_read_b128 a[92:95], v11 offset:4096
    v_cvt_pk_bf16_f32 v157, v46, v47
    v_mfma_f32_16x16x32_bf16 a[248:251], a[112:115], v[108:111], a[248:251]
    ds_read_b64_tr_b16 a[96:97], v12 offset:49152
    ds_read_b64_tr_b16 a[98:99], v12 offset:53248
    v_mfma_f32_16x16x32_bf16 a[252:255], a[120:123], v[108:111], a[252:255]
    ds_read_b64_tr_b16 a[100:101], v12 offset:57344
    v_mfma_f32_16x16x32_bf16 a[252:255], a[124:127], v[124:127], a[252:255]
    ds_read_b64_tr_b16 a[102:103], v12 offset:61440
    v_mfma_f32_16x16x32_bf16 a[244:247], a[124:127], v[120:123], a[244:247]
    s_add_u32 s32, s32, 16384
    ds_read_b64_tr_b16 a[104:105], v13 offset:49152
    v_mfma_f32_16x16x32_bf16 a[244:247], a[120:123], v[104:107], a[244:247]
    ds_read_b64_tr_b16 a[106:107], v13 offset:53248
    v_mfma_f32_16x16x32_bf16 a[236:239], a[120:123], v[100:103], a[236:239]
    ds_read_b64_tr_b16 a[108:109], v13 offset:57344
    v_mfma_f32_16x16x32_bf16 a[236:239], a[124:127], v[116:119], a[236:239]
    ds_read_b64_tr_b16 a[110:111], v13 offset:61440
    v_mfma_f32_16x16x32_bf16 a[228:231], a[124:127], v[112:115], a[228:231]
    s_add_u32 s38, s38, s38
    v_mfma_f32_16x16x32_bf16 a[228:231], a[120:123], v[96:99], a[228:231]
    s_waitcnt lgkmcnt(8)
    s_cbranch_scc0 L_loop
    s_cmp_lg_u32 s33, 0
    s_cbranch_scc1 L_hookB
L_last:
    v_mfma_f32_16x16x32_bf16 v[64:67], a[64:67], a[0:3], v[48:51]
    ds_read_b64_tr_b16 a[112:113], v14 offset:49152
    v_mfma_f32_16x16x32_bf16 v[64:67], a[68:71], a[4:7], v[64:67]
    ds_read_b64_tr_b16 a[114:115], v14 offset:53248
    v_mfma_f32_16x16x32_bf16 v[64:67], a[72:75], a[8:11], v[64:67]
    ds_read_b64_tr_b16 a[116:117], v14 offset:57344
    v_mfma_f32_16x16x32_bf16 v[64:67], a[76:79], a[12:15], v[64:67]
    ds_read_b64_tr_b16 a[118:119], v14 offset:61440
    v_mfma_f32_16x16x32_bf16 v[68:71], a[92:95], a[12:15], v[48:51]
    ds_read_b64_tr_b16 a[120:121], v15 offset:49152
    v_mfma_f32_16x16x32_bf16 v[68:71], a[88:91], a[8:11], v[68:71]
    ds_read_b64_tr_b16 a[122:123], v15 offset:53248
    v_mfma_f32_16x16x32_bf16 v[68:71], a[84:87], a[4:7], v[68:71]
    ds_read_b64_tr_b16 a[124:125], v15 offset:57344
    v_mfma_f32_16x16x32_bf16 v[68:71], a[80:83], a[0:3], v[68:71]
    ds_read_b64_tr_b16 a[126:127], v15 offset:61440
    v_mfma_f32_16x16x32_bf16 v[76:79], a[80:83], a[16:19], v[52:55]
    v_exp_f32 v40, v64
    v_mfma_f32_16x16x32_bf16 v[76:79], a[84:87], a[20:23], v[76:79]
    s_add_u32 s6, s64, 0
    v_exp_f32 v41, v65
    v_mfma_f32_16x16x32_bf16 v[76:79], a[88:91], a[24:27], v[76:79]
    s_add_u32 m0, s31, 131072
    v_exp_f32 v42, v66
    v_mfma_f32_16x16x32_bf16 v[76:79], a[92:95], a[28:31], v[76:79]
    buffer_load_dwordx4 v30, s[52:55], s6 offen offset:0 lds
    v_mfma_f32_16x16x32_bf16 v[72:75], a[76:79], a[28:31], v[52:55]
    v_exp_f32 v43, v67
    v_mfma_f32_16x16x32_bf16 v[72:75], a[72:75], a[24:27], v[72:75]
    v_cvt_pk_bf16_f32 v96, v40, v41
    v_cvt_pk_bf16_f32 v97, v42, v43
    v_mfma_f32_16x16x32_bf16 v[72:75], a[68:71], a[20:23], v[72:75]
    v_exp_f32 v44, v68
    v_mfma_f32_16x16x32_bf16 v[72:75], a[64:67], a[16:19], v[72:75]
    buffer_load_dwordx4 v31, s[52:55], s6 offen offset:1024 lds
    v_mfma_f32_16x16x32_bf16 v[80:83], a[64:67], a[32:35], v[56:59]
    v_exp_f32 v45, v69
    v_mfma_f32_16x16x32_bf16 v[80:83], a[68:71], a[36:39], v[80:83]
    v_exp_f32 v46, v70
    v_mfma_f32_16x16x32_bf16 v[80:83], a[72:75], a[40:43], v[80:83]
    v_exp_f32 v47, v71
    v_mfma_f32_16x16x32_bf16 v[80:83], a[76:79], a[44:47], v[80:83]
    buffer_load_dwordx4 v32, s[52:55], s6 offen offset:2048 lds
    v_mfma_f32_16x16x32_bf16 v[84:87], a[92:95], a[44:47], v[56:59]
    v_cvt_pk_bf16_f32 v98, v44, v45
    v_cvt_pk_bf16_f32 v99, v46, v47
    v_mfma_f32_16x16x32_bf16 v[84:87], a[88:91], a[40:43], v[84:87]
    v_exp_f32 v40, v76
    v_mfma_f32_16x16x32_bf16 v[84:87], a[84:87], a[36:39], v[84:87]
    v_exp_f32 v41, v77
    v_mfma_f32_16x16x32_bf16 v[84:87], a[80:83], a[32:35], v[84:87]
    buffer_load_dwordx4 v33, s[52:55], s6 offen offset:3072 lds
    v_mfma_f32_16x16x32_bf16 v[92:95], a[80:83], a[48:51], v[60:63]
    v_exp_f32 v42, v78
    v_mfma_f32_16x16x32_bf16 v[92:95], a[84:87], a[52:55], v[92:95]
    v_exp_f32 v43, v79
    v_mfma_f32_16x16x32_bf16 v[92:95], a[88:91], a[56:59], v[92:95]
    v_cvt_pk_bf16_f32 v102, v40, v41
    v_cvt_pk_bf16_f32 v103, v42, v43
    v_mfma_f32_16x16x32_bf16 v[92:95], a[92:95], a[60:63], v[92:95]
    v_exp_f32 v44, v72
    v_mfma_f32_16x16x32_bf16 v[88:91], a[76:79], a[60:63], v[60:63]
    v_exp_f32 v45, v73
    v_mfma_f32_16x16x32_bf16 v[88:91], a[72:75], a[56:59], v[88:91]
    v_exp_f32 v46, v74
    v_mfma_f32_16x16x32_bf16 v[88:91], a[68:71], a[52:55], v[88:91]
    v_exp_f32 v47, v75
    v_mfma_f32_16x16x32_bf16 v[88:91], a[64:67], a[48:51], v[88:91]
    s_waitcnt lgkmcnt(0)
    v_cvt_pk_bf16_f32 v100, v44, v45
    v_cvt_pk_bf16_f32 v101, v46, v47
    v_smfmac_f32_16x16x64_bf16 a[132:135], a[136:139], v[152:159], v27
    v_smfmac_f32_16x16x64_bf16 a[128:131], a[136:139], v[144:151], v27
    s_add_u32 m0, s31, 81920
    ds_read_b128 a[64:67], v8 offset:8192
    v_mfma_f32_16x16x32_bf16 v[160:163], a[96:99], v[128:131], v[160:163]
    buffer_load_dwordx4 v24, s[20:23], s39 offen offset:0 lds
    v_mfma_f32_16x16x32_bf16 v[160:163], a[100:103], v[144:147], v[160:163]
    v_exp_f32 v40, v80
    v_mfma_f32_16x16x32_bf16 v[184:187], a[100:103], v[148:151], v[184:187]
    v_exp_f32 v41, v81
    v_mfma_f32_16x16x32_bf16 v[184:187], a[96:99], v[132:135], v[184:187]
    ds_read_b128 a[68:71], v9 offset:8192
    v_cvt_pk_bf16_f32 v104, v40, v41
    v_mfma_f32_16x16x32_bf16 v[208:211], a[96:99], v[136:139], v[208:211]
    buffer_load_dwordx4 v25, s[20:23], s39 offen offset:1024 lds
    v_mfma_f32_16x16x32_bf16 v[208:211], a[100:103], v[152:155], v[208:211]
    v_exp_f32 v42, v82
    v_mfma_f32_16x16x32_bf16 v[232:235], a[100:103], v[156:159], v[232:235]
    v_exp_f32 v43, v83
    v_mfma_f32_16x16x32_bf16 v[232:235], a[96:99], v[140:143], v[232:235]
    ds_read_b128 a[72:75], v10 offset:8192
    v_cvt_pk_bf16_f32 v105, v42, v43
    v_mfma_f32_16x16x32_bf16 v[236:239], a[104:107], v[140:143], v[236:239]
    buffer_load_dwordx4 v24, s[20:23], s39 offen offset:2048 lds
    v_mfma_f32_16x16x32_bf16 v[236:239], a[108:111], v[156:159], v[236:239]
    v_exp_f32 v44, v84
    v_mfma_f32_16x16x32_bf16 v[212:215], a[108:111], v[152:155], v[212:215]
    v_exp_f32 v45, v85
    v_mfma_f32_16x16x32_bf16 v[212:215], a[104:107], v[136:139], v[212:215]
    ds_read_b128 a[76:79], v11 offset:8192
    v_cvt_pk_bf16_f32 v106, v44, v45
    v_mfma_f32_16x16x32_bf16 v[188:191], a[104:107], v[132:135], v[188:191]
    buffer_load_dwordx4 v25, s[20:23], s39 offen offset:3072 lds
    v_mfma_f32_16x16x32_bf16 v[188:191], a[108:111], v[148:151], v[188:191]
    s_add_u32 s6, s64, 32768
    v_exp_f32 v46, v86
    v_mfma_f32_16x16x32_bf16 v[164:167], a[108:111], v[144:147], v[164:167]
    s_add_u32 m0, s31, 147456
    v_exp_f32 v47, v87
    v_mfma_f32_16x16x32_bf16 v[164:167], a[104:107], v[128:131], v[164:167]
    ds_read_b128 a[80:83], v8 offset:12288
    v_cvt_pk_bf16_f32 v107, v46, v47
    v_mfma_f32_16x16x32_bf16 v[168:171], a[112:115], v[128:131], v[168:171]
    buffer_load_dwordx4 v30, s[52:55], s6 offen offset:0 lds
    v_mfma_f32_16x16x32_bf16 v[168:171], a[116:119], v[144:147], v[168:171]
    v_exp_f32 v40, v92
    v_mfma_f32_16x16x32_bf16 v[192:195], a[116:119], v[148:151], v[192:195]
    v_exp_f32 v41, v93
    v_mfma_f32_16x16x32_bf16 v[192:195], a[112:115], v[132:135], v[192:195]
    ds_read_b128 a[84:87], v9 offset:12288
    v_cvt_pk_bf16_f32 v110, v40, v41
    v_mfma_f32_16x16x32_bf16 v[216:219], a[112:115], v[136:139], v[216:219]
    buffer_load_dwordx4 v31, s[52:55], s6 offen offset:1024 lds
    v_mfma_f32_16x16x32_bf16 v[216:219], a[116:119], v[152:155], v[216:219]
    v_exp_f32 v42, v94
    v_mfma_f32_16x16x32_bf16 v[240:243], a[116:119], v[156:159], v[240:243]
    v_exp_f32 v43, v95
    v_mfma_f32_16x16x32_bf16 v[240:243], a[112:115], v[140:143], v[240:243]
    ds_read_b128 a[88:91], v10 offset:12288
    v_cvt_pk_bf16_f32 v111, v42, v43
    v_mfma_f32_16x16x32_bf16 v[244:247], a[120:123], v[140:143], v[244:247]
    buffer_load_dwordx4 v32, s[52:55], s6 offen offset:2048 lds
    v_mfma_f32_16x16x32_bf16 v[244:247], a[124:127], v[156:159], v[244:247]
    v_exp_f32 v44, v88
    v_mfma_f32_16x16x32_bf16 v[220:223], a[124:127], v[152:155], v[220:223]
    s_add_u32 s39, s39, 16384
    ds_read_b128 a[92:95], v11 offset:12288
    v_mfma_f32_16x16x32_bf16 v[220:223], a[120:123], v[136:139], v[220:223]
    v_exp_f32 v45, v89
    v_mfma_f32_16x16x32_bf16 v[196:199], a[120:123], v[132:135], v[196:199]
    buffer_load_dwordx4 v33, s[52:55], s6 offen offset:3072 lds
    v_mfma_f32_16x16x32_bf16 v[196:199], a[124:127], v[148:151], v[196:199]
    v_exp_f32 v46, v90
    v_mfma_f32_16x16x32_bf16 v[172:175], a[124:127], v[144:147], v[172:175]
    v_exp_f32 v47, v91
    v_mfma_f32_16x16x32_bf16 v[172:175], a[120:123], v[128:131], v[172:175]
    s_waitcnt lgkmcnt(0)
    v_cvt_pk_bf16_f32 v108, v44, v45
    v_cvt_pk_bf16_f32 v109, v46, v47
    v_mfma_f32_16x16x32_bf16 v[64:67], a[64:67], a[0:3], v[48:51]
    ds_read_b64_tr_b16 a[96:97], v16 offset:49152
    ds_read_b64_tr_b16 a[98:99], v16 offset:53248
    v_mfma_f32_16x16x32_bf16 v[64:67], a[68:71], a[4:7], v[64:67]
L_pad7:
    s_cbranch_execz L_pad11
    ds_read_b64_tr_b16 a[100:101], v16 offset:57344
    ds_read_b64_tr_b16 a[102:103], v16 offset:61440
    v_mfma_f32_16x16x32_bf16 v[64:67], a[72:75], a[8:11], v[64:67]
    ds_read_b64_tr_b16 a[104:105], v17 offset:49152
    ds_read_b64_tr_b16 a[106:107], v17 offset:53248
    v_mfma_f32_16x16x32_bf16 v[64:67], a[76:79], a[12:15], v[64:67]
    ds_read_b64_tr_b16 a[108:109], v17 offset:57344
    ds_read_b64_tr_b16 a[110:111], v17 offset:61440
    v_mfma_f32_16x16x32_bf16 v[68:71], a[92:95], a[12:15], v[48:51]
    ds_read_b64_tr_b16 a[112:113], v18 offset:49152
    ds_read_b64_tr_b16 a[114:115], v18 offset:53248
    v_mfma_f32_16x16x32_bf16 v[68:71], a[88:91], a[8:11], v[68:71]
    ds_read_b64_tr_b16 a[116:117], v18 offset:57344
    ds_read_b64_tr_b16 a[118:119], v18 offset:61440
    v_mfma_f32_16x16x32_bf16 v[68:71], a[84:87], a[4:7], v[68:71]
    ds_read_b64_tr_b16 a[120:121], v19 offset:49152
    ds_read_b64_tr_b16 a[122:123], v19 offset:53248
    v_mfma_f32_16x16x32_bf16 v[68:71], a[80:83], a[0:3], v[68:71]
    ds_read_b64_tr_b16 a[124:125], v19 offset:57344
    ds_read_b64_tr_b16 a[126:127], v19 offset:61440
    v_mfma_f32_16x16x32_bf16 v[76:79], a[80:83], a[16:19], v[52:55]
    v_exp_f32 v40, v64
    v_mfma_f32_16x16x32_bf16 v[76:79], a[84:87], a[20:23], v[76:79]
    v_exp_f32 v41, v65
    v_mfma_f32_16x16x32_bf16 v[76:79], a[88:91], a[24:27], v[76:79]
    v_exp_f32 v42, v66
    v_mfma_f32_16x16x32_bf16 v[76:79], a[92:95], a[28:31], v[76:79]
    v_exp_f32 v43, v67
    v_mfma_f32_16x16x32_bf16 v[72:75], a[76:79], a[28:31], v[52:55]
    v_cvt_pk_bf16_f32 v112, v40, v41
    v_cvt_pk_bf16_f32 v113, v42, v43
    v_mfma_f32_16x16x32_bf16 v[72:75], a[72:75], a[24:27], v[72:75]
    v_exp_f32 v44, v68
    v_mfma_f32_16x16x32_bf16 v[72:75], a[68:71], a[20:23], v[72:75]
    v_exp_f32 v45, v69
    v_mfma_f32_16x16x32_bf16 v[72:75], a[64:67], a[16:19], v[72:75]
    v_exp_f32 v46, v70
    v_mfma_f32_16x16x32_bf16 v[80:83], a[64:67], a[32:35], v[56:59]
    v_exp_f32 v47, v71
    v_mfma_f32_16x16x32_bf16 v[80:83], a[68:71], a[36:39], v[80:83]
    v_cvt_pk_bf16_f32 v114, v44, v45
    v_cvt_pk_bf16_f32 v115, v46, v47
    v_mfma_f32_16x16x32_bf16 v[80:83], a[72:75], a[40:43], v[80:83]
    v_exp_f32 v40, v76
    v_mfma_f32_16x16x32_bf16 v[80:83], a[76:79], a[44:47], v[80:83]
    v_exp_f32 v41, v77
    v_mfma_f32_16x16x32_bf16 v[84:87], a[92:95], a[44:47], v[56:59]
    v_exp_f32 v42, v78
    v_mfma_f32_16x16x32_bf16 v[84:87], a[88:91], a[40:43], v[84:87]
    v_exp_f32 v43, v79
    v_mfma_f32_16x16x32_bf16 v[84:87], a[84:87], a[36:39], v[84:87]
    v_cvt_pk_bf16_f32 v118, v40, v41
    v_cvt_pk_bf16_f32 v119, v42, v43
    v_mfma_f32_16x16x32_bf16 v[84:87], a[80:83], a[32:35], v[84:87]
    v_exp_f32 v44, v72
    v_mfma_f32_16x16x32_bf16 v[92:95], a[80:83], a[48:51], v[60:63]
    v_exp_f32 v45, v73
    v_mfma_f32_16x16x32_bf16 v[92:95], a[84:87], a[52:55], v[92:95]
    v_exp_f32 v46, v74
    v_mfma_f32_16x16x32_bf16 v[92:95], a[88:91], a[56:59], v[92:95]
    v_exp_f32 v47, v75
    v_mfma_f32_16x16x32_bf16 v[92:95], a[92:95], a[60:63], v[92:95]
    v_cvt_pk_bf16_f32 v116, v44, v45
    v_cvt_pk_bf16_f32 v117, v46, v47
    v_mfma_f32_16x16x32_bf16 v[88:91], a[76:79], a[60:63], v[60:63]
    v_exp_f32 v40, v80
    v_mfma_f32_16x16x32_bf16 v[88:91], a[72:75], a[56:59], v[88:91]
    v_exp_f32 v41, v81
    v_mfma_f32_16x16x32_bf16 v[88:91], a[68:71], a[52:55], v[88:91]
    s_add_u32 m0, s31, 49152
    v_exp_f32 v42, v82
    v_mfma_f32_16x16x32_bf16 v[88:91], a[64:67], a[48:51], v[88:91]
    s_waitcnt vmcnt(16) lgkmcnt(0)
    v_exp_f32 v43, v83
    v_smfmac_f32_16x16x64_bf16 a[132:135], a[136:139], v[104:111], v27
    s_barrier
    v_smfmac_f32_16x16x64_bf16 a[128:131], a[136:139], v[96:103], v27
    ds_read_b128 a[64:67], v8 offset:16384
    v_cvt_pk_bf16_f32 v120, v40, v41
    v_mfma_f32_16x16x32_bf16 v[176:179], a[96:99], v[128:131], v[176:179]
    buffer_load_dwordx4 v20, s[16:19], s32 offen offset:0 lds
    v_mfma_f32_16x16x32_bf16 v[176:179], a[100:103], v[144:147], v[176:179]
    ds_read_b128 a[68:71], v9 offset:16384
    v_cvt_pk_bf16_f32 v121, v42, v43
    v_mfma_f32_16x16x32_bf16 v[200:203], a[100:103], v[148:151], v[200:203]
    v_exp_f32 v44, v84
    v_mfma_f32_16x16x32_bf16 v[200:203], a[96:99], v[132:135], v[200:203]
    v_exp_f32 v45, v85
    v_mfma_f32_16x16x32_bf16 v[224:227], a[96:99], v[136:139], v[224:227]
    buffer_load_dwordx4 v21, s[16:19], s32 offen offset:1024 lds
    v_mfma_f32_16x16x32_bf16 v[224:227], a[100:103], v[152:155], v[224:227]
    ds_read_b128 a[72:75], v10 offset:16384
    v_cvt_pk_bf16_f32 v122, v44, v45
    v_mfma_f32_16x16x32_bf16 v[248:251], a[100:103], v[156:159], v[248:251]
    v_exp_f32 v46, v86
    v_mfma_f32_16x16x32_bf16 v[248:251], a[96:99], v[140:143], v[248:251]
    v_exp_f32 v47, v87
    v_mfma_f32_16x16x32_bf16 v[252:255], a[104:107], v[140:143], v[252:255]
    buffer_load_dwordx4 v22, s[16:19], s32 offen offset:2048 lds
    v_mfma_f32_16x16x32_bf16 v[252:255], a[108:111], v[156:159], v[252:255]
    ds_read_b128 a[76:79], v11 offset:16384
    v_cvt_pk_bf16_f32 v123, v46, v47
    v_mfma_f32_16x16x32_bf16 v[228:231], a[108:111], v[152:155], v[228:231]
    v_exp_f32 v40, v92
    v_mfma_f32_16x16x32_bf16 v[228:231], a[104:107], v[136:139], v[228:231]
    v_exp_f32 v41, v93
    v_mfma_f32_16x16x32_bf16 v[204:207], a[104:107], v[132:135], v[204:207]
    buffer_load_dwordx4 v23, s[16:19], s32 offen offset:3072 lds
    v_mfma_f32_16x16x32_bf16 v[204:207], a[108:111], v[148:151], v[204:207]
    ds_read_b128 a[80:83], v8 offset:20480
    v_cvt_pk_bf16_f32 v126, v40, v41
    v_mfma_f32_16x16x32_bf16 v[180:183], a[108:111], v[144:147], v[180:183]
    s_add_u32 s6, s65, 98304
    v_exp_f32 v42, v94
    v_mfma_f32_16x16x32_bf16 v[180:183], a[104:107], v[128:131], v[180:183]
    s_add_u32 m0, s31, 0
    v_exp_f32 v43, v95
    v_mfma_f32_16x16x32_bf16 a[224:227], a[112:115], v[128:131], a[224:227]
    buffer_load_dwordx4 v30, s[52:55], s6 offen offset:0 lds
    v_mfma_f32_16x16x32_bf16 a[224:227], a[116:119], v[144:147], a[224:227]
    ds_read_b128 a[84:87], v9 offset:20480
    v_cvt_pk_bf16_f32 v127, v42, v43
    v_mfma_f32_16x16x32_bf16 a[232:235], a[116:119], v[148:151], a[232:235]
    v_exp_f32 v44, v88
    v_mfma_f32_16x16x32_bf16 a[232:235], a[112:115], v[132:135], a[232:235]
    v_exp_f32 v45, v89
    v_mfma_f32_16x16x32_bf16 a[240:243], a[112:115], v[136:139], a[240:243]
    buffer_load_dwordx4 v31, s[52:55], s6 offen offset:1024 lds
    v_mfma_f32_16x16x32_bf16 a[240:243], a[116:119], v[152:155], a[240:243]
    ds_read_b128 a[88:91], v10 offset:20480
    v_cvt_pk_bf16_f32 v124, v44, v45
    v_mfma_f32_16x16x32_bf16 a[248:251], a[116:119], v[156:159], a[248:251]
    v_exp_f32 v46, v90
    v_mfma_f32_16x16x32_bf16 a[248:251], a[112:115], v[140:143], a[248:251]
    v_exp_f32 v47, v91
    v_mfma_f32_16x16x32_bf16 a[252:255], a[120:123], v[140:143], a[252:255]
    buffer_load_dwordx4 v32, s[52:55], s6 offen offset:2048 lds
    v_mfma_f32_16x16x32_bf16 a[252:255], a[124:127], v[156:159], a[252:255]
    ds_read_b128 a[92:95], v11 offset:20480
    v_cvt_pk_bf16_f32 v125, v46, v47
    v_mfma_f32_16x16x32_bf16 a[244:247], a[124:127], v[152:155], a[244:247]
    s_add_u32 s32, s32, 16384
    v_mfma_f32_16x16x32_bf16 a[244:247], a[120:123], v[136:139], a[244:247]
    v_mfma_f32_16x16x32_bf16 a[236:239], a[120:123], v[132:135], a[236:239]
    buffer_load_dwordx4 v33, s[52:55], s6 offen offset:3072 lds
    v_mfma_f32_16x16x32_bf16 a[236:239], a[124:127], v[148:151], a[236:239]
    v_mfma_f32_16x16x32_bf16 a[228:231], a[124:127], v[144:147], a[228:231]
    v_mfma_f32_16x16x32_bf16 a[228:231], a[120:123], v[128:131], a[228:231]
    s_waitcnt lgkmcnt(0)
    v_mfma_f32_16x16x32_bf16 v[64:67], a[64:67], a[0:3], v[48:51]
    ds_read_b64_tr_b16 a[96:97], v12 offset:0
    ds_read_b64_tr_b16 a[98:99], v12 offset:4096
    v_mfma_f32_16x16x32_bf16 v[64:67], a[68:71], a[4:7], v[64:67]
    ds_read_b64_tr_b16 a[100:101], v12 offset:8192
    ds_read_b64_tr_b16 a[102:103], v12 offset:12288
    v_mfma_f32_16x16x32_bf16 v[64:67], a[72:75], a[8:11], v[64:67]
    ds_read_b64_tr_b16 a[104:105], v13 offset:0
    ds_read_b64_tr_b16 a[106:107], v13 offset:4096
    v_mfma_f32_16x16x32_bf16 v[64:67], a[76:79], a[12:15], v[64:67]
    ds_read_b64_tr_b16 a[108:109], v13 offset:8192
    ds_read_b64_tr_b16 a[110:111], v13 offset:12288
    v_mfma_f32_16x16x32_bf16 v[68:71], a[92:95], a[12:15], v[48:51]
    ds_read_b64_tr_b16 a[112:113], v14 offset:0
    ds_read_b64_tr_b16 a[114:115], v14 offset:4096
    v_mfma_f32_16x16x32_bf16 v[68:71], a[88:91], a[8:11], v[68:71]
    ds_read_b64_tr_b16 a[116:117], v14 offset:8192
    ds_read_b64_tr_b16 a[118:119], v14 offset:12288
    v_mfma_f32_16x16x32_bf16 v[68:71], a[84:87], a[4:7], v[68:71]
    ds_read_b64_tr_b16 a[120:121], v15 offset:0
    ds_read_b64_tr_b16 a[122:123], v15 offset:4096
    v_mfma_f32_16x16x32_bf16 v[68:71], a[80:83], a[0:3], v[68:71]
    ds_read_b64_tr_b16 a[124:125], v15 offset:8192
    ds_read_b64_tr_b16 a[126:127], v15 offset:12288
    v_mfma_f32_16x16x32_bf16 v[76:79], a[80:83], a[16:19], v[52:55]
    v_exp_f32 v40, v64
    v_mfma_f32_16x16x32_bf16 v[76:79], a[84:87], a[20:23], v[76:79]
    v_exp_f32 v41, v65
    v_mfma_f32_16x16x32_bf16 v[76:79], a[88:91], a[24:27], v[76:79]
    v_exp_f32 v42, v66
    v_mfma_f32_16x16x32_bf16 v[76:79], a[92:95], a[28:31], v[76:79]
    v_exp_f32 v43, v67
    v_mfma_f32_16x16x32_bf16 v[72:75], a[76:79], a[28:31], v[52:55]
    s_waitcnt vmcnt(16)
    v_cvt_pk_bf16_f32 v128, v40, v41
    v_cvt_pk_bf16_f32 v129, v42, v43
    v_mfma_f32_16x16x32_bf16 v[72:75], a[72:75], a[24:27], v[72:75]
    ds_read_b64_tr_b16 a[144:145], v36 offset:0
    ds_read_b64_tr_b16 a[146:147], v36 offset:2048
    v_mfma_f32_16x16x32_bf16 v[72:75], a[68:71], a[20:23], v[72:75]
    v_exp_f32 v44, v68
    v_mfma_f32_16x16x32_bf16 v[72:75], a[64:67], a[16:19], v[72:75]
    v_exp_f32 v45, v69
    v_mfma_f32_16x16x32_bf16 v[80:83], a[64:67], a[32:35], v[56:59]
    v_exp_f32 v46, v70
    v_mfma_f32_16x16x32_bf16 v[80:83], a[68:71], a[36:39], v[80:83]
    ds_read_b64_tr_b16 a[148:149], v37 offset:0
    ds_read_b64_tr_b16 a[150:151], v37 offset:2048
    v_mfma_f32_16x16x32_bf16 v[80:83], a[72:75], a[40:43], v[80:83]
    v_exp_f32 v47, v71
    v_mfma_f32_16x16x32_bf16 v[80:83], a[76:79], a[44:47], v[80:83]
    v_cvt_pk_bf16_f32 v130, v44, v45
    v_cvt_pk_bf16_f32 v131, v46, v47
    v_mfma_f32_16x16x32_bf16 v[84:87], a[92:95], a[44:47], v[56:59]
    v_exp_f32 v40, v76
    v_mfma_f32_16x16x32_bf16 v[84:87], a[88:91], a[40:43], v[84:87]
    ds_read_b64_tr_b16 a[152:153], v38 offset:0
    ds_read_b64_tr_b16 a[154:155], v38 offset:2048
    v_mfma_f32_16x16x32_bf16 v[84:87], a[84:87], a[36:39], v[84:87]
    v_exp_f32 v41, v77
    v_mfma_f32_16x16x32_bf16 v[84:87], a[80:83], a[32:35], v[84:87]
    v_exp_f32 v42, v78
    v_mfma_f32_16x16x32_bf16 v[92:95], a[80:83], a[48:51], v[60:63]
    v_exp_f32 v43, v79
    v_mfma_f32_16x16x32_bf16 v[92:95], a[84:87], a[52:55], v[92:95]
    ds_read_b64_tr_b16 a[156:157], v39 offset:0
    ds_read_b64_tr_b16 a[158:159], v39 offset:2048
    v_mfma_f32_16x16x32_bf16 v[92:95], a[88:91], a[56:59], v[92:95]
    v_cvt_pk_bf16_f32 v134, v40, v41
    v_cvt_pk_bf16_f32 v135, v42, v43
    v_mfma_f32_16x16x32_bf16 v[92:95], a[92:95], a[60:63], v[92:95]
    v_exp_f32 v44, v72
    v_mfma_f32_16x16x32_bf16 v[88:91], a[76:79], a[60:63], v[60:63]
    v_exp_f32 v45, v73
    v_mfma_f32_16x16x32_bf16 v[88:91], a[72:75], a[56:59], v[88:91]
    v_exp_f32 v46, v74
    v_mfma_f32_16x16x32_bf16 v[88:91], a[68:71], a[52:55], v[88:91]
    v_exp_f32 v47, v75
    v_mfma_f32_16x16x32_bf16 v[88:91], a[64:67], a[48:51], v[88:91]
    s_waitcnt lgkmcnt(0)
    v_cvt_pk_bf16_f32 v132, v44, v45
    v_cvt_pk_bf16_f32 v133, v46, v47
    v_smfmac_f32_16x16x64_bf16 a[132:135], a[136:139], v[120:127], v27
    v_smfmac_f32_16x16x64_bf16 a[128:131], a[136:139], v[112:119], v27
    s_add_u32 m0, s31, 98304
    ds_read_b128 a[64:67], v8 offset:24576
    v_mfma_f32_16x16x32_bf16 v[160:163], a[96:99], v[96:99], v[160:163]
    buffer_load_dwordx4 v24, s[20:23], s39 offen offset:0 lds
    v_mfma_f32_16x16x32_bf16 v[160:163], a[100:103], v[112:115], v[160:163]
    v_exp_f32 v40, v80
    v_mfma_f32_16x16x32_bf16 v[184:187], a[100:103], v[116:119], v[184:187]
    v_exp_f32 v41, v81
    v_mfma_f32_16x16x32_bf16 v[184:187], a[96:99], v[100:103], v[184:187]
    ds_read_b128 a[68:71], v9 offset:24576
    v_cvt_pk_bf16_f32 v136, v40, v41
    v_mfma_f32_16x16x32_bf16 v[208:211], a[96:99], v[104:107], v[208:211]
    buffer_load_dwordx4 v25, s[20:23], s39 offen offset:1024 lds
    v_mfma_f32_16x16x32_bf16 v[208:211], a[100:103], v[120:123], v[208:211]
    v_exp_f32 v42, v82
    v_mfma_f32_16x16x32_bf16 v[232:235], a[100:103], v[124:127], v[232:235]
    v_exp_f32 v43, v83
    v_mfma_f32_16x16x32_bf16 v[232:235], a[96:99], v[108:111], v[232:235]
    ds_read_b128 a[72:75], v10 offset:24576
    v_cvt_pk_bf16_f32 v137, v42, v43
    v_mfma_f32_16x16x32_bf16 v[236:239], a[104:107], v[108:111], v[236:239]
    buffer_load_dwordx4 v24, s[20:23], s39 offen offset:2048 lds
    v_mfma_f32_16x16x32_bf16 v[236:239], a[108:111], v[124:127], v[236:239]
    v_exp_f32 v44, v84
    v_mfma_f32_16x16x32_bf16 v[212:215], a[108:111], v[120:123], v[212:215]
    v_exp_f32 v45, v85
    v_mfma_f32_16x16x32_bf16 v[212:215], a[104:107], v[104:107], v[212:215]
    ds_read_b128 a[76:79], v11 offset:24576
    v_cvt_pk_bf16_f32 v138, v44, v45
    v_mfma_f32_16x16x32_bf16 v[188:191], a[104:107], v[100:103], v[188:191]
    buffer_load_dwordx4 v25, s[20:23], s39 offen offset:3072 lds
    v_mfma_f32_16x16x32_bf16 v[188:191], a[108:111], v[116:119], v[188:191]
    s_add_u32 s6, s64, 65536
    v_exp_f32 v46, v86
    v_mfma_f32_16x16x32_bf16 v[164:167], a[108:111], v[112:115], v[164:167]
    s_add_u32 m0, s31, 131072
    v_exp_f32 v47, v87
    v_mfma_f32_16x16x32_bf16 v[164:167], a[104:107], v[96:99], v[164:167]
    ds_read_b128 a[80:83], v8 offset:28672
    v_cvt_pk_bf16_f32 v139, v46, v47
    v_mfma_f32_16x16x32_bf16 v[168:171], a[112:115], v[96:99], v[168:171]
    buffer_load_dwordx4 v30, s[52:55], s6 offen offset:0 lds
    v_mfma_f32_16x16x32_bf16 v[168:171], a[116:119], v[112:115], v[168:171]
    v_exp_f32 v40, v92
    v_mfma_f32_16x16x32_bf16 v[192:195], a[116:119], v[116:119], v[192:195]
    v_exp_f32 v41, v93
    v_mfma_f32_16x16x32_bf16 v[192:195], a[112:115], v[100:103], v[192:195]
    ds_read_b128 a[84:87], v9 offset:28672
    v_cvt_pk_bf16_f32 v142, v40, v41
    v_mfma_f32_16x16x32_bf16 v[216:219], a[112:115], v[104:107], v[216:219]
    buffer_load_dwordx4 v31, s[52:55], s6 offen offset:1024 lds
    v_mfma_f32_16x16x32_bf16 v[216:219], a[116:119], v[120:123], v[216:219]
    v_exp_f32 v42, v94
    v_mfma_f32_16x16x32_bf16 v[240:243], a[116:119], v[124:127], v[240:243]
    v_exp_f32 v43, v95
    v_mfma_f32_16x16x32_bf16 v[240:243], a[112:115], v[108:111], v[240:243]
    ds_read_b128 a[88:91], v10 offset:28672
    v_cvt_pk_bf16_f32 v143, v42, v43
    v_mfma_f32_16x16x32_bf16 v[244:247], a[120:123], v[108:111], v[244:247]
    buffer_load_dwordx4 v32, s[52:55], s6 offen offset:2048 lds
    v_mfma_f32_16x16x32_bf16 v[244:247], a[124:127], v[124:127], v[244:247]
    v_exp_f32 v44, v88
    v_mfma_f32_16x16x32_bf16 v[220:223], a[124:127], v[120:123], v[220:223]
    s_add_u32 s39, s39, 16384
    ds_read_b128 a[92:95], v11 offset:28672
    v_mfma_f32_16x16x32_bf16 v[220:223], a[120:123], v[104:107], v[220:223]
    v_exp_f32 v45, v89
    v_mfma_f32_16x16x32_bf16 v[196:199], a[120:123], v[100:103], v[196:199]
    buffer_load_dwordx4 v33, s[52:55], s6 offen offset:3072 lds
    v_mfma_f32_16x16x32_bf16 v[196:199], a[124:127], v[116:119], v[196:199]
    v_exp_f32 v46, v90
    v_mfma_f32_16x16x32_bf16 v[172:175], a[124:127], v[112:115], v[172:175]
    v_exp_f32 v47, v91
    v_mfma_f32_16x16x32_bf16 v[172:175], a[120:123], v[96:99], v[172:175]
    s_waitcnt lgkmcnt(0)
    v_cvt_pk_bf16_f32 v140, v44, v45
    v_cvt_pk_bf16_f32 v141, v46, v47
    v_mfma_f32_16x16x32_bf16 v[64:67], a[64:67], a[0:3], v[48:51]
    ds_read_b64_tr_b16 a[96:97], v16 offset:0
    ds_read_b64_tr_b16 a[98:99], v16 offset:4096
    v_mfma_f32_16x16x32_bf16 v[64:67], a[68:71], a[4:7], v[64:67]
    ds_read_b64_tr_b16 a[100:101], v16 offset:8192
    ds_read_b64_tr_b16 a[102:103], v16 offset:12288
    v_mfma_f32_16x16x32_bf16 v[64:67], a[72:75], a[8:11], v[64:67]
    ds_read_b64_tr_b16 a[104:105], v17 offset:0
    ds_read_b64_tr_b16 a[106:107], v17 offset:4096
    v_mfma_f32_16x16x32_bf16 v[64:67], a[76:79], a[12:15], v[64:67]
    ds_read_b64_tr_b16 a[108:109], v17 offset:8192
    ds_read_b64_tr_b16 a[110:111], v17 offset:12288
    v_mfma_f32_16x16x32_bf16 v[68:71], a[92:95], a[12:15], v[48:51]
    ds_read_b64_tr_b16 a[112:113], v18 offset:0
    ds_read_b64_tr_b16 a[114:115], v18 offset:4096
    v_mfma_f32_16x16x32_bf16 v[68:71], a[88:91], a[8:11], v[68:71]
    ds_read_b64_tr_b16 a[116:117], v18 offset:8192
    ds_read_b64_tr_b16 a[118:119], v18 offset:12288
    v_mfma_f32_16x16x32_bf16 v[68:71], a[84:87], a[4:7], v[68:71]
    ds_read_b64_tr_b16 a[120:121], v19 offset:0
    ds_read_b64_tr_b16 a[122:123], v19 offset:4096
    v_mfma_f32_16x16x32_bf16 v[68:71], a[80:83], a[0:3], v[68:71]
    ds_read_b64_tr_b16 a[124:125], v19 offset:8192
    ds_read_b64_tr_b16 a[126:127], v19 offset:12288
    v_mfma_f32_16x16x32_bf16 v[76:79], a[80:83], a[16:19], v[52:55]
    v_exp_f32 v40, v64
    v_mfma_f32_16x16x32_bf16 v[76:79], a[84:87], a[20:23], v[76:79]
    v_exp_f32 v41, v65
    v_mfma_f32_16x16x32_bf16 v[76:79], a[88:91], a[24:27], v[76:79]
    v_exp_f32 v42, v66
    v_mfma_f32_16x16x32_bf16 v[76:79], a[92:95], a[28:31], v[76:79]
    v_exp_f32 v43, v67
    v_mfma_f32_16x16x32_bf16 v[72:75], a[76:79], a[28:31], v[52:55]
    s_waitcnt vmcnt(16)
    v_cvt_pk_bf16_f32 v144, v40, v41
    v_cvt_pk_bf16_f32 v145, v42, v43
    v_mfma_f32_16x16x32_bf16 v[72:75], a[72:75], a[24:27], v[72:75]
    ds_read_b64_tr_b16 a[160:161], v36 offset:16384
    ds_read_b64_tr_b16 a[162:163], v36 offset:18432
    v_mfma_f32_16x16x32_bf16 v[72:75], a[68:71], a[20:23], v[72:75]
    v_exp_f32 v44, v68
    v_mfma_f32_16x16x32_bf16 v[72:75], a[64:67], a[16:19], v[72:75]
    v_exp_f32 v45, v69
    v_mfma_f32_16x16x32_bf16 v[80:83], a[64:67], a[32:35], v[56:59]
    v_exp_f32 v46, v70
    v_mfma_f32_16x16x32_bf16 v[80:83], a[68:71], a[36:39], v[80:83]
    ds_read_b64_tr_b16 a[164:165], v37 offset:16384
    ds_read_b64_tr_b16 a[166:167], v37 offset:18432
    v_mfma_f32_16x16x32_bf16 v[80:83], a[72:75], a[40:43], v[80:83]
    v_exp_f32 v47, v71
    v_mfma_f32_16x16x32_bf16 v[80:83], a[76:79], a[44:47], v[80:83]
    v_cvt_pk_bf16_f32 v146, v44, v45
    v_cvt_pk_bf16_f32 v147, v46, v47
    v_mfma_f32_16x16x32_bf16 v[84:87], a[92:95], a[44:47], v[56:59]
    v_exp_f32 v40, v76
    v_mfma_f32_16x16x32_bf16 v[84:87], a[88:91], a[40:43], v[84:87]
    ds_read_b64_tr_b16 a[168:169], v38 offset:16384
    ds_read_b64_tr_b16 a[170:171], v38 offset:18432
    v_mfma_f32_16x16x32_bf16 v[84:87], a[84:87], a[36:39], v[84:87]
    v_exp_f32 v41, v77
    v_mfma_f32_16x16x32_bf16 v[84:87], a[80:83], a[32:35], v[84:87]
    v_exp_f32 v42, v78
    v_mfma_f32_16x16x32_bf16 v[92:95], a[80:83], a[48:51], v[60:63]
    v_exp_f32 v43, v79
    v_mfma_f32_16x16x32_bf16 v[92:95], a[84:87], a[52:55], v[92:95]
    ds_read_b64_tr_b16 a[172:173], v39 offset:16384
    ds_read_b64_tr_b16 a[174:175], v39 offset:18432
    v_mfma_f32_16x16x32_bf16 v[92:95], a[88:91], a[56:59], v[92:95]
    v_cvt_pk_bf16_f32 v150, v40, v41
    v_cvt_pk_bf16_f32 v151, v42, v43
    v_mfma_f32_16x16x32_bf16 v[92:95], a[92:95], a[60:63], v[92:95]
    v_exp_f32 v44, v72
    v_mfma_f32_16x16x32_bf16 v[88:91], a[76:79], a[60:63], v[60:63]
    v_exp_f32 v45, v73
    v_mfma_f32_16x16x32_bf16 v[88:91], a[72:75], a[56:59], v[88:91]
    v_exp_f32 v46, v74
    v_mfma_f32_16x16x32_bf16 v[88:91], a[68:71], a[52:55], v[88:91]
    s_add_u32 s34, s66, 0
    v_exp_f32 v47, v75
    v_mfma_f32_16x16x32_bf16 v[88:91], a[64:67], a[48:51], v[88:91]
    s_waitcnt vmcnt(20) lgkmcnt(0)
    v_cvt_pk_bf16_f32 v148, v44, v45
    v_cvt_pk_bf16_f32 v149, v46, v47
    v_smfmac_f32_16x16x64_bf16 a[132:135], a[136:139], v[136:143], v27
    s_barrier
    v_smfmac_f32_16x16x64_bf16 a[128:131], a[136:139], v[128:135], v27
    s_add_u32 m0, s31, 16384
    ds_read_b128 a[64:67], v8 offset:32768
    v_mfma_f32_16x16x32_bf16 v[176:179], a[96:99], v[96:99], v[176:179]
    buffer_load_dwordx4 v30, s[52:55], s34 offen offset:0 lds
    v_mfma_f32_16x16x32_bf16 v[176:179], a[100:103], v[112:115], v[176:179]
    v_exp_f32 v40, v80
    v_mfma_f32_16x16x32_bf16 v[200:203], a[100:103], v[116:119], v[200:203]
    v_exp_f32 v41, v81
    v_mfma_f32_16x16x32_bf16 v[200:203], a[96:99], v[100:103], v[200:203]
    ds_read_b128 a[68:71], v9 offset:32768
    v_cvt_pk_bf16_f32 v152, v40, v41
    v_mfma_f32_16x16x32_bf16 v[224:227], a[96:99], v[104:107], v[224:227]
    buffer_load_dwordx4 v31, s[52:55], s34 offen offset:1024 lds
    v_mfma_f32_16x16x32_bf16 v[224:227], a[100:103], v[120:123], v[224:227]
    v_exp_f32 v42, v82
    v_mfma_f32_16x16x32_bf16 v[248:251], a[100:103], v[124:127], v[248:251]
    v_exp_f32 v43, v83
    v_mfma_f32_16x16x32_bf16 v[248:251], a[96:99], v[108:111], v[248:251]
    ds_read_b128 a[72:75], v10 offset:32768
    v_cvt_pk_bf16_f32 v153, v42, v43
    v_mfma_f32_16x16x32_bf16 v[252:255], a[104:107], v[108:111], v[252:255]
    buffer_load_dwordx4 v32, s[52:55], s34 offen offset:2048 lds
    v_mfma_f32_16x16x32_bf16 v[252:255], a[108:111], v[124:127], v[252:255]
    v_exp_f32 v44, v84
    v_mfma_f32_16x16x32_bf16 v[228:231], a[108:111], v[120:123], v[228:231]
    v_exp_f32 v45, v85
    v_mfma_f32_16x16x32_bf16 v[228:231], a[104:107], v[104:107], v[228:231]
    ds_read_b128 a[76:79], v11 offset:32768
    v_cvt_pk_bf16_f32 v154, v44, v45
    v_mfma_f32_16x16x32_bf16 v[204:207], a[104:107], v[100:103], v[204:207]
    buffer_load_dwordx4 v33, s[52:55], s34 offen offset:3072 lds
    v_mfma_f32_16x16x32_bf16 v[204:207], a[108:111], v[116:119], v[204:207]
    s_add_u32 s6, s64, 98304
    v_exp_f32 v46, v86
    v_mfma_f32_16x16x32_bf16 v[180:183], a[108:111], v[112:115], v[180:183]
    s_add_u32 m0, s31, 147456
    v_exp_f32 v47, v87
    v_mfma_f32_16x16x32_bf16 v[180:183], a[104:107], v[96:99], v[180:183]
    ds_read_b128 a[80:83], v8 offset:36864
    v_cvt_pk_bf16_f32 v155, v46, v47
    v_mfma_f32_16x16x32_bf16 a[224:227], a[112:115], v[96:99], a[224:227]
    buffer_load_dwordx4 v30, s[52:55], s6 offen offset:0 lds
    v_mfma_f32_16x16x32_bf16 a[224:227], a[116:119], v[112:115], a[224:227]
    v_exp_f32 v40, v92
    v_mfma_f32_16x16x32_bf16 a[232:235], a[116:119], v[116:119], a[232:235]
    v_exp_f32 v41, v93
    v_mfma_f32_16x16x32_bf16 a[232:235], a[112:115], v[100:103], a[232:235]
    ds_read_b128 a[84:87], v9 offset:36864
    v_cvt_pk_bf16_f32 v158, v40, v41
    v_mfma_f32_16x16x32_bf16 a[240:243], a[112:115], v[104:107], a[240:243]
    buffer_load_dwordx4 v31, s[52:55], s6 offen offset:1024 lds
    v_mfma_f32_16x16x32_bf16 a[240:243], a[116:119], v[120:123], a[240:243]
    v_exp_f32 v42, v94
    v_mfma_f32_16x16x32_bf16 a[248:251], a[116:119], v[124:127], a[248:251]
    v_exp_f32 v43, v95
    v_mfma_f32_16x16x32_bf16 a[248:251], a[112:115], v[108:111], a[248:251]
    ds_read_b128 a[88:91], v10 offset:36864
    v_cvt_pk_bf16_f32 v159, v42, v43
    v_mfma_f32_16x16x32_bf16 a[252:255], a[120:123], v[108:111], a[252:255]
    buffer_load_dwordx4 v32, s[52:55], s6 offen offset:2048 lds
    v_mfma_f32_16x16x32_bf16 a[252:255], a[124:127], v[124:127], a[252:255]
    v_exp_f32 v44, v88
    v_mfma_f32_16x16x32_bf16 a[244:247], a[124:127], v[120:123], a[244:247]
    ds_read_b128 a[92:95], v11 offset:36864
    v_mfma_f32_16x16x32_bf16 a[244:247], a[120:123], v[104:107], a[244:247]
    v_exp_f32 v45, v89
    v_mfma_f32_16x16x32_bf16 a[236:239], a[120:123], v[100:103], a[236:239]
    buffer_load_dwordx4 v33, s[52:55], s6 offen offset:3072 lds
    v_mfma_f32_16x16x32_bf16 a[236:239], a[124:127], v[116:119], a[236:239]
    v_exp_f32 v46, v90
    v_mfma_f32_16x16x32_bf16 a[228:231], a[124:127], v[112:115], a[228:231]
    v_exp_f32 v47, v91
    v_mfma_f32_16x16x32_bf16 a[228:231], a[120:123], v[96:99], a[228:231]
    s_waitcnt lgkmcnt(0)
    v_cvt_pk_bf16_f32 v156, v44, v45
    v_cvt_pk_bf16_f32 v157, v46, v47
    v_mfma_f32_16x16x32_bf16 v[64:67], a[64:67], a[0:3], v[48:51]
    ds_read_b64_tr_b16 a[96:97], v12 offset:16384
    ds_read_b64_tr_b16 a[98:99], v12 offset:20480
    v_mfma_f32_16x16x32_bf16 v[64:67], a[68:71], a[4:7], v[64:67]
    ds_read_b64_tr_b16 a[100:101], v12 offset:24576
    ds_read_b64_tr_b16 a[102:103], v12 offset:28672
    v_mfma_f32_16x16x32_bf16 v[64:67], a[72:75], a[8:11], v[64:67]
    ds_read_b64_tr_b16 a[104:105], v13 offset:16384
    ds_read_b64_tr_b16 a[106:107], v13 offset:20480
    v_mfma_f32_16x16x32_bf16 v[64:67], a[76:79], a[12:15], v[64:67]
    ds_read_b64_tr_b16 a[108:109], v13 offset:24576
    ds_read_b64_tr_b16 a[110:111], v13 offset:28672
    v_mfma_f32_16x16x32_bf16 v[68:71], a[92:95], a[12:15], v[48:51]
    ds_read_b64_tr_b16 a[112:113], v14 offset:16384
    ds_read_b64_tr_b16 a[114:115], v14 offset:20480
    v_mfma_f32_16x16x32_bf16 v[68:71], a[88:91], a[8:11], v[68:71]
    ds_read_b64_tr_b16 a[116:117], v14 offset:24576
    ds_read_b64_tr_b16 a[118:119], v14 offset:28672
    v_mfma_f32_16x16x32_bf16 v[68:71], a[84:87], a[4:7], v[68:71]
    ds_read_b64_tr_b16 a[120:121], v15 offset:16384
    ds_read_b64_tr_b16 a[122:123], v15 offset:20480
    v_mfma_f32_16x16x32_bf16 v[68:71], a[80:83], a[0:3], v[68:71]
    ds_read_b64_tr_b16 a[124:125], v15 offset:24576
    ds_read_b64_tr_b16 a[126:127], v15 offset:28672
    v_mfma_f32_16x16x32_bf16 v[76:79], a[80:83], a[16:19], v[52:55]
    v_exp_f32 v40, v64
    v_mfma_f32_16x16x32_bf16 v[76:79], a[84:87], a[20:23], v[76:79]
    v_exp_f32 v41, v65
    v_mfma_f32_16x16x32_bf16 v[76:79], a[88:91], a[24:27], v[76:79]
    v_exp_f32 v42, v66
    v_mfma_f32_16x16x32_bf16 v[76:79], a[92:95], a[28:31], v[76:79]
    v_exp_f32 v43, v67
    v_mfma_f32_16x16x32_bf16 v[72:75], a[76:79], a[28:31], v[52:55]
    s_waitcnt vmcnt(8)
    v_cvt_pk_bf16_f32 v96, v40, v41
    v_cvt_pk_bf16_f32 v97, v42, v43
    v_mfma_f32_16x16x32_bf16 v[72:75], a[72:75], a[24:27], v[72:75]
    ds_read_b64_tr_b16 a[176:177], v36 offset:0
    ds_read_b64_tr_b16 a[178:179], v36 offset:2048
    v_mfma_f32_16x16x32_bf16 v[72:75], a[68:71], a[20:23], v[72:75]
    v_exp_f32 v44, v68
    v_mfma_f32_16x16x32_bf16 v[72:75], a[64:67], a[16:19], v[72:75]
    v_exp_f32 v45, v69
    v_mfma_f32_16x16x32_bf16 v[80:83], a[64:67], a[32:35], v[56:59]
    v_exp_f32 v46, v70
    v_mfma_f32_16x16x32_bf16 v[80:83], a[68:71], a[36:39], v[80:83]
    ds_read_b64_tr_b16 a[180:181], v37 offset:0
    ds_read_b64_tr_b16 a[182:183], v37 offset:2048
    v_mfma_f32_16x16x32_bf16 v[80:83], a[72:75], a[40:43], v[80:83]
    v_exp_f32 v47, v71
    v_mfma_f32_16x16x32_bf16 v[80:83], a[76:79], a[44:47], v[80:83]
    v_cvt_pk_bf16_f32 v98, v44, v45
    v_cvt_pk_bf16_f32 v99, v46, v47
    v_mfma_f32_16x16x32_bf16 v[84:87], a[92:95], a[44:47], v[56:59]
    v_exp_f32 v40, v76
    v_mfma_f32_16x16x32_bf16 v[84:87], a[88:91], a[40:43], v[84:87]
    ds_read_b64_tr_b16 a[184:185], v38 offset:0
    ds_read_b64_tr_b16 a[186:187], v38 offset:2048
    v_mfma_f32_16x16x32_bf16 v[84:87], a[84:87], a[36:39], v[84:87]
    v_exp_f32 v41, v77
    v_mfma_f32_16x16x32_bf16 v[84:87], a[80:83], a[32:35], v[84:87]
    v_exp_f32 v42, v78
    v_mfma_f32_16x16x32_bf16 v[92:95], a[80:83], a[48:51], v[60:63]
    v_exp_f32 v43, v79
    v_mfma_f32_16x16x32_bf16 v[92:95], a[84:87], a[52:55], v[92:95]
    ds_read_b64_tr_b16 a[188:189], v39 offset:0
    ds_read_b64_tr_b16 a[190:191], v39 offset:2048
    v_mfma_f32_16x16x32_bf16 v[92:95], a[88:91], a[56:59], v[92:95]
    v_cvt_pk_bf16_f32 v102, v40, v41
    v_cvt_pk_bf16_f32 v103, v42, v43
    v_mfma_f32_16x16x32_bf16 v[92:95], a[92:95], a[60:63], v[92:95]
    v_exp_f32 v44, v72
    v_mfma_f32_16x16x32_bf16 v[88:91], a[76:79], a[60:63], v[60:63]
    v_exp_f32 v45, v73
    v_mfma_f32_16x16x32_bf16 v[88:91], a[72:75], a[56:59], v[88:91]
    v_exp_f32 v46, v74
    v_mfma_f32_16x16x32_bf16 v[88:91], a[68:71], a[52:55], v[88:91]
    v_exp_f32 v47, v75
    v_mfma_f32_16x16x32_bf16 v[88:91], a[64:67], a[48:51], v[88:91]
    s_waitcnt lgkmcnt(0)
    v_cvt_pk_bf16_f32 v100, v44, v45
    v_cvt_pk_bf16_f32 v101, v46, v47
    v_smfmac_f32_16x16x64_bf16 a[132:135], a[136:139], v[152:159], v27
    v_smfmac_f32_16x16x64_bf16 a[128:131], a[136:139], v[144:151], v27
    s_add_u32 m0, s31, 114688
    ds_read_b128 a[64:67], v8 offset:40960
    v_mfma_f32_16x16x32_bf16 v[160:163], a[96:99], v[128:131], v[160:163]
    buffer_load_dwordx4 v24, s[20:23], s39 offen offset:0 lds
    v_mfma_f32_16x16x32_bf16 v[160:163], a[100:103], v[144:147], v[160:163]
    v_exp_f32 v40, v80
    v_mfma_f32_16x16x32_bf16 v[184:187], a[100:103], v[148:151], v[184:187]
    v_exp_f32 v41, v81
    v_mfma_f32_16x16x32_bf16 v[184:187], a[96:99], v[132:135], v[184:187]
    ds_read_b128 a[68:71], v9 offset:40960
    v_cvt_pk_bf16_f32 v104, v40, v41
    v_mfma_f32_16x16x32_bf16 v[208:211], a[96:99], v[136:139], v[208:211]
    buffer_load_dwordx4 v25, s[20:23], s39 offen offset:1024 lds
    v_mfma_f32_16x16x32_bf16 v[208:211], a[100:103], v[152:155], v[208:211]
    v_exp_f32 v42, v82
    v_mfma_f32_16x16x32_bf16 v[232:235], a[100:103], v[156:159], v[232:235]
    v_exp_f32 v43, v83
    v_mfma_f32_16x16x32_bf16 v[232:235], a[96:99], v[140:143], v[232:235]
    ds_read_b128 a[72:75], v10 offset:40960
    v_cvt_pk_bf16_f32 v105, v42, v43
    v_mfma_f32_16x16x32_bf16 v[236:239], a[104:107], v[140:143], v[236:239]
L_pad8:
    s_cbranch_execz L_pad12
    buffer_load_dwordx4 v24, s[20:23], s39 offen offset:2048 lds
    v_mfma_f32_16x16x32_bf16 v[236:239], a[108:111], v[156:159], v[236:239]
    v_exp_f32 v44, v84
    v_mfma_f32_16x16x32_bf16 v[212:215], a[108:111], v[152:155], v[212:215]
    v_exp_f32 v45, v85
    v_mfma_f32_16x16x32_bf16 v[212:215], a[104:107], v[136:139], v[212:215]
    ds_read_b128 a[76:79], v11 offset:40960
    v_cvt_pk_bf16_f32 v106, v44, v45
    v_mfma_f32_16x16x32_bf16 v[188:191], a[104:107], v[132:135], v[188:191]
    buffer_load_dwordx4 v25, s[20:23], s39 offen offset:3072 lds
    v_mfma_f32_16x16x32_bf16 v[188:191], a[108:111], v[148:151], v[188:191]
    s_add_u32 s6, s65, 0
    v_exp_f32 v46, v86
    v_mfma_f32_16x16x32_bf16 v[164:167], a[108:111], v[144:147], v[164:167]
    s_add_u32 m0, s31, 131072
    v_exp_f32 v47, v87
    v_mfma_f32_16x16x32_bf16 v[164:167], a[104:107], v[128:131], v[164:167]
    ds_read_b128 a[80:83], v8 offset:45056
    v_cvt_pk_bf16_f32 v107, v46, v47
    v_mfma_f32_16x16x32_bf16 v[168:171], a[112:115], v[128:131], v[168:171]
    buffer_load_dwordx4 v30, s[52:55], s6 offen offset:0 lds
    v_mfma_f32_16x16x32_bf16 v[168:171], a[116:119], v[144:147], v[168:171]
    v_exp_f32 v40, v92
    v_mfma_f32_16x16x32_bf16 v[192:195], a[116:119], v[148:151], v[192:195]
    v_exp_f32 v41, v93
    v_mfma_f32_16x16x32_bf16 v[192:195], a[112:115], v[132:135], v[192:195]
    ds_read_b128 a[84:87], v9 offset:45056
    v_cvt_pk_bf16_f32 v110, v40, v41
    v_mfma_f32_16x16x32_bf16 v[216:219], a[112:115], v[136:139], v[216:219]
    buffer_load_dwordx4 v31, s[52:55], s6 offen offset:1024 lds
    v_mfma_f32_16x16x32_bf16 v[216:219], a[116:119], v[152:155], v[216:219]
    v_exp_f32 v42, v94
    v_mfma_f32_16x16x32_bf16 v[240:243], a[116:119], v[156:159], v[240:243]
    v_exp_f32 v43, v95
    v_mfma_f32_16x16x32_bf16 v[240:243], a[112:115], v[140:143], v[240:243]
    ds_read_b128 a[88:91], v10 offset:45056
    v_cvt_pk_bf16_f32 v111, v42, v43
    v_mfma_f32_16x16x32_bf16 v[244:247], a[120:123], v[140:143], v[244:247]
    buffer_load_dwordx4 v32, s[52:55], s6 offen offset:2048 lds
    v_mfma_f32_16x16x32_bf16 v[244:247], a[124:127], v[156:159], v[244:247]
    v_exp_f32 v44, v88
    v_mfma_f32_16x16x32_bf16 v[220:223], a[124:127], v[152:155], v[220:223]
    s_add_u32 s39, s39, 16384
    ds_read_b128 a[92:95], v11 offset:45056
    v_mfma_f32_16x16x32_bf16 v[220:223], a[120:123], v[136:139], v[220:223]
    v_exp_f32 v45, v89
    v_mfma_f32_16x16x32_bf16 v[196:199], a[120:123], v[132:135], v[196:199]
    buffer_load_dwordx4 v33, s[52:55], s6 offen offset:3072 lds
    v_mfma_f32_16x16x32_bf16 v[196:199], a[124:127], v[148:151], v[196:199]
    v_exp_f32 v46, v90
    v_mfma_f32_16x16x32_bf16 v[172:175], a[124:127], v[144:147], v[172:175]
    v_exp_f32 v47, v91
    v_mfma_f32_16x16x32_bf16 v[172:175], a[120:123], v[128:131], v[172:175]
    s_waitcnt lgkmcnt(0)
    v_cvt_pk_bf16_f32 v108, v44, v45
    v_cvt_pk_bf16_f32 v109, v46, v47
    v_mfma_f32_16x16x32_bf16 v[64:67], a[64:67], a[0:3], v[48:51]
    ds_read_b64_tr_b16 a[96:97], v16 offset:16384
    ds_read_b64_tr_b16 a[98:99], v16 offset:20480
    v_mfma_f32_16x16x32_bf16 v[64:67], a[68:71], a[4:7], v[64:67]
    ds_read_b64_tr_b16 a[100:101], v16 offset:24576
    ds_read_b64_tr_b16 a[102:103], v16 offset:28672
    v_mfma_f32_16x16x32_bf16 v[64:67], a[72:75], a[8:11], v[64:67]
    ds_read_b64_tr_b16 a[104:105], v17 offset:16384
    ds_read_b64_tr_b16 a[106:107], v17 offset:20480
    v_mfma_f32_16x16x32_bf16 v[64:67], a[76:79], a[12:15], v[64:67]
    ds_read_b64_tr_b16 a[108:109], v17 offset:24576
    ds_read_b64_tr_b16 a[110:111], v17 offset:28672
    v_mfma_f32_16x16x32_bf16 v[68:71], a[92:95], a[12:15], v[48:51]
    ds_read_b64_tr_b16 a[112:113], v18 offset:16384
    ds_read_b64_tr_b16 a[114:115], v18 offset:20480
    v_mfma_f32_16x16x32_bf16 v[68:71], a[88:91], a[8:11], v[68:71]
    ds_read_b64_tr_b16 a[116:117], v18 offset:24576
    ds_read_b64_tr_b16 a[118:119], v18 offset:28672
    v_mfma_f32_16x16x32_bf16 v[68:71], a[84:87], a[4:7], v[68:71]
    ds_read_b64_tr_b16 a[120:121], v19 offset:16384
    ds_read_b64_tr_b16 a[122:123], v19 offset:20480
    v_mfma_f32_16x16x32_bf16 v[68:71], a[80:83], a[0:3], v[68:71]
    ds_read_b64_tr_b16 a[124:125], v19 offset:24576
    ds_read_b64_tr_b16 a[126:127], v19 offset:28672
    v_mfma_f32_16x16x32_bf16 v[76:79], a[80:83], a[16:19], v[52:55]
    v_exp_f32 v40, v64
    v_mfma_f32_16x16x32_bf16 v[76:79], a[84:87], a[20:23], v[76:79]
    v_exp_f32 v41, v65
    v_mfma_f32_16x16x32_bf16 v[76:79], a[88:91], a[24:27], v[76:79]
    v_exp_f32 v42, v66
    v_mfma_f32_16x16x32_bf16 v[76:79], a[92:95], a[28:31], v[76:79]
    v_exp_f32 v43, v67
    v_mfma_f32_16x16x32_bf16 v[72:75], a[76:79], a[28:31], v[52:55]
    s_waitcnt vmcnt(8)
    v_cvt_pk_bf16_f32 v112, v40, v41
    v_cvt_pk_bf16_f32 v113, v42, v43
    v_mfma_f32_16x16x32_bf16 v[72:75], a[72:75], a[24:27], v[72:75]
    ds_read_b64_tr_b16 a[192:193], v36 offset:16384
    ds_read_b64_tr_b16 a[194:195], v36 offset:18432
    v_mfma_f32_16x16x32_bf16 v[72:75], a[68:71], a[20:23], v[72:75]
    v_exp_f32 v44, v68
    v_mfma_f32_16x16x32_bf16 v[72:75], a[64:67], a[16:19], v[72:75]
    v_exp_f32 v45, v69
    v_mfma_f32_16x16x32_bf16 v[80:83], a[64:67], a[32:35], v[56:59]
    v_exp_f32 v46, v70
    v_mfma_f32_16x16x32_bf16 v[80:83], a[68:71], a[36:39], v[80:83]
    ds_read_b64_tr_b16 a[196:197], v37 offset:16384
    ds_read_b64_tr_b16 a[198:199], v37 offset:18432
    v_mfma_f32_16x16x32_bf16 v[80:83], a[72:75], a[40:43], v[80:83]
    v_exp_f32 v47, v71
    v_mfma_f32_16x16x32_bf16 v[80:83], a[76:79], a[44:47], v[80:83]
    v_cvt_pk_bf16_f32 v114, v44, v45
    v_cvt_pk_bf16_f32 v115, v46, v47
    v_mfma_f32_16x16x32_bf16 v[84:87], a[92:95], a[44:47], v[56:59]
    v_exp_f32 v40, v76
    v_mfma_f32_16x16x32_bf16 v[84:87], a[88:91], a[40:43], v[84:87]
    ds_read_b64_tr_b16 a[200:201], v38 offset:16384
    ds_read_b64_tr_b16 a[202:203], v38 offset:18432
    v_mfma_f32_16x16x32_bf16 v[84:87], a[84:87], a[36:39], v[84:87]
    v_exp_f32 v41, v77
    v_mfma_f32_16x16x32_bf16 v[84:87], a[80:83], a[32:35], v[84:87]
    v_exp_f32 v42, v78
    v_mfma_f32_16x16x32_bf16 v[92:95], a[80:83], a[48:51], v[60:63]
    v_exp_f32 v43, v79
    v_mfma_f32_16x16x32_bf16 v[92:95], a[84:87], a[52:55], v[92:95]
    ds_read_b64_tr_b16 a[204:205], v39 offset:16384
    ds_read_b64_tr_b16 a[206:207], v39 offset:18432
    v_mfma_f32_16x16x32_bf16 v[92:95], a[88:91], a[56:59], v[92:95]
    v_cvt_pk_bf16_f32 v118, v40, v41
    v_cvt_pk_bf16_f32 v119, v42, v43
    v_mfma_f32_16x16x32_bf16 v[92:95], a[92:95], a[60:63], v[92:95]
    v_exp_f32 v44, v72
    v_mfma_f32_16x16x32_bf16 v[88:91], a[76:79], a[60:63], v[60:63]
    v_exp_f32 v45, v73
    v_mfma_f32_16x16x32_bf16 v[88:91], a[72:75], a[56:59], v[88:91]
    v_exp_f32 v46, v74
    v_mfma_f32_16x16x32_bf16 v[88:91], a[68:71], a[52:55], v[88:91]
    s_add_u32 s34, s66, 32768
    v_exp_f32 v47, v75
    v_mfma_f32_16x16x32_bf16 v[88:91], a[64:67], a[48:51], v[88:91]
    s_waitcnt vmcnt(20) lgkmcnt(0)
    v_cvt_pk_bf16_f32 v116, v44, v45
    v_cvt_pk_bf16_f32 v117, v46, v47
    v_smfmac_f32_16x16x64_bf16 a[132:135], a[136:139], v[104:111], v27
    s_barrier
    v_smfmac_f32_16x16x64_bf16 a[128:131], a[136:139], v[96:103], v27
    s_add_u32 m0, s31, 65536
    ds_read_b128 a[64:67], v8 offset:49152
    v_mfma_f32_16x16x32_bf16 v[176:179], a[96:99], v[128:131], v[176:179]
    buffer_load_dwordx4 v30, s[52:55], s34 offen offset:0 lds
    v_mfma_f32_16x16x32_bf16 v[176:179], a[100:103], v[144:147], v[176:179]
    v_exp_f32 v40, v80
    v_mfma_f32_16x16x32_bf16 v[200:203], a[100:103], v[148:151], v[200:203]
    v_exp_f32 v41, v81
    v_mfma_f32_16x16x32_bf16 v[200:203], a[96:99], v[132:135], v[200:203]
    ds_read_b128 a[68:71], v9 offset:49152
    v_cvt_pk_bf16_f32 v120, v40, v41
    v_mfma_f32_16x16x32_bf16 v[224:227], a[96:99], v[136:139], v[224:227]
    buffer_load_dwordx4 v31, s[52:55], s34 offen offset:1024 lds
    v_mfma_f32_16x16x32_bf16 v[224:227], a[100:103], v[152:155], v[224:227]
    v_exp_f32 v42, v82
    v_mfma_f32_16x16x32_bf16 v[248:251], a[100:103], v[156:159], v[248:251]
    v_exp_f32 v43, v83
    v_mfma_f32_16x16x32_bf16 v[248:251], a[96:99], v[140:143], v[248:251]
    ds_read_b128 a[72:75], v10 offset:49152
    v_cvt_pk_bf16_f32 v121, v42, v43
    v_mfma_f32_16x16x32_bf16 v[252:255], a[104:107], v[140:143], v[252:255]
    buffer_load_dwordx4 v32, s[52:55], s34 offen offset:2048 lds
    v_mfma_f32_16x16x32_bf16 v[252:255], a[108:111], v[156:159], v[252:255]
    v_exp_f32 v44, v84
    v_mfma_f32_16x16x32_bf16 v[228:231], a[108:111], v[152:155], v[228:231]
    v_exp_f32 v45, v85
    v_mfma_f32_16x16x32_bf16 v[228:231], a[104:107], v[136:139], v[228:231]
    ds_read_b128 a[76:79], v11 offset:49152
    v_cvt_pk_bf16_f32 v122, v44, v45
    v_mfma_f32_16x16x32_bf16 v[204:207], a[104:107], v[132:135], v[204:207]
    buffer_load_dwordx4 v33, s[52:55], s34 offen offset:3072 lds
    v_mfma_f32_16x16x32_bf16 v[204:207], a[108:111], v[148:151], v[204:207]
    s_add_u32 s6, s65, 32768
    v_exp_f32 v46, v86
    v_mfma_f32_16x16x32_bf16 v[180:183], a[108:111], v[144:147], v[180:183]
    s_add_u32 m0, s31, 147456
    v_exp_f32 v47, v87
    v_mfma_f32_16x16x32_bf16 v[180:183], a[104:107], v[128:131], v[180:183]
    ds_read_b128 a[80:83], v8 offset:53248
    v_cvt_pk_bf16_f32 v123, v46, v47
    v_mfma_f32_16x16x32_bf16 a[224:227], a[112:115], v[128:131], a[224:227]
    buffer_load_dwordx4 v30, s[52:55], s6 offen offset:0 lds
    v_mfma_f32_16x16x32_bf16 a[224:227], a[116:119], v[144:147], a[224:227]
    v_exp_f32 v40, v92
    v_mfma_f32_16x16x32_bf16 a[232:235], a[116:119], v[148:151], a[232:235]
    v_exp_f32 v41, v93
    v_mfma_f32_16x16x32_bf16 a[232:235], a[112:115], v[132:135], a[232:235]
    ds_read_b128 a[84:87], v9 offset:53248
    v_cvt_pk_bf16_f32 v126, v40, v41
    v_mfma_f32_16x16x32_bf16 a[240:243], a[112:115], v[136:139], a[240:243]
    buffer_load_dwordx4 v31, s[52:55], s6 offen offset:1024 lds
    v_mfma_f32_16x16x32_bf16 a[240:243], a[116:119], v[152:155], a[240:243]
    v_exp_f32 v42, v94
    v_mfma_f32_16x16x32_bf16 a[248:251], a[116:119], v[156:159], a[248:251]
    v_exp_f32 v43, v95
    v_mfma_f32_16x16x32_bf16 a[248:251], a[112:115], v[140:143], a[248:251]
    ds_read_b128 a[88:91], v10 offset:53248
    v_cvt_pk_bf16_f32 v127, v42, v43
    v_mfma_f32_16x16x32_bf16 a[252:255], a[120:123], v[140:143], a[252:255]
    buffer_load_dwordx4 v32, s[52:55], s6 offen offset:2048 lds
    v_mfma_f32_16x16x32_bf16 a[252:255], a[124:127], v[156:159], a[252:255]
    v_exp_f32 v44, v88
    v_mfma_f32_16x16x32_bf16 a[244:247], a[124:127], v[152:155], a[244:247]
    ds_read_b128 a[92:95], v11 offset:53248
    v_mfma_f32_16x16x32_bf16 a[244:247], a[120:123], v[136:139], a[244:247]
    v_exp_f32 v45, v89
    v_mfma_f32_16x16x32_bf16 a[236:239], a[120:123], v[132:135], a[236:239]
    buffer_load_dwordx4 v33, s[52:55], s6 offen offset:3072 lds
    v_mfma_f32_16x16x32_bf16 a[236:239], a[124:127], v[148:151], a[236:239]
    v_exp_f32 v46, v90
    v_mfma_f32_16x16x32_bf16 a[228:231], a[124:127], v[144:147], a[228:231]
    v_exp_f32 v47, v91
    v_mfma_f32_16x16x32_bf16 a[228:231], a[120:123], v[128:131], a[228:231]
    s_waitcnt lgkmcnt(0)
    v_cvt_pk_bf16_f32 v124, v44, v45
    v_cvt_pk_bf16_f32 v125, v46, v47
    v_mfma_f32_16x16x32_bf16 v[64:67], a[64:67], a[0:3], v[48:51]
    ds_read_b64_tr_b16 a[96:97], v12 offset:32768
    ds_read_b64_tr_b16 a[98:99], v12 offset:36864
    v_mfma_f32_16x16x32_bf16 v[64:67], a[68:71], a[4:7], v[64:67]
    ds_read_b64_tr_b16 a[100:101], v12 offset:40960
    ds_read_b64_tr_b16 a[102:103], v12 offset:45056
    v_mfma_f32_16x16x32_bf16 v[64:67], a[72:75], a[8:11], v[64:67]
    ds_read_b64_tr_b16 a[104:105], v13 offset:32768
    ds_read_b64_tr_b16 a[106:107], v13 offset:36864
    v_mfma_f32_16x16x32_bf16 v[64:67], a[76:79], a[12:15], v[64:67]
    ds_read_b64_tr_b16 a[108:109], v13 offset:40960
    ds_read_b64_tr_b16 a[110:111], v13 offset:45056
    v_mfma_f32_16x16x32_bf16 v[68:71], a[92:95], a[12:15], v[48:51]
    ds_read_b64_tr_b16 a[112:113], v14 offset:32768
    ds_read_b64_tr_b16 a[114:115], v14 offset:36864
    v_mfma_f32_16x16x32_bf16 v[68:71], a[88:91], a[8:11], v[68:71]
    ds_read_b64_tr_b16 a[116:117], v14 offset:40960
    ds_read_b64_tr_b16 a[118:119], v14 offset:45056
    v_mfma_f32_16x16x32_bf16 v[68:71], a[84:87], a[4:7], v[68:71]
    ds_read_b64_tr_b16 a[120:121], v15 offset:32768
    ds_read_b64_tr_b16 a[122:123], v15 offset:36864
    v_mfma_f32_16x16x32_bf16 v[68:71], a[80:83], a[0:3], v[68:71]
    ds_read_b64_tr_b16 a[124:125], v15 offset:40960
    ds_read_b64_tr_b16 a[126:127], v15 offset:45056
    v_mfma_f32_16x16x32_bf16 v[76:79], a[80:83], a[16:19], v[52:55]
    v_exp_f32 v40, v64
    v_mfma_f32_16x16x32_bf16 v[76:79], a[84:87], a[20:23], v[76:79]
    v_exp_f32 v41, v65
    v_mfma_f32_16x16x32_bf16 v[76:79], a[88:91], a[24:27], v[76:79]
    v_exp_f32 v42, v66
    v_mfma_f32_16x16x32_bf16 v[76:79], a[92:95], a[28:31], v[76:79]
    v_exp_f32 v43, v67
    v_mfma_f32_16x16x32_bf16 v[72:75], a[76:79], a[28:31], v[52:55]
    s_waitcnt vmcnt(8)
    v_cvt_pk_bf16_f32 v128, v40, v41
    v_cvt_pk_bf16_f32 v129, v42, v43
    v_mfma_f32_16x16x32_bf16 v[72:75], a[72:75], a[24:27], v[72:75]
    ds_read_b64_tr_b16 a[208:209], v36 offset:0
    ds_read_b64_tr_b16 a[210:211], v36 offset:2048
    v_mfma_f32_16x16x32_bf16 v[72:75], a[68:71], a[20:23], v[72:75]
    v_exp_f32 v44, v68
    v_mfma_f32_16x16x32_bf16 v[72:75], a[64:67], a[16:19], v[72:75]
    v_exp_f32 v45, v69
    v_mfma_f32_16x16x32_bf16 v[80:83], a[64:67], a[32:35], v[56:59]
    v_exp_f32 v46, v70
    v_mfma_f32_16x16x32_bf16 v[80:83], a[68:71], a[36:39], v[80:83]
    ds_read_b64_tr_b16 a[212:213], v37 offset:0
    ds_read_b64_tr_b16 a[214:215], v37 offset:2048
    v_mfma_f32_16x16x32_bf16 v[80:83], a[72:75], a[40:43], v[80:83]
    v_exp_f32 v47, v71
    v_mfma_f32_16x16x32_bf16 v[80:83], a[76:79], a[44:47], v[80:83]
    v_cvt_pk_bf16_f32 v130, v44, v45
    v_cvt_pk_bf16_f32 v131, v46, v47
    v_mfma_f32_16x16x32_bf16 v[84:87], a[92:95], a[44:47], v[56:59]
    v_exp_f32 v40, v76
    v_mfma_f32_16x16x32_bf16 v[84:87], a[88:91], a[40:43], v[84:87]
    ds_read_b64_tr_b16 a[216:217], v38 offset:0
    ds_read_b64_tr_b16 a[218:219], v38 offset:2048
    v_mfma_f32_16x16x32_bf16 v[84:87], a[84:87], a[36:39], v[84:87]
    v_exp_f32 v41, v77
    v_mfma_f32_16x16x32_bf16 v[84:87], a[80:83], a[32:35], v[84:87]
    v_exp_f32 v42, v78
    v_mfma_f32_16x16x32_bf16 v[92:95], a[80:83], a[48:51], v[60:63]
    v_exp_f32 v43, v79
    v_mfma_f32_16x16x32_bf16 v[92:95], a[84:87], a[52:55], v[92:95]
    ds_read_b64_tr_b16 a[220:221], v39 offset:0
    ds_read_b64_tr_b16 a[222:223], v39 offset:2048
    v_mfma_f32_16x16x32_bf16 v[92:95], a[88:91], a[56:59], v[92:95]
    v_cvt_pk_bf16_f32 v134, v40, v41
    v_cvt_pk_bf16_f32 v135, v42, v43
    v_mfma_f32_16x16x32_bf16 v[92:95], a[92:95], a[60:63], v[92:95]
    v_exp_f32 v44, v72
    v_mfma_f32_16x16x32_bf16 v[88:91], a[76:79], a[60:63], v[60:63]
    v_exp_f32 v45, v73
    v_mfma_f32_16x16x32_bf16 v[88:91], a[72:75], a[56:59], v[88:91]
    v_exp_f32 v46, v74
    v_mfma_f32_16x16x32_bf16 v[88:91], a[68:71], a[52:55], v[88:91]
    v_exp_f32 v47, v75
    v_mfma_f32_16x16x32_bf16 v[88:91], a[64:67], a[48:51], v[88:91]
    s_waitcnt lgkmcnt(0)
    v_cvt_pk_bf16_f32 v132, v44, v45
    v_cvt_pk_bf16_f32 v133, v46, v47
    v_smfmac_f32_16x16x64_bf16 a[132:135], a[136:139], v[120:127], v27
    s_add_u32 s34, s66, 65536
    v_smfmac_f32_16x16x64_bf16 a[128:131], a[136:139], v[112:119], v27
    s_add_u32 m0, s31, 32768
    ds_read_b128 a[64:67], v8 offset:57344
    v_mfma_f32_16x16x32_bf16 v[160:163], a[96:99], v[96:99], v[160:163]
    buffer_load_dwordx4 v30, s[52:55], s34 offen offset:0 lds
    v_mfma_f32_16x16x32_bf16 v[160:163], a[100:103], v[112:115], v[160:163]
    v_exp_f32 v40, v80
    v_mfma_f32_16x16x32_bf16 v[184:187], a[100:103], v[116:119], v[184:187]
    v_exp_f32 v41, v81
    v_mfma_f32_16x16x32_bf16 v[184:187], a[96:99], v[100:103], v[184:187]
    ds_read_b128 a[68:71], v9 offset:57344
    v_cvt_pk_bf16_f32 v136, v40, v41
    v_mfma_f32_16x16x32_bf16 v[208:211], a[96:99], v[104:107], v[208:211]
    buffer_load_dwordx4 v31, s[52:55], s34 offen offset:1024 lds
    v_mfma_f32_16x16x32_bf16 v[208:211], a[100:103], v[120:123], v[208:211]
    v_exp_f32 v42, v82
    v_mfma_f32_16x16x32_bf16 v[232:235], a[100:103], v[124:127], v[232:235]
    v_exp_f32 v43, v83
    v_mfma_f32_16x16x32_bf16 v[232:235], a[96:99], v[108:111], v[232:235]
    ds_read_b128 a[72:75], v10 offset:57344
    v_cvt_pk_bf16_f32 v137, v42, v43
    v_mfma_f32_16x16x32_bf16 v[236:239], a[104:107], v[108:111], v[236:239]
    buffer_load_dwordx4 v32, s[52:55], s34 offen offset:2048 lds
    v_mfma_f32_16x16x32_bf16 v[236:239], a[108:111], v[124:127], v[236:239]
    v_exp_f32 v44, v84
    v_mfma_f32_16x16x32_bf16 v[212:215], a[108:111], v[120:123], v[212:215]
    v_exp_f32 v45, v85
    v_mfma_f32_16x16x32_bf16 v[212:215], a[104:107], v[104:107], v[212:215]
    ds_read_b128 a[76:79], v11 offset:57344
    v_cvt_pk_bf16_f32 v138, v44, v45
    v_mfma_f32_16x16x32_bf16 v[188:191], a[104:107], v[100:103], v[188:191]
    buffer_load_dwordx4 v33, s[52:55], s34 offen offset:3072 lds
    v_mfma_f32_16x16x32_bf16 v[188:191], a[108:111], v[116:119], v[188:191]
    s_add_u32 s6, s65, 65536
    v_exp_f32 v46, v86
    v_mfma_f32_16x16x32_bf16 v[164:167], a[108:111], v[112:115], v[164:167]
    s_add_u32 m0, s31, 131072
    v_exp_f32 v47, v87
    v_mfma_f32_16x16x32_bf16 v[164:167], a[104:107], v[96:99], v[164:167]
    ds_read_b128 a[80:83], v8 offset:61440
    v_cvt_pk_bf16_f32 v139, v46, v47
    v_mfma_f32_16x16x32_bf16 v[168:171], a[112:115], v[96:99], v[168:171]
    buffer_load_dwordx4 v30, s[52:55], s6 offen offset:0 lds
    v_mfma_f32_16x16x32_bf16 v[168:171], a[116:119], v[112:115], v[168:171]
    v_exp_f32 v40, v92
    v_mfma_f32_16x16x32_bf16 v[192:195], a[116:119], v[116:119], v[192:195]
    v_exp_f32 v41, v93
    v_mfma_f32_16x16x32_bf16 v[192:195], a[112:115], v[100:103], v[192:195]
    ds_read_b128 a[84:87], v9 offset:61440
    v_cvt_pk_bf16_f32 v142, v40, v41
    v_mfma_f32_16x16x32_bf16 v[216:219], a[112:115], v[104:107], v[216:219]
    buffer_load_dwordx4 v31, s[52:55], s6 offen offset:1024 lds
    v_mfma_f32_16x16x32_bf16 v[216:219], a[116:119], v[120:123], v[216:219]
    v_exp_f32 v42, v94
    v_mfma_f32_16x16x32_bf16 v[240:243], a[116:119], v[124:127], v[240:243]
    v_exp_f32 v43, v95
    v_mfma_f32_16x16x32_bf16 v[240:243], a[112:115], v[108:111], v[240:243]
    ds_read_b128 a[88:91], v10 offset:61440
    v_cvt_pk_bf16_f32 v143, v42, v43
    v_mfma_f32_16x16x32_bf16 v[244:247], a[120:123], v[108:111], v[244:247]
    buffer_load_dwordx4 v32, s[52:55], s6 offen offset:2048 lds
    v_mfma_f32_16x16x32_bf16 v[244:247], a[124:127], v[124:127], v[244:247]
    v_exp_f32 v44, v88
    v_mfma_f32_16x16x32_bf16 v[220:223], a[124:127], v[120:123], v[220:223]
    ds_read_b128 a[92:95], v11 offset:61440
    v_mfma_f32_16x16x32_bf16 v[220:223], a[120:123], v[104:107], v[220:223]
    v_exp_f32 v45, v89
    v_mfma_f32_16x16x32_bf16 v[196:199], a[120:123], v[100:103], v[196:199]
    buffer_load_dwordx4 v33, s[52:55], s6 offen offset:3072 lds
    v_mfma_f32_16x16x32_bf16 v[196:199], a[124:127], v[116:119], v[196:199]
    v_exp_f32 v46, v90
    v_mfma_f32_16x16x32_bf16 v[172:175], a[124:127], v[112:115], v[172:175]
    v_exp_f32 v47, v91
    v_mfma_f32_16x16x32_bf16 v[172:175], a[120:123], v[96:99], v[172:175]
    s_waitcnt lgkmcnt(0)
    v_cvt_pk_bf16_f32 v140, v44, v45
    v_cvt_pk_bf16_f32 v141, v46, v47
    v_mfma_f32_16x16x32_bf16 v[64:67], a[64:67], a[0:3], v[48:51]
    ds_read_b64_tr_b16 a[96:97], v16 offset:32768
    ds_read_b64_tr_b16 a[98:99], v16 offset:36864
    v_mfma_f32_16x16x32_bf16 v[64:67], a[68:71], a[4:7], v[64:67]
    ds_read_b64_tr_b16 a[100:101], v16 offset:40960
    ds_read_b64_tr_b16 a[102:103], v16 offset:45056
    v_mfma_f32_16x16x32_bf16 v[64:67], a[72:75], a[8:11], v[64:67]
    ds_read_b64_tr_b16 a[104:105], v17 offset:32768
    ds_read_b64_tr_b16 a[106:107], v17 offset:36864
    v_mfma_f32_16x16x32_bf16 v[64:67], a[76:79], a[12:15], v[64:67]
    ds_read_b64_tr_b16 a[108:109], v17 offset:40960
    ds_read_b64_tr_b16 a[110:111], v17 offset:45056
    v_mfma_f32_16x16x32_bf16 v[68:71], a[92:95], a[12:15], v[48:51]
    ds_read_b64_tr_b16 a[112:113], v18 offset:32768
    ds_read_b64_tr_b16 a[114:115], v18 offset:36864
    v_mfma_f32_16x16x32_bf16 v[68:71], a[88:91], a[8:11], v[68:71]
    ds_read_b64_tr_b16 a[116:117], v18 offset:40960
    ds_read_b64_tr_b16 a[118:119], v18 offset:45056
    v_mfma_f32_16x16x32_bf16 v[68:71], a[84:87], a[4:7], v[68:71]
    ds_read_b64_tr_b16 a[120:121], v19 offset:32768
    ds_read_b64_tr_b16 a[122:123], v19 offset:36864
    v_mfma_f32_16x16x32_bf16 v[68:71], a[80:83], a[0:3], v[68:71]
    ds_read_b64_tr_b16 a[124:125], v19 offset:40960
    ds_read_b64_tr_b16 a[126:127], v19 offset:45056
    v_mfma_f32_16x16x32_bf16 v[76:79], a[80:83], a[16:19], v[52:55]
    v_exp_f32 v40, v64
    v_mfma_f32_16x16x32_bf16 v[76:79], a[84:87], a[20:23], v[76:79]
    s_add_u32 s6, s66, 98304
    v_exp_f32 v41, v65
    v_mfma_f32_16x16x32_bf16 v[76:79], a[88:91], a[24:27], v[76:79]
    s_add_u32 m0, s31, 81920
    v_exp_f32 v42, v66
    v_mfma_f32_16x16x32_bf16 v[76:79], a[92:95], a[28:31], v[76:79]
    buffer_load_dwordx4 v30, s[52:55], s6 offen offset:0 lds
    v_mfma_f32_16x16x32_bf16 v[72:75], a[76:79], a[28:31], v[52:55]
    v_exp_f32 v43, v67
    v_mfma_f32_16x16x32_bf16 v[72:75], a[72:75], a[24:27], v[72:75]
    v_cvt_pk_bf16_f32 v144, v40, v41
    v_cvt_pk_bf16_f32 v145, v42, v43
    v_mfma_f32_16x16x32_bf16 v[72:75], a[68:71], a[20:23], v[72:75]
    v_exp_f32 v44, v68
    v_mfma_f32_16x16x32_bf16 v[72:75], a[64:67], a[16:19], v[72:75]
    buffer_load_dwordx4 v31, s[52:55], s6 offen offset:1024 lds
    v_mfma_f32_16x16x32_bf16 v[80:83], a[64:67], a[32:35], v[56:59]
    v_exp_f32 v45, v69
    v_mfma_f32_16x16x32_bf16 v[80:83], a[68:71], a[36:39], v[80:83]
    v_exp_f32 v46, v70
    v_mfma_f32_16x16x32_bf16 v[80:83], a[72:75], a[40:43], v[80:83]
    v_exp_f32 v47, v71
    v_mfma_f32_16x16x32_bf16 v[80:83], a[76:79], a[44:47], v[80:83]
    buffer_load_dwordx4 v32, s[52:55], s6 offen offset:2048 lds
    v_mfma_f32_16x16x32_bf16 v[84:87], a[92:95], a[44:47], v[56:59]
    v_cvt_pk_bf16_f32 v146, v44, v45
    v_cvt_pk_bf16_f32 v147, v46, v47
    v_mfma_f32_16x16x32_bf16 v[84:87], a[88:91], a[40:43], v[84:87]
    v_exp_f32 v40, v76
    v_mfma_f32_16x16x32_bf16 v[84:87], a[84:87], a[36:39], v[84:87]
    v_exp_f32 v41, v77
    v_mfma_f32_16x16x32_bf16 v[84:87], a[80:83], a[32:35], v[84:87]
    buffer_load_dwordx4 v33, s[52:55], s6 offen offset:3072 lds
    v_mfma_f32_16x16x32_bf16 v[92:95], a[80:83], a[48:51], v[60:63]
    v_exp_f32 v42, v78
    v_mfma_f32_16x16x32_bf16 v[92:95], a[84:87], a[52:55], v[92:95]
    v_exp_f32 v43, v79
    v_mfma_f32_16x16x32_bf16 v[92:95], a[88:91], a[56:59], v[92:95]
    v_cvt_pk_bf16_f32 v150, v40, v41
    v_cvt_pk_bf16_f32 v151, v42, v43
    v_mfma_f32_16x16x32_bf16 v[92:95], a[92:95], a[60:63], v[92:95]
    v_exp_f32 v44, v72
    v_mfma_f32_16x16x32_bf16 v[88:91], a[76:79], a[60:63], v[60:63]
    v_exp_f32 v45, v73
    v_mfma_f32_16x16x32_bf16 v[88:91], a[72:75], a[56:59], v[88:91]
    v_exp_f32 v46, v74
    v_mfma_f32_16x16x32_bf16 v[88:91], a[68:71], a[52:55], v[88:91]
    s_add_u32 s34, s67, 0
    v_exp_f32 v47, v75
    v_mfma_f32_16x16x32_bf16 v[88:91], a[64:67], a[48:51], v[88:91]
    s_waitcnt vmcnt(24) lgkmcnt(0)
    v_cvt_pk_bf16_f32 v148, v44, v45
    v_cvt_pk_bf16_f32 v149, v46, v47
    v_smfmac_f32_16x16x64_bf16 a[132:135], a[136:139], v[136:143], v27
    s_barrier
    v_smfmac_f32_16x16x64_bf16 a[128:131], a[136:139], v[128:135], v27
    s_add_u32 m0, s31, 49152
    v_mfma_f32_16x16x32_bf16 v[176:179], a[96:99], v[96:99], v[176:179]
    buffer_load_dwordx4 v30, s[52:55], s34 offen offset:0 lds
    v_mfma_f32_16x16x32_bf16 v[176:179], a[100:103], v[112:115], v[176:179]
    v_exp_f32 v40, v80
    v_mfma_f32_16x16x32_bf16 v[200:203], a[100:103], v[116:119], v[200:203]
    v_exp_f32 v41, v81
    v_mfma_f32_16x16x32_bf16 v[200:203], a[96:99], v[100:103], v[200:203]
    v_exp_f32 v42, v82
    v_mfma_f32_16x16x32_bf16 v[224:227], a[96:99], v[104:107], v[224:227]
    buffer_load_dwordx4 v31, s[52:55], s34 offen offset:1024 lds
    v_mfma_f32_16x16x32_bf16 v[224:227], a[100:103], v[120:123], v[224:227]
    v_exp_f32 v43, v83
    v_mfma_f32_16x16x32_bf16 v[248:251], a[100:103], v[124:127], v[248:251]
    v_cvt_pk_bf16_f32 v152, v40, v41
    v_cvt_pk_bf16_f32 v153, v42, v43
    v_mfma_f32_16x16x32_bf16 v[248:251], a[96:99], v[108:111], v[248:251]
    v_exp_f32 v44, v84
    v_mfma_f32_16x16x32_bf16 v[252:255], a[104:107], v[108:111], v[252:255]
    buffer_load_dwordx4 v32, s[52:55], s34 offen offset:2048 lds
    v_mfma_f32_16x16x32_bf16 v[252:255], a[108:111], v[124:127], v[252:255]
    v_exp_f32 v45, v85
    v_mfma_f32_16x16x32_bf16 v[228:231], a[108:111], v[120:123], v[228:231]
    v_exp_f32 v46, v86
    v_mfma_f32_16x16x32_bf16 v[228:231], a[104:107], v[104:107], v[228:231]
    v_exp_f32 v47, v87
    v_mfma_f32_16x16x32_bf16 v[204:207], a[104:107], v[100:103], v[204:207]
    buffer_load_dwordx4 v33, s[52:55], s34 offen offset:3072 lds
    v_mfma_f32_16x16x32_bf16 v[204:207], a[108:111], v[116:119], v[204:207]
    v_cvt_pk_bf16_f32 v154, v44, v45
    v_cvt_pk_bf16_f32 v155, v46, v47
    v_mfma_f32_16x16x32_bf16 v[180:183], a[108:111], v[112:115], v[180:183]
    s_add_u32 s6, s67, 32768
    v_exp_f32 v40, v92
    v_mfma_f32_16x16x32_bf16 v[180:183], a[104:107], v[96:99], v[180:183]
    s_add_u32 m0, s31, 98304
    v_exp_f32 v41, v93
    v_mfma_f32_16x16x32_bf16 a[224:227], a[112:115], v[96:99], a[224:227]
    buffer_load_dwordx4 v30, s[52:55], s6 offen offset:0 lds
    v_mfma_f32_16x16x32_bf16 a[224:227], a[116:119], v[112:115], a[224:227]
    s_waitcnt vmcnt(17)
    v_exp_f32 v42, v94
    v_mfma_f32_16x16x32_bf16 a[232:235], a[116:119], v[116:119], a[232:235]
    ds_read_b64_tr_b16 a[64:65], v36 offset:16384
    ds_read_b64_tr_b16 a[66:67], v36 offset:18432
    v_mfma_f32_16x16x32_bf16 a[232:235], a[112:115], v[100:103], a[232:235]
    v_exp_f32 v43, v95
    v_mfma_f32_16x16x32_bf16 a[240:243], a[112:115], v[104:107], a[240:243]
    buffer_load_dwordx4 v31, s[52:55], s6 offen offset:1024 lds
    v_mfma_f32_16x16x32_bf16 a[240:243], a[116:119], v[120:123], a[240:243]
    v_cvt_pk_bf16_f32 v158, v40, v41
    v_cvt_pk_bf16_f32 v159, v42, v43
    v_mfma_f32_16x16x32_bf16 a[248:251], a[116:119], v[124:127], a[248:251]
    ds_read_b64_tr_b16 a[68:69], v37 offset:16384
    ds_read_b64_tr_b16 a[70:71], v37 offset:18432
    v_mfma_f32_16x16x32_bf16 a[248:251], a[112:115], v[108:111], a[248:251]
    v_exp_f32 v44, v88
    v_mfma_f32_16x16x32_bf16 a[252:255], a[120:123], v[108:111], a[252:255]
    buffer_load_dwordx4 v32, s[52:55], s6 offen offset:2048 lds
    v_mfma_f32_16x16x32_bf16 a[252:255], a[124:127], v[124:127], a[252:255]
    v_exp_f32 v45, v89
    v_mfma_f32_16x16x32_bf16 a[244:247], a[124:127], v[120:123], a[244:247]
    ds_read_b64_tr_b16 a[72:73], v38 offset:16384
    ds_read_b64_tr_b16 a[74:75], v38 offset:18432
    v_mfma_f32_16x16x32_bf16 a[244:247], a[120:123], v[104:107], a[244:247]
    v_exp_f32 v46, v90
    v_mfma_f32_16x16x32_bf16 a[236:239], a[120:123], v[100:103], a[236:239]
    buffer_load_dwordx4 v33, s[52:55], s6 offen offset:3072 lds
    v_mfma_f32_16x16x32_bf16 a[236:239], a[124:127], v[116:119], a[236:239]
    v_exp_f32 v47, v91
    v_mfma_f32_16x16x32_bf16 a[228:231], a[124:127], v[112:115], a[228:231]
    ds_read_b64_tr_b16 a[76:77], v39 offset:16384
    ds_read_b64_tr_b16 a[78:79], v39 offset:18432
    v_mfma_f32_16x16x32_bf16 a[228:231], a[120:123], v[96:99], a[228:231]
    s_waitcnt lgkmcnt(0)
    v_cvt_pk_bf16_f32 v156, v44, v45
    v_cvt_pk_bf16_f32 v157, v46, v47
    ds_read_b64_tr_b16 a[96:97], v12 offset:49152
    ds_read_b64_tr_b16 a[98:99], v12 offset:53248
    ds_read_b64_tr_b16 a[100:101], v12 offset:57344
    ds_read_b64_tr_b16 a[102:103], v12 offset:61440
    ds_read_b64_tr_b16 a[104:105], v13 offset:49152
    ds_read_b64_tr_b16 a[106:107], v13 offset:53248
    ds_read_b64_tr_b16 a[108:109], v13 offset:57344
    ds_read_b64_tr_b16 a[110:111], v13 offset:61440
    ds_read_b64_tr_b16 a[112:113], v14 offset:49152
    ds_read_b64_tr_b16 a[114:115], v14 offset:53248
    ds_read_b64_tr_b16 a[116:117], v14 offset:57344
    ds_read_b64_tr_b16 a[118:119], v14 offset:61440
    ds_read_b64_tr_b16 a[120:121], v15 offset:49152
    ds_read_b64_tr_b16 a[122:123], v15 offset:53248
    ds_read_b64_tr_b16 a[124:125], v15 offset:57344
    ds_read_b64_tr_b16 a[126:127], v15 offset:61440
    v_smfmac_f32_16x16x64_bf16 a[132:135], a[136:139], v[152:159], v27
    s_add_u32 m0, s31, 147456
    s_add_u32 s34, s67, 65536
    v_smfmac_f32_16x16x64_bf16 a[128:131], a[136:139], v[144:151], v27
    buffer_load_dwordx4 v30, s[52:55], s34 offen offset:0 lds
    s_waitcnt lgkmcnt(12)
    v_mfma_f32_16x16x32_bf16 v[160:163], a[96:99], v[128:131], v[160:163]
    s_waitcnt vmcnt(13)
    ds_read_b64_tr_b16 a[80:81], v36 offset:0
    v_mfma_f32_16x16x32_bf16 v[160:163], a[100:103], v[144:147], v[160:163]
    ds_read_b64_tr_b16 a[82:83], v36 offset:2048
    ds_read_b64_tr_b16 a[84:85], v37 offset:0
    v_mfma_f32_16x16x32_bf16 v[184:187], a[100:103], v[148:151], v[184:187]
    buffer_load_dwordx4 v31, s[52:55], s34 offen offset:1024 lds
    v_mfma_f32_16x16x32_bf16 v[184:187], a[96:99], v[132:135], v[184:187]
    ds_read_b64_tr_b16 a[86:87], v37 offset:2048
    ds_read_b64_tr_b16 a[88:89], v38 offset:0
    v_mfma_f32_16x16x32_bf16 v[208:211], a[96:99], v[136:139], v[208:211]
L_pad9:
    s_cbranch_execz L_pad13
    v_accvgpr_read_b32 v70, a134
    v_accvgpr_read_b32 v71, a135
    v_mfma_f32_16x16x32_bf16 v[208:211], a[100:103], v[152:155], v[208:211]
    buffer_load_dwordx4 v32, s[52:55], s34 offen offset:2048 lds
    v_mfma_f32_16x16x32_bf16 v[232:235], a[100:103], v[156:159], v[232:235]
    ds_read_b64_tr_b16 a[90:91], v38 offset:2048
    ds_read_b64_tr_b16 a[92:93], v39 offset:0
    v_mfma_f32_16x16x32_bf16 v[232:235], a[96:99], v[140:143], v[232:235]
    ds_read_b64_tr_b16 a[94:95], v39 offset:2048
    v_add_f32 v71, v70, v71
    s_waitcnt lgkmcnt(15)
    v_mfma_f32_16x16x32_bf16 v[236:239], a[104:107], v[140:143], v[236:239]
    buffer_load_dwordx4 v33, s[52:55], s34 offen offset:3072 lds
    v_mfma_f32_16x16x32_bf16 v[236:239], a[108:111], v[156:159], v[236:239]
    s_barrier
    v_mfma_f32_16x16x32_bf16 v[212:215], a[108:111], v[152:155], v[212:215]
    s_add_u32 s75, s62, 196608
    v_rcp_f32 v70, v71
    v_mfma_f32_16x16x32_bf16 v[212:215], a[104:107], v[136:139], v[212:215]
    s_add_u32 m0, s31, 131072
    v_lshlrev_b32 v5, 4, v1
    v_add_u32 v52, 8388608, v5
    v_mfma_f32_16x16x32_bf16 v[188:191], a[104:107], v[132:135], v[188:191]
    s_add_u32 s34, s67, 98304
    v_accvgpr_read_b32 v68, a132
    v_accvgpr_read_b32 v69, a133
    v_mfma_f32_16x16x32_bf16 v[188:191], a[108:111], v[148:151], v[188:191]
    s_waitcnt lgkmcnt(0)
    v_mul_f32 v232, v232, v70
    v_mul_f32 v233, v233, v70
    v_mfma_f32_16x16x32_bf16 v[164:167], a[108:111], v[144:147], v[164:167]
    buffer_load_dwordx4 v30, s[52:55], s34 offen offset:0 lds
    v_mfma_f32_16x16x32_bf16 v[164:167], a[104:107], v[128:131], v[164:167]
    s_add_u32 s74, s62, 131072
    v_mul_f32 v234, v234, v70
    v_mul_f32 v235, v235, v70
    s_waitcnt lgkmcnt(12)
    v_mfma_f32_16x16x32_bf16 v[168:171], a[112:115], v[128:131], v[168:171]
    s_add_u32 s73, s62, 65536
    v_mul_f32 v236, v236, v70
    v_mul_f32 v237, v237, v70
    v_mfma_f32_16x16x32_bf16 v[168:171], a[116:119], v[144:147], v[168:171]
    buffer_load_dwordx4 v31, s[52:55], s34 offen offset:1024 lds
    v_mfma_f32_16x16x32_bf16 v[192:195], a[116:119], v[148:151], v[192:195]
    s_add_u32 s72, s62, 0
    v_mul_f32 v238, v238, v70
    v_mul_f32 v239, v239, v70
    v_mfma_f32_16x16x32_bf16 v[192:195], a[112:115], v[132:135], v[192:195]
    v_cvt_pk_bf16_f32 v232, v232, v233
    v_cvt_pk_bf16_f32 v233, v234, v235
    v_mfma_f32_16x16x32_bf16 v[216:219], a[112:115], v[136:139], v[216:219]
    buffer_load_dwordx4 v32, s[52:55], s34 offen offset:2048 lds
    v_mfma_f32_16x16x32_bf16 v[216:219], a[116:119], v[152:155], v[216:219]
    v_cvt_pk_bf16_f32 v234, v236, v237
    v_cvt_pk_bf16_f32 v235, v238, v239
    v_mfma_f32_16x16x32_bf16 v[240:243], a[116:119], v[156:159], v[240:243]
    buffer_load_dwordx4 v33, s[52:55], s34 offen offset:3072 lds
    v_mfma_f32_16x16x32_bf16 v[240:243], a[112:115], v[140:143], v[240:243]
    buffer_store_dwordx4 v[232:235], v52, s[24:27], s75 offen sc1
    s_waitcnt lgkmcnt(8)
    v_mfma_f32_16x16x32_bf16 v[244:247], a[120:123], v[140:143], v[244:247]
    ds_read_b64_tr_b16 a[96:97], v16 offset:49152
    ds_read_b64_tr_b16 a[98:99], v16 offset:53248
    v_mfma_f32_16x16x32_bf16 v[244:247], a[124:127], v[156:159], v[244:247]
    v_accvgpr_read_b32 v66, a130
    v_accvgpr_read_b32 v67, a131
    v_mfma_f32_16x16x32_bf16 v[220:223], a[124:127], v[152:155], v[220:223]
    ds_read_b64_tr_b16 a[100:101], v16 offset:57344
    ds_read_b64_tr_b16 a[102:103], v16 offset:61440
    v_mfma_f32_16x16x32_bf16 v[220:223], a[120:123], v[136:139], v[220:223]
    v_accvgpr_read_b32 v64, a128
    v_accvgpr_read_b32 v65, a129
    v_mfma_f32_16x16x32_bf16 v[196:199], a[120:123], v[132:135], v[196:199]
    s_mov_b32 s3, 0x5f800000
    v_add_f32 v69, v68, v69
    v_add_f32 v67, v66, v67
    v_mfma_f32_16x16x32_bf16 v[196:199], a[124:127], v[148:151], v[196:199]
    v_add_f32 v65, v64, v65
    v_cmp_nlt_f32 s[98:99], v71, s3
    v_mfma_f32_16x16x32_bf16 v[172:175], a[124:127], v[144:147], v[172:175]
    v_rcp_f32 v68, v69
    v_mfma_f32_16x16x32_bf16 v[172:175], a[120:123], v[128:131], v[172:175]
    ds_read_b64_tr_b16 a[104:105], v17 offset:49152
    ds_read_b64_tr_b16 a[106:107], v17 offset:53248
    s_waitcnt lgkmcnt(2)
    v_mfma_f32_16x16x32_bf16 v[176:179], a[96:99], v[128:131], v[176:179]
    v_cmp_nlt_f32 s[96:97], v69, s3
    v_cmp_nlt_f32 s[94:95], v67, s3
    v_mfma_f32_16x16x32_bf16 v[176:179], a[100:103], v[144:147], v[176:179]
    ds_read_b64_tr_b16 a[108:109], v17 offset:57344
    ds_read_b64_tr_b16 a[110:111], v17 offset:61440
    v_mfma_f32_16x16x32_bf16 v[200:203], a[100:103], v[148:151], v[200:203]
    v_cmp_nlt_f32 s[92:93], v65, s3
    v_lshlrev_b32 v73, 2, v2
    v_mfma_f32_16x16x32_bf16 v[200:203], a[96:99], v[132:135], v[200:203]
    s_or_b64 s[96:97], s[96:97], s[98:99]
    v_mul_f32 v208, v208, v68
    v_mul_f32 v209, v209, v68
    v_mfma_f32_16x16x32_bf16 v[224:227], a[96:99], v[136:139], v[224:227]
    s_or_b64 s[92:93], s[92:93], s[94:95]
    v_mul_f32 v210, v210, v68
    v_mul_f32 v211, v211, v68
    v_mfma_f32_16x16x32_bf16 v[224:227], a[100:103], v[152:155], v[224:227]
    s_or_b64 s[92:93], s[92:93], s[96:97]
    v_mul_f32 v212, v212, v68
    v_mul_f32 v213, v213, v68
    v_mfma_f32_16x16x32_bf16 v[248:251], a[100:103], v[156:159], v[248:251]
    s_or_b32 s92, s92, s93
    v_mul_f32 v214, v214, v68
    v_mul_f32 v215, v215, v68
    v_mfma_f32_16x16x32_bf16 v[248:251], a[96:99], v[140:143], v[248:251]
    ds_read_b64_tr_b16 a[112:113], v18 offset:49152
    ds_read_b64_tr_b16 a[114:115], v18 offset:53248
    s_waitcnt lgkmcnt(2)
    v_mfma_f32_16x16x32_bf16 v[252:255], a[104:107], v[140:143], v[252:255]
    v_cvt_pk_bf16_f32 v208, v208, v209
    v_cvt_pk_bf16_f32 v209, v210, v211
    v_mfma_f32_16x16x32_bf16 v[252:255], a[108:111], v[156:159], v[252:255]
    ds_read_b64_tr_b16 a[116:117], v18 offset:57344
    ds_read_b64_tr_b16 a[118:119], v18 offset:61440
    v_mfma_f32_16x16x32_bf16 v[228:231], a[108:111], v[152:155], v[228:231]
    v_cvt_pk_bf16_f32 v210, v212, v213
    v_cvt_pk_bf16_f32 v211, v214, v215
    v_mfma_f32_16x16x32_bf16 v[228:231], a[104:107], v[136:139], v[228:231]
    buffer_store_dwordx4 v[208:211], v52, s[24:27], s74 offen sc1
    v_mfma_f32_16x16x32_bf16 v[204:207], a[104:107], v[132:135], v[204:207]
    v_add_u32 v73, 114688, v73
    v_mov_b32 v6, s92
    v_mfma_f32_16x16x32_bf16 v[204:207], a[108:111], v[148:151], v[204:207]
    ds_write_b32 v73, v6
    v_mov_b32 v72, 114688
    v_mfma_f32_16x16x32_bf16 v[180:183], a[108:111], v[144:147], v[180:183]
    v_rcp_f32 v66, v67
    v_mfma_f32_16x16x32_bf16 v[180:183], a[104:107], v[128:131], v[180:183]
    ds_read_b64_tr_b16 a[120:121], v19 offset:49152
    ds_read_b64_tr_b16 a[122:123], v19 offset:53248
    s_waitcnt lgkmcnt(3)
    v_mfma_f32_16x16x32_bf16 a[224:227], a[112:115], v[128:131], a[224:227]
    v_rcp_f32 v64, v65
    v_mfma_f32_16x16x32_bf16 a[224:227], a[116:119], v[144:147], a[224:227]
    ds_read_b64_tr_b16 a[124:125], v19 offset:57344
    ds_read_b64_tr_b16 a[126:127], v19 offset:61440
    v_mfma_f32_16x16x32_bf16 a[232:235], a[116:119], v[148:151], a[232:235]
    s_waitcnt lgkmcnt(4)
    s_barrier
    v_mfma_f32_16x16x32_bf16 a[232:235], a[112:115], v[132:135], a[232:235]
    ds_read_b128 v[72:75], v72
    v_add_u32 v53, 8404992, v5
    v_mfma_f32_16x16x32_bf16 a[240:243], a[112:115], v[136:139], a[240:243]
    v_add_u32 v54, 8421376, v5
    v_add_u32 v55, 8437760, v5
    v_mfma_f32_16x16x32_bf16 a[240:243], a[116:119], v[152:155], a[240:243]
    v_mul_f32 v184, v184, v66
    v_mul_f32 v185, v185, v66
    v_mfma_f32_16x16x32_bf16 a[248:251], a[116:119], v[156:159], a[248:251]
    v_mul_f32 v186, v186, v66
    v_mul_f32 v187, v187, v66
    v_mfma_f32_16x16x32_bf16 a[248:251], a[112:115], v[140:143], a[248:251]
    v_mul_f32 v188, v188, v66
    v_mul_f32 v189, v189, v66
    s_waitcnt lgkmcnt(1)
    v_mfma_f32_16x16x32_bf16 a[252:255], a[120:123], v[140:143], a[252:255]
    s_waitcnt lgkmcnt(0)
    v_or3_b32 v6, v72, v73, v74
    v_or_b32 v6, v6, v75
    v_mfma_f32_16x16x32_bf16 a[252:255], a[124:127], v[156:159], a[252:255]
    v_mul_f32 v190, v190, v66
    v_mul_f32 v191, v191, v66
    v_mfma_f32_16x16x32_bf16 a[244:247], a[124:127], v[152:155], a[244:247]
    v_readfirstlane_b32 s42, v6
    v_mfma_f32_16x16x32_bf16 a[244:247], a[120:123], v[136:139], a[244:247]
    v_cvt_pk_bf16_f32 v184, v184, v185
    v_cvt_pk_bf16_f32 v185, v186, v187
    v_mfma_f32_16x16x32_bf16 a[236:239], a[120:123], v[132:135], a[236:239]
    v_cvt_pk_bf16_f32 v186, v188, v189
    v_cvt_pk_bf16_f32 v187, v190, v191
    v_mfma_f32_16x16x32_bf16 a[236:239], a[124:127], v[148:151], a[236:239]
    buffer_store_dwordx4 v[184:187], v52, s[24:27], s73 offen sc1
    v_mfma_f32_16x16x32_bf16 a[228:231], a[124:127], v[144:147], a[228:231]
    s_cmp_lg_u32 s37, 0
    s_cselect_b32 s42, 0, s42
    s_cmp_lg_u32 s42, 0
    s_cbranch_scc1 L_fallback
    v_mfma_f32_16x16x32_bf16 a[228:231], a[120:123], v[128:131], a[228:231]
    v_pk_mul_f32 v[160:161], v[160:161], v[64:65] op_sel_hi:[1,0]
    v_pk_mul_f32 v[162:163], v[162:163], v[64:65] op_sel_hi:[1,0]
    v_pk_mul_f32 v[164:165], v[164:165], v[64:65] op_sel_hi:[1,0]
    v_pk_mul_f32 v[166:167], v[166:167], v[64:65] op_sel_hi:[1,0]
    v_cvt_pk_bf16_f32 v160, v160, v161
    v_cvt_pk_bf16_f32 v161, v162, v163
    v_cvt_pk_bf16_f32 v162, v164, v165
    v_cvt_pk_bf16_f32 v163, v166, v167
    buffer_store_dwordx4 v[160:163], v52, s[24:27], s72 offen sc1
    v_pk_mul_f32 v[240:241], v[240:241], v[70:71] op_sel_hi:[1,0]
    v_pk_mul_f32 v[242:243], v[242:243], v[70:71] op_sel_hi:[1,0]
    v_pk_mul_f32 v[244:245], v[244:245], v[70:71] op_sel_hi:[1,0]
    v_pk_mul_f32 v[246:247], v[246:247], v[70:71] op_sel_hi:[1,0]
    v_cvt_pk_bf16_f32 v240, v240, v241
    v_cvt_pk_bf16_f32 v241, v242, v243
    v_cvt_pk_bf16_f32 v242, v244, v245
    v_cvt_pk_bf16_f32 v243, v246, v247
    buffer_store_dwordx4 v[240:243], v53, s[24:27], s75 offen sc1
    v_subrev_u32 v40, 131072, v36
    v_subrev_u32 v44, 65536, v36
    v_mov_b32 v48, v36
    v_subrev_u32 v41, 131072, v37
    v_subrev_u32 v45, 65536, v37
    v_mov_b32 v49, v37
    v_subrev_u32 v42, 131072, v38
    v_subrev_u32 v46, 65536, v38
    v_mov_b32 v50, v38
    v_subrev_u32 v43, 131072, v39
    v_subrev_u32 v47, 65536, v39
    v_mov_b32 v51, v39
    v_pk_mul_f32 v[216:217], v[216:217], v[68:69] op_sel_hi:[1,0]
    v_pk_mul_f32 v[218:219], v[218:219], v[68:69] op_sel_hi:[1,0]
    v_pk_mul_f32 v[220:221], v[220:221], v[68:69] op_sel_hi:[1,0]
    v_pk_mul_f32 v[222:223], v[222:223], v[68:69] op_sel_hi:[1,0]
    v_cvt_pk_bf16_f32 v216, v216, v217
    v_cvt_pk_bf16_f32 v217, v218, v219
    v_cvt_pk_bf16_f32 v218, v220, v221
    v_cvt_pk_bf16_f32 v219, v222, v223
    buffer_store_dwordx4 v[216:219], v53, s[24:27], s74 offen sc1
    v_pk_mul_f32 v[192:193], v[192:193], v[66:67] op_sel_hi:[1,0]
    v_pk_mul_f32 v[194:195], v[194:195], v[66:67] op_sel_hi:[1,0]
    v_pk_mul_f32 v[196:197], v[196:197], v[66:67] op_sel_hi:[1,0]
    v_pk_mul_f32 v[198:199], v[198:199], v[66:67] op_sel_hi:[1,0]
    v_cvt_pk_bf16_f32 v192, v192, v193
    v_cvt_pk_bf16_f32 v193, v194, v195
    v_cvt_pk_bf16_f32 v194, v196, v197
    v_cvt_pk_bf16_f32 v195, v198, v199
    buffer_store_dwordx4 v[192:195], v53, s[24:27], s73 offen sc1
    v_pk_mul_f32 v[168:169], v[168:169], v[64:65] op_sel_hi:[1,0]
    v_pk_mul_f32 v[170:171], v[170:171], v[64:65] op_sel_hi:[1,0]
    v_pk_mul_f32 v[172:173], v[172:173], v[64:65] op_sel_hi:[1,0]
    v_pk_mul_f32 v[174:175], v[174:175], v[64:65] op_sel_hi:[1,0]
    v_cvt_pk_bf16_f32 v168, v168, v169
    v_cvt_pk_bf16_f32 v169, v170, v171
    v_cvt_pk_bf16_f32 v170, v172, v173
    v_cvt_pk_bf16_f32 v171, v174, v175
    buffer_store_dwordx4 v[168:171], v53, s[24:27], s72 offen sc1
    s_waitcnt vmcnt(63) lgkmcnt(0)
    ds_read_b64_tr_b16 a[0:1], v40 offset:0
    ds_read_b64_tr_b16 a[2:3], v40 offset:2048
    ds_read_b64_tr_b16 a[4:5], v41 offset:0
    ds_read_b64_tr_b16 a[6:7], v41 offset:2048
    ds_read_b64_tr_b16 a[8:9], v42 offset:0
    ds_read_b64_tr_b16 a[10:11], v42 offset:2048
    ds_read_b64_tr_b16 a[12:13], v43 offset:0
    ds_read_b64_tr_b16 a[14:15], v43 offset:2048
    v_pk_mul_f32 v[248:249], v[248:249], v[70:71] op_sel_hi:[1,0]
    v_pk_mul_f32 v[250:251], v[250:251], v[70:71] op_sel_hi:[1,0]
    v_pk_mul_f32 v[252:253], v[252:253], v[70:71] op_sel_hi:[1,0]
    v_pk_mul_f32 v[254:255], v[254:255], v[70:71] op_sel_hi:[1,0]
    v_cvt_pk_bf16_f32 v248, v248, v249
    v_cvt_pk_bf16_f32 v249, v250, v251
    v_cvt_pk_bf16_f32 v250, v252, v253
    v_cvt_pk_bf16_f32 v251, v254, v255
    buffer_store_dwordx4 v[248:251], v54, s[24:27], s75 offen sc1
    s_waitcnt vmcnt(57) lgkmcnt(0)
    ds_read_b64_tr_b16 a[16:17], v40 offset:16384
    ds_read_b64_tr_b16 a[18:19], v40 offset:18432
    ds_read_b64_tr_b16 a[20:21], v41 offset:16384
    ds_read_b64_tr_b16 a[22:23], v41 offset:18432
    ds_read_b64_tr_b16 a[24:25], v42 offset:16384
    ds_read_b64_tr_b16 a[26:27], v42 offset:18432
    ds_read_b64_tr_b16 a[28:29], v43 offset:16384
    ds_read_b64_tr_b16 a[30:31], v43 offset:18432
    v_pk_mul_f32 v[224:225], v[224:225], v[68:69] op_sel_hi:[1,0]
    v_pk_mul_f32 v[226:227], v[226:227], v[68:69] op_sel_hi:[1,0]
    v_pk_mul_f32 v[228:229], v[228:229], v[68:69] op_sel_hi:[1,0]
    v_pk_mul_f32 v[230:231], v[230:231], v[68:69] op_sel_hi:[1,0]
    v_cvt_pk_bf16_f32 v224, v224, v225
    v_cvt_pk_bf16_f32 v225, v226, v227
    v_cvt_pk_bf16_f32 v226, v228, v229
    v_cvt_pk_bf16_f32 v227, v230, v231
    buffer_store_dwordx4 v[224:227], v54, s[24:27], s74 offen sc1
    s_waitcnt vmcnt(42) lgkmcnt(0)
    ds_read_b64_tr_b16 a[32:33], v44 offset:0
    ds_read_b64_tr_b16 a[34:35], v44 offset:2048
    ds_read_b64_tr_b16 a[36:37], v45 offset:0
    ds_read_b64_tr_b16 a[38:39], v45 offset:2048
    ds_read_b64_tr_b16 a[40:41], v46 offset:0
    ds_read_b64_tr_b16 a[42:43], v46 offset:2048
    ds_read_b64_tr_b16 a[44:45], v47 offset:0
    ds_read_b64_tr_b16 a[46:47], v47 offset:2048
    v_pk_mul_f32 v[200:201], v[200:201], v[66:67] op_sel_hi:[1,0]
    v_pk_mul_f32 v[202:203], v[202:203], v[66:67] op_sel_hi:[1,0]
    v_pk_mul_f32 v[204:205], v[204:205], v[66:67] op_sel_hi:[1,0]
    v_pk_mul_f32 v[206:207], v[206:207], v[66:67] op_sel_hi:[1,0]
    v_cvt_pk_bf16_f32 v200, v200, v201
    v_cvt_pk_bf16_f32 v201, v202, v203
    v_cvt_pk_bf16_f32 v202, v204, v205
    v_cvt_pk_bf16_f32 v203, v206, v207
    buffer_store_dwordx4 v[200:203], v54, s[24:27], s73 offen sc1
    s_waitcnt vmcnt(35) lgkmcnt(0)
    ds_read_b64_tr_b16 a[48:49], v40 offset:32768
    ds_read_b64_tr_b16 a[50:51], v40 offset:34816
    ds_read_b64_tr_b16 a[52:53], v41 offset:32768
    ds_read_b64_tr_b16 a[54:55], v41 offset:34816
    ds_read_b64_tr_b16 a[56:57], v42 offset:32768
    ds_read_b64_tr_b16 a[58:59], v42 offset:34816
    ds_read_b64_tr_b16 a[60:61], v43 offset:32768
    ds_read_b64_tr_b16 a[62:63], v43 offset:34816
    v_pk_mul_f32 v[176:177], v[176:177], v[64:65] op_sel_hi:[1,0]
    v_pk_mul_f32 v[178:179], v[178:179], v[64:65] op_sel_hi:[1,0]
    v_pk_mul_f32 v[180:181], v[180:181], v[64:65] op_sel_hi:[1,0]
    v_pk_mul_f32 v[182:183], v[182:183], v[64:65] op_sel_hi:[1,0]
    v_cvt_pk_bf16_f32 v176, v176, v177
    v_cvt_pk_bf16_f32 v177, v178, v179
    v_cvt_pk_bf16_f32 v178, v180, v181
    v_cvt_pk_bf16_f32 v179, v182, v183
    buffer_store_dwordx4 v[176:179], v54, s[24:27], s72 offen sc1
    s_waitcnt vmcnt(28) lgkmcnt(0)
    ds_read_b64_tr_b16 a[128:129], v44 offset:16384
    ds_read_b64_tr_b16 a[130:131], v44 offset:18432
    ds_read_b64_tr_b16 a[132:133], v45 offset:16384
    ds_read_b64_tr_b16 a[134:135], v45 offset:18432
    ds_read_b64_tr_b16 a[136:137], v46 offset:16384
    ds_read_b64_tr_b16 a[138:139], v46 offset:18432
    ds_read_b64_tr_b16 a[140:141], v47 offset:16384
    ds_read_b64_tr_b16 a[142:143], v47 offset:18432
    v_accvgpr_read_b32 v96, a224
    v_accvgpr_read_b32 v97, a225
    v_accvgpr_read_b32 v98, a226
    v_accvgpr_read_b32 v99, a227
    v_accvgpr_read_b32 v100, a228
    v_accvgpr_read_b32 v101, a229
    v_accvgpr_read_b32 v102, a230
    v_accvgpr_read_b32 v103, a231
    v_pk_mul_f32 v[96:97], v[96:97], v[64:65] op_sel_hi:[1,0]
    v_pk_mul_f32 v[98:99], v[98:99], v[64:65] op_sel_hi:[1,0]
    v_pk_mul_f32 v[100:101], v[100:101], v[64:65] op_sel_hi:[1,0]
    v_pk_mul_f32 v[102:103], v[102:103], v[64:65] op_sel_hi:[1,0]
    v_cvt_pk_bf16_f32 v96, v96, v97
    v_cvt_pk_bf16_f32 v97, v98, v99
    v_cvt_pk_bf16_f32 v98, v100, v101
    v_cvt_pk_bf16_f32 v99, v102, v103
    buffer_store_dwordx4 v[96:99], v55, s[24:27], s72 offen sc1
    s_waitcnt vmcnt(25) lgkmcnt(0)
    ds_read_b64_tr_b16 a[96:97], v40 offset:49152
    ds_read_b64_tr_b16 a[98:99], v40 offset:51200
    ds_read_b64_tr_b16 a[100:101], v41 offset:49152
    ds_read_b64_tr_b16 a[102:103], v41 offset:51200
    ds_read_b64_tr_b16 a[104:105], v42 offset:49152
    ds_read_b64_tr_b16 a[106:107], v42 offset:51200
    ds_read_b64_tr_b16 a[108:109], v43 offset:49152
    ds_read_b64_tr_b16 a[110:111], v43 offset:51200
    v_accvgpr_read_b32 v104, a232
    v_accvgpr_read_b32 v105, a233
    v_accvgpr_read_b32 v106, a234
    v_accvgpr_read_b32 v107, a235
    v_accvgpr_read_b32 v108, a236
    v_accvgpr_read_b32 v109, a237
    v_accvgpr_read_b32 v110, a238
    v_accvgpr_read_b32 v111, a239
    v_pk_mul_f32 v[104:105], v[104:105], v[66:67] op_sel_hi:[1,0]
    v_pk_mul_f32 v[106:107], v[106:107], v[66:67] op_sel_hi:[1,0]
    v_pk_mul_f32 v[108:109], v[108:109], v[66:67] op_sel_hi:[1,0]
    v_pk_mul_f32 v[110:111], v[110:111], v[66:67] op_sel_hi:[1,0]
    v_cvt_pk_bf16_f32 v104, v104, v105
    v_cvt_pk_bf16_f32 v105, v106, v107
    v_cvt_pk_bf16_f32 v106, v108, v109
    v_cvt_pk_bf16_f32 v107, v110, v111
    buffer_store_dwordx4 v[104:107], v55, s[24:27], s73 offen sc1
    s_waitcnt vmcnt(22) lgkmcnt(0)
    ds_read_b64_tr_b16 a[112:113], v44 offset:32768
    ds_read_b64_tr_b16 a[114:115], v44 offset:34816
    ds_read_b64_tr_b16 a[116:117], v45 offset:32768
    ds_read_b64_tr_b16 a[118:119], v45 offset:34816
    ds_read_b64_tr_b16 a[120:121], v46 offset:32768
    ds_read_b64_tr_b16 a[122:123], v46 offset:34816
    ds_read_b64_tr_b16 a[124:125], v47 offset:32768
    ds_read_b64_tr_b16 a[126:127], v47 offset:34816
    v_accvgpr_read_b32 v112, a240
    v_accvgpr_read_b32 v113, a241
    v_accvgpr_read_b32 v114, a242
    v_accvgpr_read_b32 v115, a243
    v_accvgpr_read_b32 v116, a244
    v_accvgpr_read_b32 v117, a245
    v_accvgpr_read_b32 v118, a246
    v_accvgpr_read_b32 v119, a247
    v_pk_mul_f32 v[112:113], v[112:113], v[68:69] op_sel_hi:[1,0]
    v_pk_mul_f32 v[114:115], v[114:115], v[68:69] op_sel_hi:[1,0]
    v_pk_mul_f32 v[116:117], v[116:117], v[68:69] op_sel_hi:[1,0]
    v_pk_mul_f32 v[118:119], v[118:119], v[68:69] op_sel_hi:[1,0]
    v_cvt_pk_bf16_f32 v112, v112, v113
    v_cvt_pk_bf16_f32 v113, v114, v115
    v_cvt_pk_bf16_f32 v114, v116, v117
    v_cvt_pk_bf16_f32 v115, v118, v119
    buffer_store_dwordx4 v[112:115], v55, s[24:27], s74 offen sc1
    s_waitcnt vmcnt(19) lgkmcnt(0)
    ds_read_b64_tr_b16 a[224:225], v48 offset:16384
    ds_read_b64_tr_b16 a[226:227], v48 offset:18432
    ds_read_b64_tr_b16 a[228:229], v49 offset:16384
    ds_read_b64_tr_b16 a[230:231], v49 offset:18432
    ds_read_b64_tr_b16 a[232:233], v50 offset:16384
    ds_read_b64_tr_b16 a[234:235], v50 offset:18432
    ds_read_b64_tr_b16 a[236:237], v51 offset:16384
    ds_read_b64_tr_b16 a[238:239], v51 offset:18432
    v_accvgpr_read_b32 v120, a248
    v_accvgpr_read_b32 v121, a249
    v_accvgpr_read_b32 v122, a250
    v_accvgpr_read_b32 v123, a251
    v_accvgpr_read_b32 v124, a252
    v_accvgpr_read_b32 v125, a253
    v_accvgpr_read_b32 v126, a254
    v_accvgpr_read_b32 v127, a255
    v_pk_mul_f32 v[120:121], v[120:121], v[70:71] op_sel_hi:[1,0]
    v_pk_mul_f32 v[122:123], v[122:123], v[70:71] op_sel_hi:[1,0]
    v_pk_mul_f32 v[124:125], v[124:125], v[70:71] op_sel_hi:[1,0]
    v_pk_mul_f32 v[126:127], v[126:127], v[70:71] op_sel_hi:[1,0]
    v_cvt_pk_bf16_f32 v120, v120, v121
    v_cvt_pk_bf16_f32 v121, v122, v123
    v_cvt_pk_bf16_f32 v122, v124, v125
    v_cvt_pk_bf16_f32 v123, v126, v127
    buffer_store_dwordx4 v[120:123], v55, s[24:27], s75 offen sc1
    s_waitcnt vmcnt(16) lgkmcnt(0)
    ds_read_b64_tr_b16 a[240:241], v48 offset:0
    ds_read_b64_tr_b16 a[242:243], v48 offset:2048
    ds_read_b64_tr_b16 a[244:245], v49 offset:0
    ds_read_b64_tr_b16 a[246:247], v49 offset:2048
    ds_read_b64_tr_b16 a[248:249], v50 offset:0
    ds_read_b64_tr_b16 a[250:251], v50 offset:2048
    ds_read_b64_tr_b16 a[252:253], v51 offset:0
    ds_read_b64_tr_b16 a[254:255], v51 offset:2048
    s_lshr_b32 s3, s68, 2
    s_lshl_b32 s3, s3, 18
    s_and_b32 s42, s68, 3
    s_lshl_b32 s42, s42, 10
    s_add_u32 s3, s3, s42
    s_lshl_b32 s42, s28, 12
    s_add_u32 s3, s3, s42
    s_and_b32 s63, s30, 0
    s_lshl_b32 s42, s63, 16
    s_add_u32 s3, s3, s42
    s_lshl_b32 s63, s63, 4
    s_xor_b32 s42, s3, 1024
    s_lshr_b32 s43, s64, 19
    s_lshl_b32 s43, s43, 21
    s_add_u32 s72, s43, s42
    s_add_u32 s76, s43, s3
    s_lshr_b32 s43, s65, 19
    s_lshl_b32 s43, s43, 21
    s_add_u32 s73, s43, s42
    s_add_u32 s77, s43, s3
    s_lshr_b32 s43, s66, 19
    s_lshl_b32 s43, s43, 21
    s_add_u32 s74, s43, s42
    s_add_u32 s78, s43, s3
    s_lshr_b32 s43, s67, 19
    s_lshl_b32 s43, s43, 21
    s_add_u32 s75, s43, s42
    s_add_u32 s79, s43, s3
    buffer_load_dword v33, v35, s[24:27], s7 offen sc1
    v_cmp_ne_u32 vcc, 0, v26
    s_nop 0
    s_cmp_eq_u32 vcc_lo, -1
    s_cbranch_scc0 L_keys_wait
L_keys_ok:
    v_and_b32 v26, 0x7ff, v26
    s_lshl_b32 s61, s68, 6
    s_sub_u32 s61, 2047, s61
    v_readlane_b32 s90, v26, 0
    v_readlane_b32 s91, v26, 1
    v_readlane_b32 s92, v26, 2
    v_readlane_b32 s93, v26, 3
    v_readlane_b32 s94, v26, 4
    v_readlane_b32 s95, v26, 5
    v_readlane_b32 s96, v26, 6
    v_readlane_b32 s97, v26, 7
    s_lshl_b32 s58, s68, 16
    s_lshl_b32 s62, s30, 7
    s_add_u32 s58, s58, s62
    s_add_u32 s62, s62, 2113536
    s_xor_b32 s70, s69, 32768
    v_lshrrev_b32 v58, 3, v0
    v_and_b32 v59, 7, v0
    v_xor_b32 v62, s63, v58
    v_xor_b32 v63, 32, v62
    v_lshlrev_b32 v56, 10, v62
    v_lshl_add_u32 v56, v59, 4, v56
    v_xor_b32 v57, 32768, v56
    v_mov_b32 v31, 1073741824
    v_mov_b32 v32, 1073741824
    v_sub_u32 v62, s61, v62
    v_sub_u32 v63, s61, v63
    v_lshlrev_b32 v5, 4, v59
    v_cmp_eq_u32 s[98:99], s90, v62
    v_cmp_eq_u32 s[42:43], s90, v63
    v_add_u32 v6, 0, v5
    v_cndmask_b32 v31, v31, v6, s[98:99]
    v_cndmask_b32 v32, v32, v6, s[42:43]
    v_cmp_eq_u32 s[98:99], s91, v62
    v_cmp_eq_u32 s[42:43], s91, v63
    v_add_u32 v6, 1024, v5
    v_cndmask_b32 v31, v31, v6, s[98:99]
    v_cndmask_b32 v32, v32, v6, s[42:43]
    v_cmp_eq_u32 s[98:99], s92, v62
    v_cmp_eq_u32 s[42:43], s92, v63
    v_add_u32 v6, 2048, v5
    v_cndmask_b32 v31, v31, v6, s[98:99]
    v_cndmask_b32 v32, v32, v6, s[42:43]
    v_cmp_eq_u32 s[98:99], s93, v62
    v_cmp_eq_u32 s[42:43], s93, v63
    v_add_u32 v6, 3072, v5
    v_cndmask_b32 v31, v31, v6, s[98:99]
    v_cndmask_b32 v32, v32, v6, s[42:43]
    v_cmp_eq_u32 s[98:99], s94, v62
    v_cmp_eq_u32 s[42:43], s94, v63
    v_add_u32 v6, 4096, v5
    v_cndmask_b32 v31, v31, v6, s[98:99]
    v_cndmask_b32 v32, v32, v6, s[42:43]
    v_cmp_eq_u32 s[98:99], s95, v62
    v_cmp_eq_u32 s[42:43], s95, v63
    v_add_u32 v6, 5120, v5
    v_cndmask_b32 v31, v31, v6, s[98:99]
    v_cndmask_b32 v32, v32, v6, s[42:43]
    v_cmp_eq_u32 s[98:99], s96, v62
    v_cmp_eq_u32 s[42:43], s96, v63
    v_add_u32 v6, 6144, v5
    v_cndmask_b32 v31, v31, v6, s[98:99]
    v_cndmask_b32 v32, v32, v6, s[42:43]
    v_cmp_eq_u32 s[98:99], s97, v62
    v_cmp_eq_u32 s[42:43], s97, v63
    v_add_u32 v6, 7168, v5
    v_cndmask_b32 v31, v31, v6, s[98:99]
    v_cndmask_b32 v32, v32, v6, s[42:43]
    s_mov_b32 s5, 0
    v_mov_b32 v6, 1
L_late1:
    s_waitcnt vmcnt(1)
    s_barrier
    buffer_store_dword v6, v27, s[24:27], s59 offen sc1
    buffer_load_dwordx4 v[40:43], v56, s[24:27], s58 offen sc1
    buffer_load_dwordx4 v[44:47], v57, s[24:27], s58 offen sc1
    buffer_load_dwordx4 v[36:39], v31, s[24:27], s62 offen sc1
    buffer_load_dwordx4 v[60:63], v32, s[24:27], s62 offen sc1
    buffer_load_dwordx4 v[16:19], v56, s[8:11], s58 offen
    buffer_load_dwordx4 v[20:23], v57, s[8:11], s58 offen
    s_waitcnt vmcnt(7)
    s_mov_b32 s57, 0
L_flag_chk:
    v_cmp_eq_u32 vcc, 1, v33
    s_nop 0
    s_or_b32 s5, s5, vcc_lo
    s_and_b32 s3, s5, 1
    s_cmp_eq_u32 s3, 1
    s_cbranch_scc1 L_flag_ok
    s_add_u32 s57, s57, 1
    s_cmp_gt_u32 s57, 0x40000
    s_cbranch_scc1 L_flag_ok
    s_sleep 1
    buffer_load_dword v33, v35, s[24:27], s7 offen sc1
    s_waitcnt vmcnt(0)
    s_branch L_flag_chk
L_flag_ok:
    buffer_load_dwordx4 v[128:131], v52, s[24:27], s72 offen sc1
    buffer_load_dwordx4 v[132:135], v53, s[24:27], s72 offen sc1
    buffer_load_dwordx4 v[136:139], v54, s[24:27], s72 offen sc1
    buffer_load_dwordx4 v[140:143], v55, s[24:27], s72 offen sc1
    s_xor_b32 s72, s72, 65536
    buffer_load_dwordx4 v[144:147], v52, s[24:27], s72 offen sc1
    buffer_load_dwordx4 v[148:151], v53, s[24:27], s72 offen sc1
    buffer_load_dwordx4 v[152:155], v54, s[24:27], s72 offen sc1
    buffer_load_dwordx4 v[156:159], v55, s[24:27], s72 offen sc1
    s_xor_b32 s72, s72, 196608
    buffer_load_dwordx4 v[160:163], v52, s[24:27], s72 offen sc1
    buffer_load_dwordx4 v[164:167], v53, s[24:27], s72 offen sc1
    buffer_load_dwordx4 v[168:171], v54, s[24:27], s72 offen sc1
    buffer_load_dwordx4 v[172:175], v55, s[24:27], s72 offen sc1
    s_xor_b32 s72, s72, 65536
L_G:
    s_waitcnt vmcnt(8) lgkmcnt(0)
    v_mfma_f32_16x16x32_bf16 v[64:67], a[144:147], v[128:131], 0
    buffer_load_dwordx4 v[176:179], v52, s[24:27], s72 offen sc1
    v_mfma_f32_16x16x32_bf16 v[64:67], a[160:163], v[132:135], v[64:67]
    v_and_b32 v5, 7, v3
    v_xor_b32 v5, v5, v4
    v_mfma_f32_16x16x32_bf16 v[64:67], a[176:179], v[136:139], v[64:67]
    v_lshlrev_b32 v5, 4, v5
    v_lshl_add_u32 v5, v3, 8, v5
    v_mfma_f32_16x16x32_bf16 v[64:67], a[192:195], v[140:143], v[64:67]
    v_lshl_add_u32 v48, v2, 12, v5
    v_xor_b32 v49, 64, v48
    v_mfma_f32_16x16x32_bf16 v[68:71], a[196:199], v[140:143], 0
L_pad10:
    s_cbranch_execz L_pad14
    buffer_load_dwordx4 v[180:183], v53, s[24:27], s72 offen sc1
    v_mfma_f32_16x16x32_bf16 v[68:71], a[180:183], v[136:139], v[68:71]
    v_lshlrev_b32 v5, 1, v59
    v_and_b32 v6, 7, v58
    v_mfma_f32_16x16x32_bf16 v[68:71], a[164:167], v[132:135], v[68:71]
    v_xor_b32 v5, v5, v6
    v_lshlrev_b32 v5, 4, v5
    v_mfma_f32_16x16x32_bf16 v[68:71], a[148:151], v[128:131], v[68:71]
    v_and_b32 v6, 15, v58
    v_lshl_add_u32 v5, v6, 8, v5
    v_mfma_f32_16x16x32_bf16 v[72:75], a[152:155], v[128:131], 0
    buffer_load_dwordx4 v[184:187], v54, s[24:27], s72 offen sc1
    v_mfma_f32_16x16x32_bf16 v[72:75], a[168:171], v[132:135], v[72:75]
    v_lshrrev_b32 v6, 4, v58
    v_lshl_add_u32 v50, v6, 14, v5
    v_mfma_f32_16x16x32_bf16 v[72:75], a[184:187], v[136:139], v[72:75]
    v_xor_b32 v51, 16, v50
    v_lshlrev_b32 v30, 4, v1
    v_mfma_f32_16x16x32_bf16 v[72:75], a[200:203], v[140:143], v[72:75]
    v_mfma_f32_16x16x32_bf16 v[76:79], a[204:207], v[140:143], 0
    buffer_load_dwordx4 v[188:191], v55, s[24:27], s72 offen sc1
    v_mfma_f32_16x16x32_bf16 v[76:79], a[188:191], v[136:139], v[76:79]
    v_mfma_f32_16x16x32_bf16 v[76:79], a[172:175], v[132:135], v[76:79]
    s_xor_b32 s72, s72, 196608
    v_mfma_f32_16x16x32_bf16 v[76:79], a[156:159], v[128:131], v[76:79]
    s_waitcnt vmcnt(8)
    s_bitcmp1_b32 s5, 1
    s_cbranch_scc0 L_rf1
L_rf1_ok:
    v_mfma_f32_16x16x32_bf16 v[80:83], a[144:147], v[144:147], 0
    buffer_load_dwordx4 v[128:131], v52, s[24:27], s76 offen sc1
    v_mfma_f32_16x16x32_bf16 v[80:83], a[160:163], v[148:151], v[80:83]
    v_mfma_f32_16x16x32_bf16 v[80:83], a[176:179], v[152:155], v[80:83]
    v_mfma_f32_16x16x32_bf16 v[80:83], a[192:195], v[156:159], v[80:83]
    v_mfma_f32_16x16x32_bf16 v[84:87], a[196:199], v[156:159], 0
    buffer_load_dwordx4 v[132:135], v53, s[24:27], s76 offen sc1
    v_mfma_f32_16x16x32_bf16 v[84:87], a[180:183], v[152:155], v[84:87]
    v_mfma_f32_16x16x32_bf16 v[84:87], a[164:167], v[148:151], v[84:87]
    v_mfma_f32_16x16x32_bf16 v[84:87], a[148:151], v[144:147], v[84:87]
    v_mfma_f32_16x16x32_bf16 v[88:91], a[152:155], v[144:147], 0
    buffer_load_dwordx4 v[136:139], v54, s[24:27], s76 offen sc1
    v_mfma_f32_16x16x32_bf16 v[88:91], a[168:171], v[148:151], v[88:91]
    v_mfma_f32_16x16x32_bf16 v[88:91], a[184:187], v[152:155], v[88:91]
    v_mfma_f32_16x16x32_bf16 v[88:91], a[200:203], v[156:159], v[88:91]
    v_mfma_f32_16x16x32_bf16 v[92:95], a[204:207], v[156:159], 0
    buffer_load_dwordx4 v[140:143], v55, s[24:27], s76 offen sc1
    v_mfma_f32_16x16x32_bf16 v[92:95], a[188:191], v[152:155], v[92:95]
    v_mfma_f32_16x16x32_bf16 v[92:95], a[172:175], v[148:151], v[92:95]
    s_xor_b32 s76, s76, 65536
    v_mfma_f32_16x16x32_bf16 v[92:95], a[156:159], v[144:147], v[92:95]
    s_waitcnt vmcnt(8)
    v_mfma_f32_16x16x32_bf16 v[96:99], a[144:147], v[160:163], 0
    buffer_load_dwordx4 v[144:147], v52, s[24:27], s76 offen sc1
    v_mfma_f32_16x16x32_bf16 v[96:99], a[160:163], v[164:167], v[96:99]
    v_mfma_f32_16x16x32_bf16 v[96:99], a[176:179], v[168:171], v[96:99]
    v_mfma_f32_16x16x32_bf16 v[96:99], a[192:195], v[172:175], v[96:99]
    v_mfma_f32_16x16x32_bf16 v[100:103], a[196:199], v[172:175], 0
    buffer_load_dwordx4 v[148:151], v53, s[24:27], s76 offen sc1
    v_mfma_f32_16x16x32_bf16 v[100:103], a[180:183], v[168:171], v[100:103]
    v_mfma_f32_16x16x32_bf16 v[100:103], a[164:167], v[164:167], v[100:103]
    v_mfma_f32_16x16x32_bf16 v[100:103], a[148:151], v[160:163], v[100:103]
    v_mfma_f32_16x16x32_bf16 v[104:107], a[152:155], v[160:163], 0
    buffer_load_dwordx4 v[152:155], v54, s[24:27], s76 offen sc1
    v_mfma_f32_16x16x32_bf16 v[104:107], a[168:171], v[164:167], v[104:107]
    v_mfma_f32_16x16x32_bf16 v[104:107], a[184:187], v[168:171], v[104:107]
    v_mfma_f32_16x16x32_bf16 v[104:107], a[200:203], v[172:175], v[104:107]
    v_mfma_f32_16x16x32_bf16 v[108:111], a[204:207], v[172:175], 0
    buffer_load_dwordx4 v[156:159], v55, s[24:27], s76 offen sc1
    v_mfma_f32_16x16x32_bf16 v[108:111], a[188:191], v[168:171], v[108:111]
    v_mfma_f32_16x16x32_bf16 v[108:111], a[172:175], v[164:167], v[108:111]
    s_xor_b32 s76, s76, 196608
    v_mfma_f32_16x16x32_bf16 v[108:111], a[156:159], v[160:163], v[108:111]
    s_waitcnt vmcnt(8)
    v_mfma_f32_16x16x32_bf16 v[112:115], a[144:147], v[176:179], 0
    buffer_load_dwordx4 v[160:163], v52, s[24:27], s76 offen sc1
    v_mfma_f32_16x16x32_bf16 v[112:115], a[160:163], v[180:183], v[112:115]
    v_max3_u32 v24, v36, v37, v38
    v_max3_u32 v25, v39, v60, v61
    v_mfma_f32_16x16x32_bf16 v[112:115], a[176:179], v[184:187], v[112:115]
    v_max3_u32 v24, v24, v62, v63
    v_mfma_f32_16x16x32_bf16 v[112:115], a[192:195], v[188:191], v[112:115]
    v_max_u32 v24, v24, v25
    v_mfma_f32_16x16x32_bf16 v[116:119], a[196:199], v[188:191], 0
    buffer_load_dwordx4 v[164:167], v53, s[24:27], s76 offen sc1
    v_mfma_f32_16x16x32_bf16 v[116:119], a[180:183], v[184:187], v[116:119]
    v_cmp_ne_u32 vcc, -1, v24
    v_mfma_f32_16x16x32_bf16 v[116:119], a[164:167], v[180:183], v[116:119]
    s_cmp_eq_u64 vcc, -1
    s_cbranch_scc0 L_up_wait
L_up_ok:
    v_mfma_f32_16x16x32_bf16 v[116:119], a[148:151], v[176:179], v[116:119]
    v_lshlrev_b32 v24, 16, v40
    v_and_b32 v25, 0xffff0000, v40
    v_mfma_f32_16x16x32_bf16 v[120:123], a[152:155], v[176:179], 0
    buffer_load_dwordx4 v[168:171], v54, s[24:27], s76 offen sc1
    v_mfma_f32_16x16x32_bf16 v[120:123], a[168:171], v[180:183], v[120:123]
    v_lshlrev_b32 v26, 16, v36
    v_and_b32 v27, 0xffff0000, v36
    v_mfma_f32_16x16x32_bf16 v[120:123], a[184:187], v[184:187], v[120:123]
    v_add_f32 v24, v24, v26
    v_add_f32 v25, v25, v27
    v_mfma_f32_16x16x32_bf16 v[120:123], a[200:203], v[188:191], v[120:123]
    v_cvt_pk_bf16_f32 v40, v24, v25
    v_mfma_f32_16x16x32_bf16 v[124:127], a[204:207], v[188:191], 0
    buffer_load_dwordx4 v[172:175], v55, s[24:27], s76 offen sc1
    v_mfma_f32_16x16x32_bf16 v[124:127], a[188:191], v[184:187], v[124:127]
    v_lshlrev_b32 v24, 16, v40
    v_and_b32 v25, 0xffff0000, v40
    v_mfma_f32_16x16x32_bf16 v[124:127], a[172:175], v[180:183], v[124:127]
    s_xor_b32 s76, s76, 65536
    v_mul_f32 v26, 0xbfb8aa3b, v24
    v_mul_f32 v27, 0xbfb8aa3b, v25
    v_mfma_f32_16x16x32_bf16 v[124:127], a[156:159], v[176:179], v[124:127]
    v_exp_f32 v26, v26
    s_waitcnt vmcnt(8)
    v_mfma_f32_16x16x32_bf16 v[192:195], a[144:147], v[128:131], 0
    buffer_load_dwordx4 v[176:179], v52, s[24:27], s76 offen sc1
    v_mfma_f32_16x16x32_bf16 v[192:195], a[160:163], v[132:135], v[192:195]
    v_exp_f32 v27, v27
    v_mfma_f32_16x16x32_bf16 v[192:195], a[176:179], v[136:139], v[192:195]
    v_add_f32 v26, 1.0, v26
    v_add_f32 v27, 1.0, v27
    v_mfma_f32_16x16x32_bf16 v[192:195], a[192:195], v[140:143], v[192:195]
    v_rcp_f32 v26, v26
    v_mfma_f32_16x16x32_bf16 v[196:199], a[196:199], v[140:143], 0
    buffer_load_dwordx4 v[180:183], v53, s[24:27], s76 offen sc1
    v_mfma_f32_16x16x32_bf16 v[196:199], a[180:183], v[136:139], v[196:199]
    v_rcp_f32 v27, v27
    v_mfma_f32_16x16x32_bf16 v[196:199], a[164:167], v[132:135], v[196:199]
    v_mul_f32 v24, v24, v26
    v_mul_f32 v25, v25, v27
    v_mfma_f32_16x16x32_bf16 v[196:199], a[148:151], v[128:131], v[196:199]
    v_cvt_pk_bf16_f32 v40, v24, v25
    v_mfma_f32_16x16x32_bf16 v[200:203], a[152:155], v[128:131], 0
    buffer_load_dwordx4 v[184:187], v54, s[24:27], s76 offen sc1
    v_mfma_f32_16x16x32_bf16 v[200:203], a[168:171], v[132:135], v[200:203]
    v_lshlrev_b32 v24, 16, v41
    v_and_b32 v25, 0xffff0000, v41
    v_mfma_f32_16x16x32_bf16 v[200:203], a[184:187], v[136:139], v[200:203]
    v_lshlrev_b32 v26, 16, v37
    v_and_b32 v27, 0xffff0000, v37
    v_mfma_f32_16x16x32_bf16 v[200:203], a[200:203], v[140:143], v[200:203]
    v_add_f32 v24, v24, v26
    v_add_f32 v25, v25, v27
    v_mfma_f32_16x16x32_bf16 v[204:207], a[204:207], v[140:143], 0
    buffer_load_dwordx4 v[188:191], v55, s[24:27], s76 offen sc1
    v_mfma_f32_16x16x32_bf16 v[204:207], a[188:191], v[136:139], v[204:207]
    v_cvt_pk_bf16_f32 v41, v24, v25
    v_mfma_f32_16x16x32_bf16 v[204:207], a[172:175], v[132:135], v[204:207]
    s_xor_b32 s76, s76, 196608
    v_lshlrev_b32 v24, 16, v41
    v_and_b32 v25, 0xffff0000, v41
    v_mfma_f32_16x16x32_bf16 v[204:207], a[156:159], v[128:131], v[204:207]
    v_mul_f32 v26, 0xbfb8aa3b, v24
    v_mul_f32 v27, 0xbfb8aa3b, v25
    s_waitcnt vmcnt(8)
    v_cmp_eq_u32 vcc, 1, v33
    s_nop 0
    s_or_b32 s5, s5, vcc_lo
    s_bitcmp1_b32 s5, 1
    s_cbranch_scc0 L_hw1
L_hw1_ok:
    s_bitcmp1_b32 s5, 2
    s_cbranch_scc0 L_rf5
L_rf5_ok:
    v_mfma_f32_16x16x32_bf16 v[208:211], a[144:147], v[144:147], 0
    buffer_load_dwordx4 v[128:131], v52, s[24:27], s73 offen sc1
    v_mfma_f32_16x16x32_bf16 v[208:211], a[160:163], v[148:151], v[208:211]
    v_exp_f32 v26, v26
    v_mfma_f32_16x16x32_bf16 v[208:211], a[176:179], v[152:155], v[208:211]
    v_exp_f32 v27, v27
    v_mfma_f32_16x16x32_bf16 v[208:211], a[192:195], v[156:159], v[208:211]
    v_add_f32 v26, 1.0, v26
    v_add_f32 v27, 1.0, v27
    v_mfma_f32_16x16x32_bf16 v[212:215], a[196:199], v[156:159], 0
    buffer_load_dwordx4 v[132:135], v53, s[24:27], s73 offen sc1
    v_mfma_f32_16x16x32_bf16 v[212:215], a[180:183], v[152:155], v[212:215]
    v_rcp_f32 v26, v26
    v_mfma_f32_16x16x32_bf16 v[212:215], a[164:167], v[148:151], v[212:215]
    v_rcp_f32 v27, v27
    v_mfma_f32_16x16x32_bf16 v[212:215], a[148:151], v[144:147], v[212:215]
    v_mul_f32 v24, v24, v26
    v_mul_f32 v25, v25, v27
    v_mfma_f32_16x16x32_bf16 v[216:219], a[152:155], v[144:147], 0
    buffer_load_dwordx4 v[136:139], v54, s[24:27], s73 offen sc1
    v_mfma_f32_16x16x32_bf16 v[216:219], a[168:171], v[148:151], v[216:219]
    v_cvt_pk_bf16_f32 v41, v24, v25
    v_mfma_f32_16x16x32_bf16 v[216:219], a[184:187], v[152:155], v[216:219]
    v_lshlrev_b32 v24, 16, v42
    v_and_b32 v25, 0xffff0000, v42
    v_mfma_f32_16x16x32_bf16 v[216:219], a[200:203], v[156:159], v[216:219]
    v_lshlrev_b32 v26, 16, v38
    v_and_b32 v27, 0xffff0000, v38
    v_mfma_f32_16x16x32_bf16 v[220:223], a[204:207], v[156:159], 0
    buffer_load_dwordx4 v[140:143], v55, s[24:27], s73 offen sc1
    v_mfma_f32_16x16x32_bf16 v[220:223], a[188:191], v[152:155], v[220:223]
    v_add_f32 v24, v24, v26
    v_add_f32 v25, v25, v27
    v_mfma_f32_16x16x32_bf16 v[220:223], a[172:175], v[148:151], v[220:223]
    s_xor_b32 s73, s73, 65536
    v_cvt_pk_bf16_f32 v42, v24, v25
    v_mfma_f32_16x16x32_bf16 v[220:223], a[156:159], v[144:147], v[220:223]
    v_lshlrev_b32 v24, 16, v42
    v_and_b32 v25, 0xffff0000, v42
    s_waitcnt vmcnt(8)
    v_mfma_f32_16x16x32_bf16 v[224:227], a[144:147], v[160:163], 0
    buffer_load_dwordx4 v[144:147], v52, s[24:27], s73 offen sc1
    v_mfma_f32_16x16x32_bf16 v[224:227], a[160:163], v[164:167], v[224:227]
    v_mul_f32 v26, 0xbfb8aa3b, v24
    v_mul_f32 v27, 0xbfb8aa3b, v25
    v_mfma_f32_16x16x32_bf16 v[224:227], a[176:179], v[168:171], v[224:227]
    v_exp_f32 v26, v26
    v_mfma_f32_16x16x32_bf16 v[224:227], a[192:195], v[172:175], v[224:227]
    v_exp_f32 v27, v27
    v_mfma_f32_16x16x32_bf16 v[228:231], a[196:199], v[172:175], 0
    buffer_load_dwordx4 v[148:151], v53, s[24:27], s73 offen sc1
    v_mfma_f32_16x16x32_bf16 v[228:231], a[180:183], v[168:171], v[228:231]
    v_add_f32 v26, 1.0, v26
    v_add_f32 v27, 1.0, v27
    v_mfma_f32_16x16x32_bf16 v[228:231], a[164:167], v[164:167], v[228:231]
    v_rcp_f32 v26, v26
    v_mfma_f32_16x16x32_bf16 v[228:231], a[148:151], v[160:163], v[228:231]
    v_rcp_f32 v27, v27
    v_mfma_f32_16x16x32_bf16 v[232:235], a[152:155], v[160:163], 0
    buffer_load_dwordx4 v[152:155], v54, s[24:27], s73 offen sc1
    v_mfma_f32_16x16x32_bf16 v[232:235], a[168:171], v[164:167], v[232:235]
    v_mul_f32 v24, v24, v26
    v_mul_f32 v25, v25, v27
    v_mfma_f32_16x16x32_bf16 v[232:235], a[184:187], v[168:171], v[232:235]
    v_cvt_pk_bf16_f32 v42, v24, v25
    v_mfma_f32_16x16x32_bf16 v[232:235], a[200:203], v[172:175], v[232:235]
    v_lshlrev_b32 v24, 16, v43
    v_and_b32 v25, 0xffff0000, v43
    v_mfma_f32_16x16x32_bf16 v[236:239], a[204:207], v[172:175], 0
    buffer_load_dwordx4 v[156:159], v55, s[24:27], s73 offen sc1
    v_mfma_f32_16x16x32_bf16 v[236:239], a[188:191], v[168:171], v[236:239]
    v_lshlrev_b32 v26, 16, v39
    v_and_b32 v27, 0xffff0000, v39
    v_mfma_f32_16x16x32_bf16 v[236:239], a[172:175], v[164:167], v[236:239]
    s_xor_b32 s73, s73, 196608
    v_add_f32 v24, v24, v26
    v_add_f32 v25, v25, v27
    v_mfma_f32_16x16x32_bf16 v[236:239], a[156:159], v[160:163], v[236:239]
    v_cvt_pk_bf16_f32 v43, v24, v25
    s_waitcnt vmcnt(8)
    v_mfma_f32_16x16x32_bf16 v[240:243], a[144:147], v[176:179], 0
    buffer_load_dwordx4 v[160:163], v52, s[24:27], s73 offen sc1
    v_mfma_f32_16x16x32_bf16 v[240:243], a[160:163], v[180:183], v[240:243]
    v_lshlrev_b32 v24, 16, v43
    v_and_b32 v25, 0xffff0000, v43
    v_mfma_f32_16x16x32_bf16 v[240:243], a[176:179], v[184:187], v[240:243]
    v_mul_f32 v26, 0xbfb8aa3b, v24
    v_mul_f32 v27, 0xbfb8aa3b, v25
    v_mfma_f32_16x16x32_bf16 v[240:243], a[192:195], v[188:191], v[240:243]
    v_exp_f32 v26, v26
    v_mfma_f32_16x16x32_bf16 v[244:247], a[196:199], v[188:191], 0
    buffer_load_dwordx4 v[164:167], v53, s[24:27], s73 offen sc1
    v_mfma_f32_16x16x32_bf16 v[244:247], a[180:183], v[184:187], v[244:247]
    v_exp_f32 v27, v27
    v_mfma_f32_16x16x32_bf16 v[244:247], a[164:167], v[180:183], v[244:247]
    v_add_f32 v26, 1.0, v26
    v_add_f32 v27, 1.0, v27
    v_mfma_f32_16x16x32_bf16 v[244:247], a[148:151], v[176:179], v[244:247]
    v_rcp_f32 v26, v26
    v_mfma_f32_16x16x32_bf16 v[248:251], a[152:155], v[176:179], 0
    buffer_load_dwordx4 v[168:171], v54, s[24:27], s73 offen sc1
    v_mfma_f32_16x16x32_bf16 v[248:251], a[168:171], v[180:183], v[248:251]
    v_rcp_f32 v27, v27
    v_mfma_f32_16x16x32_bf16 v[248:251], a[184:187], v[184:187], v[248:251]
    v_mul_f32 v24, v24, v26
    v_mul_f32 v25, v25, v27
    v_mfma_f32_16x16x32_bf16 v[248:251], a[200:203], v[188:191], v[248:251]
    v_cvt_pk_bf16_f32 v43, v24, v25
    v_mfma_f32_16x16x32_bf16 v[252:255], a[204:207], v[188:191], 0
    buffer_load_dwordx4 v[172:175], v55, s[24:27], s73 offen sc1
    v_mfma_f32_16x16x32_bf16 v[252:255], a[188:191], v[184:187], v[252:255]
    v_lshlrev_b32 v24, 16, v44
    v_and_b32 v25, 0xffff0000, v44
    v_mfma_f32_16x16x32_bf16 v[252:255], a[172:175], v[180:183], v[252:255]
    s_xor_b32 s73, s73, 65536
    v_lshlrev_b32 v26, 16, v60
    v_and_b32 v27, 0xffff0000, v60
    v_mfma_f32_16x16x32_bf16 v[252:255], a[156:159], v[176:179], v[252:255]
    v_add_f32 v24, v24, v26
    v_add_f32 v25, v25, v27
    s_waitcnt vmcnt(8)
    v_mfma_f32_16x16x32_bf16 v[64:67], a[208:211], v[128:131], v[64:67]
    buffer_load_dwordx4 v[176:179], v52, s[24:27], s73 offen sc1
    v_mfma_f32_16x16x32_bf16 v[64:67], a[64:67], v[132:135], v[64:67]
    v_cvt_pk_bf16_f32 v44, v24, v25
    v_mfma_f32_16x16x32_bf16 v[64:67], a[80:83], v[136:139], v[64:67]
    v_lshlrev_b32 v24, 16, v44
    v_and_b32 v25, 0xffff0000, v44
    v_mfma_f32_16x16x32_bf16 v[64:67], a[0:3], v[140:143], v[64:67]
    v_mul_f32 v26, 0xbfb8aa3b, v24
    v_mul_f32 v27, 0xbfb8aa3b, v25
    v_mfma_f32_16x16x32_bf16 v[68:71], a[4:7], v[140:143], v[68:71]
    buffer_load_dwordx4 v[180:183], v53, s[24:27], s73 offen sc1
    v_mfma_f32_16x16x32_bf16 v[68:71], a[84:87], v[136:139], v[68:71]
    v_exp_f32 v26, v26
    v_mfma_f32_16x16x32_bf16 v[68:71], a[68:71], v[132:135], v[68:71]
    v_exp_f32 v27, v27
    v_mfma_f32_16x16x32_bf16 v[68:71], a[212:215], v[128:131], v[68:71]
    v_add_f32 v26, 1.0, v26
    v_add_f32 v27, 1.0, v27
    v_mfma_f32_16x16x32_bf16 v[72:75], a[216:219], v[128:131], v[72:75]
    buffer_load_dwordx4 v[184:187], v54, s[24:27], s73 offen sc1
    v_mfma_f32_16x16x32_bf16 v[72:75], a[72:75], v[132:135], v[72:75]
    v_rcp_f32 v26, v26
    v_mfma_f32_16x16x32_bf16 v[72:75], a[88:91], v[136:139], v[72:75]
    v_rcp_f32 v27, v27
    v_mfma_f32_16x16x32_bf16 v[72:75], a[8:11], v[140:143], v[72:75]
    v_mul_f32 v24, v24, v26
    v_mul_f32 v25, v25, v27
    v_mfma_f32_16x16x32_bf16 v[76:79], a[12:15], v[140:143], v[76:79]
    buffer_load_dwordx4 v[188:191], v55, s[24:27], s73 offen sc1
    v_mfma_f32_16x16x32_bf16 v[76:79], a[92:95], v[136:139], v[76:79]
    v_cvt_pk_bf16_f32 v44, v24, v25
    v_mfma_f32_16x16x32_bf16 v[76:79], a[76:79], v[132:135], v[76:79]
    s_xor_b32 s73, s73, 196608
    v_lshlrev_b32 v24, 16, v45
    v_and_b32 v25, 0xffff0000, v45
    v_mfma_f32_16x16x32_bf16 v[76:79], a[220:223], v[128:131], v[76:79]
    v_lshlrev_b32 v26, 16, v61
    v_and_b32 v27, 0xffff0000, v61
    s_waitcnt vmcnt(8)
    v_cmp_eq_u32 vcc, 1, v33
    s_nop 0
    s_or_b32 s5, s5, vcc_lo
    s_bitcmp1_b32 s5, 2
    s_cbranch_scc0 L_hw2
L_hw2_ok:
    s_bitcmp1_b32 s5, 3
    s_cbranch_scc0 L_rf9
L_rf9_ok:
    v_mfma_f32_16x16x32_bf16 v[80:83], a[208:211], v[144:147], v[80:83]
    buffer_load_dwordx4 v[128:131], v52, s[24:27], s74 offen sc1
    v_mfma_f32_16x16x32_bf16 v[80:83], a[64:67], v[148:151], v[80:83]
    v_add_f32 v24, v24, v26
    v_add_f32 v25, v25, v27
    v_mfma_f32_16x16x32_bf16 v[80:83], a[80:83], v[152:155], v[80:83]
    v_cvt_pk_bf16_f32 v45, v24, v25
    v_mfma_f32_16x16x32_bf16 v[80:83], a[0:3], v[156:159], v[80:83]
    v_lshlrev_b32 v24, 16, v45
    v_and_b32 v25, 0xffff0000, v45
    v_mfma_f32_16x16x32_bf16 v[84:87], a[4:7], v[156:159], v[84:87]
    buffer_load_dwordx4 v[132:135], v53, s[24:27], s74 offen sc1
    v_mfma_f32_16x16x32_bf16 v[84:87], a[84:87], v[152:155], v[84:87]
    v_mul_f32 v26, 0xbfb8aa3b, v24
    v_mul_f32 v27, 0xbfb8aa3b, v25
    v_mfma_f32_16x16x32_bf16 v[84:87], a[68:71], v[148:151], v[84:87]
    v_exp_f32 v26, v26
    v_mfma_f32_16x16x32_bf16 v[84:87], a[212:215], v[144:147], v[84:87]
    v_exp_f32 v27, v27
    v_mfma_f32_16x16x32_bf16 v[88:91], a[216:219], v[144:147], v[88:91]
    buffer_load_dwordx4 v[136:139], v54, s[24:27], s74 offen sc1
    v_mfma_f32_16x16x32_bf16 v[88:91], a[72:75], v[148:151], v[88:91]
    v_add_f32 v26, 1.0, v26
    v_add_f32 v27, 1.0, v27
    v_mfma_f32_16x16x32_bf16 v[88:91], a[88:91], v[152:155], v[88:91]
    v_rcp_f32 v26, v26
    v_mfma_f32_16x16x32_bf16 v[88:91], a[8:11], v[156:159], v[88:91]
    v_rcp_f32 v27, v27
    v_mfma_f32_16x16x32_bf16 v[92:95], a[12:15], v[156:159], v[92:95]
    buffer_load_dwordx4 v[140:143], v55, s[24:27], s74 offen sc1
    v_mfma_f32_16x16x32_bf16 v[92:95], a[92:95], v[152:155], v[92:95]
    v_mul_f32 v24, v24, v26
    v_mul_f32 v25, v25, v27
    v_mfma_f32_16x16x32_bf16 v[92:95], a[76:79], v[148:151], v[92:95]
    s_xor_b32 s74, s74, 65536
    v_cvt_pk_bf16_f32 v45, v24, v25
    v_mfma_f32_16x16x32_bf16 v[92:95], a[220:223], v[144:147], v[92:95]
    v_lshlrev_b32 v24, 16, v46
    v_and_b32 v25, 0xffff0000, v46
    s_waitcnt vmcnt(8)
    v_mfma_f32_16x16x32_bf16 v[96:99], a[208:211], v[160:163], v[96:99]
    buffer_load_dwordx4 v[144:147], v52, s[24:27], s74 offen sc1
    v_mfma_f32_16x16x32_bf16 v[96:99], a[64:67], v[164:167], v[96:99]
    v_lshlrev_b32 v26, 16, v62
    v_and_b32 v27, 0xffff0000, v62
    v_mfma_f32_16x16x32_bf16 v[96:99], a[80:83], v[168:171], v[96:99]
    v_add_f32 v24, v24, v26
    v_add_f32 v25, v25, v27
    v_mfma_f32_16x16x32_bf16 v[96:99], a[0:3], v[172:175], v[96:99]
    v_cvt_pk_bf16_f32 v46, v24, v25
    v_mfma_f32_16x16x32_bf16 v[100:103], a[4:7], v[172:175], v[100:103]
    buffer_load_dwordx4 v[148:151], v53, s[24:27], s74 offen sc1
    v_mfma_f32_16x16x32_bf16 v[100:103], a[84:87], v[168:171], v[100:103]
    v_lshlrev_b32 v24, 16, v46
    v_and_b32 v25, 0xffff0000, v46
    v_mfma_f32_16x16x32_bf16 v[100:103], a[68:71], v[164:167], v[100:103]
    v_mul_f32 v26, 0xbfb8aa3b, v24
    v_mul_f32 v27, 0xbfb8aa3b, v25
    v_mfma_f32_16x16x32_bf16 v[100:103], a[212:215], v[160:163], v[100:103]
    v_exp_f32 v26, v26
    v_mfma_f32_16x16x32_bf16 v[104:107], a[216:219], v[160:163], v[104:107]
    buffer_load_dwordx4 v[152:155], v54, s[24:27], s74 offen sc1
    v_mfma_f32_16x16x32_bf16 v[104:107], a[72:75], v[164:167], v[104:107]
    v_exp_f32 v27, v27
    v_mfma_f32_16x16x32_bf16 v[104:107], a[88:91], v[168:171], v[104:107]
    v_add_f32 v26, 1.0, v26
    v_add_f32 v27, 1.0, v27
    v_mfma_f32_16x16x32_bf16 v[104:107], a[8:11], v[172:175], v[104:107]
    v_rcp_f32 v26, v26
    v_mfma_f32_16x16x32_bf16 v[108:111], a[12:15], v[172:175], v[108:111]
    buffer_load_dwordx4 v[156:159], v55, s[24:27], s74 offen sc1
    v_mfma_f32_16x16x32_bf16 v[108:111], a[92:95], v[168:171], v[108:111]
    v_rcp_f32 v27, v27
    v_mfma_f32_16x16x32_bf16 v[108:111], a[76:79], v[164:167], v[108:111]
    s_xor_b32 s74, s74, 196608
    v_mul_f32 v24, v24, v26
    v_mul_f32 v25, v25, v27
    v_mfma_f32_16x16x32_bf16 v[108:111], a[220:223], v[160:163], v[108:111]
    v_cvt_pk_bf16_f32 v46, v24, v25
    s_waitcnt vmcnt(8)
    v_mfma_f32_16x16x32_bf16 v[112:115], a[208:211], v[176:179], v[112:115]
    buffer_load_dwordx4 v[160:163], v52, s[24:27], s74 offen sc1
    v_mfma_f32_16x16x32_bf16 v[112:115], a[64:67], v[180:183], v[112:115]
    v_lshlrev_b32 v24, 16, v47
    v_and_b32 v25, 0xffff0000, v47
    v_mfma_f32_16x16x32_bf16 v[112:115], a[80:83], v[184:187], v[112:115]
    v_lshlrev_b32 v26, 16, v63
    v_and_b32 v27, 0xffff0000, v63
    v_mfma_f32_16x16x32_bf16 v[112:115], a[0:3], v[188:191], v[112:115]
    v_add_f32 v24, v24, v26
    v_add_f32 v25, v25, v27
    v_mfma_f32_16x16x32_bf16 v[116:119], a[4:7], v[188:191], v[116:119]
    buffer_load_dwordx4 v[164:167], v53, s[24:27], s74 offen sc1
    v_mfma_f32_16x16x32_bf16 v[116:119], a[84:87], v[184:187], v[116:119]
    v_cvt_pk_bf16_f32 v47, v24, v25
    v_mfma_f32_16x16x32_bf16 v[116:119], a[68:71], v[180:183], v[116:119]
    v_lshlrev_b32 v24, 16, v47
    v_and_b32 v25, 0xffff0000, v47
    v_mfma_f32_16x16x32_bf16 v[116:119], a[212:215], v[176:179], v[116:119]
    v_mul_f32 v26, 0xbfb8aa3b, v24
    v_mul_f32 v27, 0xbfb8aa3b, v25
    v_mfma_f32_16x16x32_bf16 v[120:123], a[216:219], v[176:179], v[120:123]
    buffer_load_dwordx4 v[168:171], v54, s[24:27], s74 offen sc1
    v_mfma_f32_16x16x32_bf16 v[120:123], a[72:75], v[180:183], v[120:123]
    v_exp_f32 v26, v26
    v_mfma_f32_16x16x32_bf16 v[120:123], a[88:91], v[184:187], v[120:123]
    v_exp_f32 v27, v27
    v_mfma_f32_16x16x32_bf16 v[120:123], a[8:11], v[188:191], v[120:123]
    v_add_f32 v26, 1.0, v26
    v_add_f32 v27, 1.0, v27
    v_mfma_f32_16x16x32_bf16 v[124:127], a[12:15], v[188:191], v[124:127]
    buffer_load_dwordx4 v[172:175], v55, s[24:27], s74 offen sc1
    v_mfma_f32_16x16x32_bf16 v[124:127], a[92:95], v[184:187], v[124:127]
    v_rcp_f32 v26, v26
    v_mfma_f32_16x16x32_bf16 v[124:127], a[76:79], v[180:183], v[124:127]
    s_xor_b32 s74, s74, 65536
    v_rcp_f32 v27, v27
    v_mfma_f32_16x16x32_bf16 v[124:127], a[220:223], v[176:179], v[124:127]
    v_mul_f32 v24, v24, v26
    v_mul_f32 v25, v25, v27
    s_waitcnt vmcnt(8)
    v_mfma_f32_16x16x32_bf16 v[64:67], a[16:19], v[128:131], v[64:67]
    buffer_load_dwordx4 v[176:179], v52, s[24:27], s74 offen sc1
    v_mfma_f32_16x16x32_bf16 v[64:67], a[32:35], v[132:135], v[64:67]
    v_cvt_pk_bf16_f32 v47, v24, v25
    v_mfma_f32_16x16x32_bf16 v[64:67], a[48:51], v[136:139], v[64:67]
    v_mfma_f32_16x16x32_bf16 v[64:67], a[128:131], v[140:143], v[64:67]
    v_mfma_f32_16x16x32_bf16 v[68:71], a[132:135], v[140:143], v[68:71]
    buffer_load_dwordx4 v[180:183], v53, s[24:27], s74 offen sc1
    v_mfma_f32_16x16x32_bf16 v[68:71], a[52:55], v[136:139], v[68:71]
    v_mfma_f32_16x16x32_bf16 v[68:71], a[36:39], v[132:135], v[68:71]
    v_mfma_f32_16x16x32_bf16 v[68:71], a[20:23], v[128:131], v[68:71]
    v_mfma_f32_16x16x32_bf16 v[72:75], a[24:27], v[128:131], v[72:75]
    buffer_load_dwordx4 v[184:187], v54, s[24:27], s74 offen sc1
    v_mfma_f32_16x16x32_bf16 v[72:75], a[40:43], v[132:135], v[72:75]
    v_mfma_f32_16x16x32_bf16 v[72:75], a[56:59], v[136:139], v[72:75]
    v_mfma_f32_16x16x32_bf16 v[72:75], a[136:139], v[140:143], v[72:75]
    v_mfma_f32_16x16x32_bf16 v[76:79], a[140:143], v[140:143], v[76:79]
    buffer_load_dwordx4 v[188:191], v55, s[24:27], s74 offen sc1
    v_mfma_f32_16x16x32_bf16 v[76:79], a[60:63], v[136:139], v[76:79]
    v_mfma_f32_16x16x32_bf16 v[76:79], a[44:47], v[132:135], v[76:79]
    s_xor_b32 s74, s74, 196608
    v_mfma_f32_16x16x32_bf16 v[76:79], a[28:31], v[128:131], v[76:79]
    s_waitcnt vmcnt(8)
    v_cmp_eq_u32 vcc, 1, v33
    s_nop 0
    s_or_b32 s5, s5, vcc_lo
    s_bitcmp1_b32 s5, 3
    s_cbranch_scc0 L_hw3
L_hw3_ok:
    v_mfma_f32_16x16x32_bf16 v[80:83], a[16:19], v[144:147], v[80:83]
    buffer_load_dwordx4 v[128:131], v52, s[24:27], s75 offen sc1
    v_mfma_f32_16x16x32_bf16 v[80:83], a[32:35], v[148:151], v[80:83]
    v_mfma_f32_16x16x32_bf16 v[80:83], a[48:51], v[152:155], v[80:83]
    v_mfma_f32_16x16x32_bf16 v[80:83], a[128:131], v[156:159], v[80:83]
    v_mfma_f32_16x16x32_bf16 v[84:87], a[132:135], v[156:159], v[84:87]
    buffer_load_dwordx4 v[132:135], v53, s[24:27], s75 offen sc1
    v_mfma_f32_16x16x32_bf16 v[84:87], a[52:55], v[152:155], v[84:87]
    v_mfma_f32_16x16x32_bf16 v[84:87], a[36:39], v[148:151], v[84:87]
    v_mfma_f32_16x16x32_bf16 v[84:87], a[20:23], v[144:147], v[84:87]
    v_mfma_f32_16x16x32_bf16 v[88:91], a[24:27], v[144:147], v[88:91]
    buffer_load_dwordx4 v[136:139], v54, s[24:27], s75 offen sc1
    v_mfma_f32_16x16x32_bf16 v[88:91], a[40:43], v[148:151], v[88:91]
    v_mfma_f32_16x16x32_bf16 v[88:91], a[56:59], v[152:155], v[88:91]
    v_mfma_f32_16x16x32_bf16 v[88:91], a[136:139], v[156:159], v[88:91]
    v_mfma_f32_16x16x32_bf16 v[92:95], a[140:143], v[156:159], v[92:95]
    buffer_load_dwordx4 v[140:143], v55, s[24:27], s75 offen sc1
    v_mfma_f32_16x16x32_bf16 v[92:95], a[60:63], v[152:155], v[92:95]
    v_mfma_f32_16x16x32_bf16 v[92:95], a[44:47], v[148:151], v[92:95]
    s_xor_b32 s75, s75, 65536
    v_mfma_f32_16x16x32_bf16 v[92:95], a[28:31], v[144:147], v[92:95]
    s_waitcnt vmcnt(8)
    v_mfma_f32_16x16x32_bf16 v[96:99], a[16:19], v[160:163], v[96:99]
    buffer_load_dwordx4 v[144:147], v52, s[24:27], s75 offen sc1
    v_mfma_f32_16x16x32_bf16 v[96:99], a[32:35], v[164:167], v[96:99]
    v_mfma_f32_16x16x32_bf16 v[96:99], a[48:51], v[168:171], v[96:99]
    v_mfma_f32_16x16x32_bf16 v[96:99], a[128:131], v[172:175], v[96:99]
    v_mfma_f32_16x16x32_bf16 v[100:103], a[132:135], v[172:175], v[100:103]
    buffer_load_dwordx4 v[148:151], v53, s[24:27], s75 offen sc1
    v_mfma_f32_16x16x32_bf16 v[100:103], a[52:55], v[168:171], v[100:103]
    v_mfma_f32_16x16x32_bf16 v[100:103], a[36:39], v[164:167], v[100:103]
    v_mfma_f32_16x16x32_bf16 v[100:103], a[20:23], v[160:163], v[100:103]
    v_mfma_f32_16x16x32_bf16 v[104:107], a[24:27], v[160:163], v[104:107]
    buffer_load_dwordx4 v[152:155], v54, s[24:27], s75 offen sc1
    v_mfma_f32_16x16x32_bf16 v[104:107], a[40:43], v[164:167], v[104:107]
    v_mfma_f32_16x16x32_bf16 v[104:107], a[56:59], v[168:171], v[104:107]
    v_mfma_f32_16x16x32_bf16 v[104:107], a[136:139], v[172:175], v[104:107]
    v_mfma_f32_16x16x32_bf16 v[108:111], a[140:143], v[172:175], v[108:111]
    buffer_load_dwordx4 v[156:159], v55, s[24:27], s75 offen sc1
    v_mfma_f32_16x16x32_bf16 v[108:111], a[60:63], v[168:171], v[108:111]
    v_mfma_f32_16x16x32_bf16 v[108:111], a[44:47], v[164:167], v[108:111]
    s_xor_b32 s75, s75, 196608
    v_mfma_f32_16x16x32_bf16 v[108:111], a[28:31], v[160:163], v[108:111]
    s_waitcnt vmcnt(8)
    v_mfma_f32_16x16x32_bf16 v[112:115], a[16:19], v[176:179], v[112:115]
    buffer_load_dwordx4 v[160:163], v52, s[24:27], s75 offen sc1
    v_mfma_f32_16x16x32_bf16 v[112:115], a[32:35], v[180:183], v[112:115]
    v_mfma_f32_16x16x32_bf16 v[112:115], a[48:51], v[184:187], v[112:115]
    v_mfma_f32_16x16x32_bf16 v[112:115], a[128:131], v[188:191], v[112:115]
    v_mfma_f32_16x16x32_bf16 v[116:119], a[132:135], v[188:191], v[116:119]
    buffer_load_dwordx4 v[164:167], v53, s[24:27], s75 offen sc1
    v_mfma_f32_16x16x32_bf16 v[116:119], a[52:55], v[184:187], v[116:119]
    v_mfma_f32_16x16x32_bf16 v[116:119], a[36:39], v[180:183], v[116:119]
    v_mfma_f32_16x16x32_bf16 v[116:119], a[20:23], v[176:179], v[116:119]
    v_mfma_f32_16x16x32_bf16 v[120:123], a[24:27], v[176:179], v[120:123]
    buffer_load_dwordx4 v[168:171], v54, s[24:27], s75 offen sc1
    v_mfma_f32_16x16x32_bf16 v[120:123], a[40:43], v[180:183], v[120:123]
    v_mfma_f32_16x16x32_bf16 v[120:123], a[56:59], v[184:187], v[120:123]
    v_mfma_f32_16x16x32_bf16 v[120:123], a[136:139], v[188:191], v[120:123]
    v_mfma_f32_16x16x32_bf16 v[124:127], a[140:143], v[188:191], v[124:127]
    buffer_load_dwordx4 v[172:175], v55, s[24:27], s75 offen sc1
    v_mfma_f32_16x16x32_bf16 v[124:127], a[60:63], v[184:187], v[124:127]
    v_mfma_f32_16x16x32_bf16 v[124:127], a[44:47], v[180:183], v[124:127]
    s_xor_b32 s75, s75, 65536
    v_mfma_f32_16x16x32_bf16 v[124:127], a[28:31], v[176:179], v[124:127]
    s_waitcnt vmcnt(8)
    v_mfma_f32_16x16x32_bf16 v[64:67], a[96:99], v[128:131], v[64:67]
    buffer_load_dwordx4 v[176:179], v52, s[24:27], s75 offen sc1
    v_mfma_f32_16x16x32_bf16 v[64:67], a[112:115], v[132:135], v[64:67]
    v_mfma_f32_16x16x32_bf16 v[64:67], a[224:227], v[136:139], v[64:67]
    v_mfma_f32_16x16x32_bf16 v[64:67], a[240:243], v[140:143], v[64:67]
    v_mfma_f32_16x16x32_bf16 v[68:71], a[244:247], v[140:143], v[68:71]
    buffer_load_dwordx4 v[180:183], v53, s[24:27], s75 offen sc1
    v_mfma_f32_16x16x32_bf16 v[68:71], a[228:231], v[136:139], v[68:71]
    v_mfma_f32_16x16x32_bf16 v[68:71], a[116:119], v[132:135], v[68:71]
    v_mfma_f32_16x16x32_bf16 v[68:71], a[100:103], v[128:131], v[68:71]
    v_mfma_f32_16x16x32_bf16 v[72:75], a[104:107], v[128:131], v[72:75]
    buffer_load_dwordx4 v[184:187], v54, s[24:27], s75 offen sc1
    v_mfma_f32_16x16x32_bf16 v[72:75], a[120:123], v[132:135], v[72:75]
    v_mfma_f32_16x16x32_bf16 v[72:75], a[232:235], v[136:139], v[72:75]
    v_mfma_f32_16x16x32_bf16 v[72:75], a[248:251], v[140:143], v[72:75]
    v_mfma_f32_16x16x32_bf16 v[76:79], a[252:255], v[140:143], v[76:79]
    buffer_load_dwordx4 v[188:191], v55, s[24:27], s75 offen sc1
    v_mfma_f32_16x16x32_bf16 v[76:79], a[236:239], v[136:139], v[76:79]
    v_mfma_f32_16x16x32_bf16 v[76:79], a[124:127], v[132:135], v[76:79]
    s_xor_b32 s75, s75, 196608
    v_mfma_f32_16x16x32_bf16 v[76:79], a[108:111], v[128:131], v[76:79]
    s_waitcnt vmcnt(8)
    v_mfma_f32_16x16x32_bf16 v[80:83], a[96:99], v[144:147], v[80:83]
    buffer_load_dwordx4 v[128:131], v52, s[24:27], s77 offen sc1
    v_mfma_f32_16x16x32_bf16 v[80:83], a[112:115], v[148:151], v[80:83]
    v_mfma_f32_16x16x32_bf16 v[80:83], a[224:227], v[152:155], v[80:83]
    ds_write_b128 v48, v[64:67] offset:0
    v_mfma_f32_16x16x32_bf16 v[80:83], a[240:243], v[156:159], v[80:83]
    v_mfma_f32_16x16x32_bf16 v[84:87], a[244:247], v[156:159], v[84:87]
    buffer_load_dwordx4 v[132:135], v53, s[24:27], s77 offen sc1
    v_mfma_f32_16x16x32_bf16 v[84:87], a[228:231], v[152:155], v[84:87]
    v_mfma_f32_16x16x32_bf16 v[84:87], a[116:119], v[148:151], v[84:87]
    ds_write_b128 v49, v[68:71] offset:0
    v_mfma_f32_16x16x32_bf16 v[84:87], a[100:103], v[144:147], v[84:87]
    v_mfma_f32_16x16x32_bf16 v[88:91], a[104:107], v[144:147], v[88:91]
    buffer_load_dwordx4 v[136:139], v54, s[24:27], s77 offen sc1
    v_mfma_f32_16x16x32_bf16 v[88:91], a[120:123], v[148:151], v[88:91]
    v_mfma_f32_16x16x32_bf16 v[88:91], a[232:235], v[152:155], v[88:91]
    ds_write_b128 v48, v[72:75] offset:128
    v_mfma_f32_16x16x32_bf16 v[88:91], a[248:251], v[156:159], v[88:91]
    v_mfma_f32_16x16x32_bf16 v[92:95], a[252:255], v[156:159], v[92:95]
    buffer_load_dwordx4 v[140:143], v55, s[24:27], s77 offen sc1
    v_mfma_f32_16x16x32_bf16 v[92:95], a[236:239], v[152:155], v[92:95]
    ds_write_b128 v49, v[76:79] offset:128
L_pad11:
    s_cbranch_execz L_pad15
    v_mfma_f32_16x16x32_bf16 v[92:95], a[124:127], v[148:151], v[92:95]
    s_xor_b32 s77, s77, 65536
    v_mfma_f32_16x16x32_bf16 v[92:95], a[108:111], v[144:147], v[92:95]
    s_waitcnt vmcnt(8)
    v_mfma_f32_16x16x32_bf16 v[96:99], a[96:99], v[160:163], v[96:99]
    buffer_load_dwordx4 v[144:147], v52, s[24:27], s77 offen sc1
    v_mfma_f32_16x16x32_bf16 v[96:99], a[112:115], v[164:167], v[96:99]
    v_mfma_f32_16x16x32_bf16 v[96:99], a[224:227], v[168:171], v[96:99]
    ds_write_b128 v48, v[80:83] offset:16384
    v_mfma_f32_16x16x32_bf16 v[96:99], a[240:243], v[172:175], v[96:99]
    v_mfma_f32_16x16x32_bf16 v[100:103], a[244:247], v[172:175], v[100:103]
    buffer_load_dwordx4 v[148:151], v53, s[24:27], s77 offen sc1
    v_mfma_f32_16x16x32_bf16 v[100:103], a[228:231], v[168:171], v[100:103]
    v_mfma_f32_16x16x32_bf16 v[100:103], a[116:119], v[164:167], v[100:103]
    ds_write_b128 v49, v[84:87] offset:16384
    v_mfma_f32_16x16x32_bf16 v[100:103], a[100:103], v[160:163], v[100:103]
    v_mfma_f32_16x16x32_bf16 v[104:107], a[104:107], v[160:163], v[104:107]
    buffer_load_dwordx4 v[152:155], v54, s[24:27], s77 offen sc1
    v_mfma_f32_16x16x32_bf16 v[104:107], a[120:123], v[164:167], v[104:107]
    v_mfma_f32_16x16x32_bf16 v[104:107], a[232:235], v[168:171], v[104:107]
    ds_write_b128 v48, v[88:91] offset:16512
    v_mfma_f32_16x16x32_bf16 v[104:107], a[248:251], v[172:175], v[104:107]
    v_mfma_f32_16x16x32_bf16 v[108:111], a[252:255], v[172:175], v[108:111]
    buffer_load_dwordx4 v[156:159], v55, s[24:27], s77 offen sc1
    v_mfma_f32_16x16x32_bf16 v[108:111], a[236:239], v[168:171], v[108:111]
    ds_write_b128 v49, v[92:95] offset:16512
    v_mfma_f32_16x16x32_bf16 v[108:111], a[124:127], v[164:167], v[108:111]
    s_xor_b32 s77, s77, 196608
    v_mfma_f32_16x16x32_bf16 v[108:111], a[108:111], v[160:163], v[108:111]
    s_waitcnt vmcnt(8)
    v_mfma_f32_16x16x32_bf16 v[112:115], a[96:99], v[176:179], v[112:115]
    buffer_load_dwordx4 v[160:163], v52, s[24:27], s77 offen sc1
    v_mfma_f32_16x16x32_bf16 v[112:115], a[112:115], v[180:183], v[112:115]
    s_waitcnt lgkmcnt(0)
    s_barrier
    v_mfma_f32_16x16x32_bf16 v[112:115], a[224:227], v[184:187], v[112:115]
    ds_write_b128 v48, v[96:99] offset:32768
    v_mfma_f32_16x16x32_bf16 v[112:115], a[240:243], v[188:191], v[112:115]
    ds_read_b128 v[64:67], v50 offset:0
    ds_read_b128 v[68:71], v51 offset:0
    v_mfma_f32_16x16x32_bf16 v[116:119], a[244:247], v[188:191], v[116:119]
    buffer_load_dwordx4 v[164:167], v53, s[24:27], s77 offen sc1
    v_mfma_f32_16x16x32_bf16 v[116:119], a[228:231], v[184:187], v[116:119]
    ds_read_b128 v[72:75], v50 offset:4096
    ds_read_b128 v[76:79], v51 offset:4096
    v_mfma_f32_16x16x32_bf16 v[116:119], a[116:119], v[180:183], v[116:119]
    ds_write_b128 v49, v[100:103] offset:32768
    v_mfma_f32_16x16x32_bf16 v[116:119], a[100:103], v[176:179], v[116:119]
    v_mfma_f32_16x16x32_bf16 v[120:123], a[104:107], v[176:179], v[120:123]
    buffer_load_dwordx4 v[168:171], v54, s[24:27], s77 offen sc1
    v_mfma_f32_16x16x32_bf16 v[120:123], a[120:123], v[180:183], v[120:123]
    ds_read_b128 v[80:83], v50 offset:8192
    ds_read_b128 v[84:87], v51 offset:8192
    v_mfma_f32_16x16x32_bf16 v[120:123], a[232:235], v[184:187], v[120:123]
    ds_write_b128 v48, v[104:107] offset:32896
    v_mfma_f32_16x16x32_bf16 v[120:123], a[248:251], v[188:191], v[120:123]
    ds_read_b128 v[88:91], v50 offset:12288
    ds_read_b128 v[92:95], v51 offset:12288
    v_mfma_f32_16x16x32_bf16 v[124:127], a[252:255], v[188:191], v[124:127]
    buffer_load_dwordx4 v[172:175], v55, s[24:27], s77 offen sc1
    v_mfma_f32_16x16x32_bf16 v[124:127], a[236:239], v[184:187], v[124:127]
    ds_write_b128 v49, v[108:111] offset:32896
    v_mfma_f32_16x16x32_bf16 v[124:127], a[124:127], v[180:183], v[124:127]
    s_xor_b32 s77, s77, 65536
    v_mfma_f32_16x16x32_bf16 v[124:127], a[108:111], v[176:179], v[124:127]
    s_waitcnt vmcnt(8)
    v_mfma_f32_16x16x32_bf16 v[192:195], a[208:211], v[128:131], v[192:195]
    buffer_load_dwordx4 v[176:179], v52, s[24:27], s77 offen sc1
    v_mfma_f32_16x16x32_bf16 v[192:195], a[64:67], v[132:135], v[192:195]
    v_mfma_f32_16x16x32_bf16 v[192:195], a[80:83], v[136:139], v[192:195]
    ds_write_b128 v48, v[112:115] offset:49152
    v_mfma_f32_16x16x32_bf16 v[192:195], a[0:3], v[140:143], v[192:195]
    s_waitcnt lgkmcnt(2)
    v_add_f32 v64, v64, v72
    v_add_f32 v65, v65, v73
    v_mfma_f32_16x16x32_bf16 v[196:199], a[4:7], v[140:143], v[196:199]
    buffer_load_dwordx4 v[180:183], v53, s[24:27], s77 offen sc1
    v_mfma_f32_16x16x32_bf16 v[196:199], a[84:87], v[136:139], v[196:199]
    v_add_f32 v66, v66, v74
    v_add_f32 v67, v67, v75
    v_mfma_f32_16x16x32_bf16 v[196:199], a[68:71], v[132:135], v[196:199]
    ds_write_b128 v49, v[116:119] offset:49152
    v_mfma_f32_16x16x32_bf16 v[196:199], a[212:215], v[128:131], v[196:199]
    v_add_f32 v68, v68, v76
    v_add_f32 v69, v69, v77
    v_mfma_f32_16x16x32_bf16 v[200:203], a[216:219], v[128:131], v[200:203]
    buffer_load_dwordx4 v[184:187], v54, s[24:27], s77 offen sc1
    v_mfma_f32_16x16x32_bf16 v[200:203], a[72:75], v[132:135], v[200:203]
    v_add_f32 v70, v70, v78
    v_add_f32 v71, v71, v79
    v_mfma_f32_16x16x32_bf16 v[200:203], a[88:91], v[136:139], v[200:203]
    ds_write_b128 v48, v[120:123] offset:49280
    v_mfma_f32_16x16x32_bf16 v[200:203], a[8:11], v[140:143], v[200:203]
    v_add_f32 v80, v80, v88
    v_add_f32 v81, v81, v89
    v_mfma_f32_16x16x32_bf16 v[204:207], a[12:15], v[140:143], v[204:207]
    buffer_load_dwordx4 v[188:191], v55, s[24:27], s77 offen sc1
    v_mfma_f32_16x16x32_bf16 v[204:207], a[92:95], v[136:139], v[204:207]
    ds_write_b128 v49, v[124:127] offset:49280
    v_mfma_f32_16x16x32_bf16 v[204:207], a[76:79], v[132:135], v[204:207]
    s_xor_b32 s77, s77, 196608
    v_add_f32 v82, v82, v90
    v_add_f32 v83, v83, v91
    v_mfma_f32_16x16x32_bf16 v[204:207], a[220:223], v[128:131], v[204:207]
    v_add_f32 v84, v84, v92
    v_add_f32 v85, v85, v93
    s_waitcnt vmcnt(8)
    v_mfma_f32_16x16x32_bf16 v[208:211], a[208:211], v[144:147], v[208:211]
    buffer_load_dwordx4 v[128:131], v52, s[24:27], s78 offen sc1
    v_mfma_f32_16x16x32_bf16 v[208:211], a[64:67], v[148:151], v[208:211]
    s_waitcnt lgkmcnt(0)
    s_barrier
    v_mfma_f32_16x16x32_bf16 v[208:211], a[80:83], v[152:155], v[208:211]
    v_add_f32 v86, v86, v94
    v_add_f32 v87, v87, v95
    v_mfma_f32_16x16x32_bf16 v[208:211], a[0:3], v[156:159], v[208:211]
    v_add_f32 v64, v64, v80
    v_add_f32 v65, v65, v81
    v_mfma_f32_16x16x32_bf16 v[212:215], a[4:7], v[156:159], v[212:215]
    buffer_load_dwordx4 v[132:135], v53, s[24:27], s78 offen sc1
    v_mfma_f32_16x16x32_bf16 v[212:215], a[84:87], v[152:155], v[212:215]
    v_add_f32 v66, v66, v82
    v_add_f32 v67, v67, v83
    v_mfma_f32_16x16x32_bf16 v[212:215], a[68:71], v[148:151], v[212:215]
    v_add_f32 v68, v68, v84
    v_add_f32 v69, v69, v85
    v_mfma_f32_16x16x32_bf16 v[212:215], a[212:215], v[144:147], v[212:215]
    v_add_f32 v70, v70, v86
    v_add_f32 v71, v71, v87
    v_mfma_f32_16x16x32_bf16 v[216:219], a[216:219], v[144:147], v[216:219]
    buffer_load_dwordx4 v[136:139], v54, s[24:27], s78 offen sc1
    v_mfma_f32_16x16x32_bf16 v[216:219], a[72:75], v[148:151], v[216:219]
    v_cvt_pk_bf16_f32 v72, v64, v65
    v_cvt_pk_bf16_f32 v73, v66, v67
    v_mfma_f32_16x16x32_bf16 v[216:219], a[88:91], v[152:155], v[216:219]
    v_cvt_pk_bf16_f32 v74, v68, v69
    v_cvt_pk_bf16_f32 v75, v70, v71
    v_mfma_f32_16x16x32_bf16 v[216:219], a[8:11], v[156:159], v[216:219]
    buffer_store_dwordx4 v[72:75], v30, s[24:27], s69 offen offset:0 sc1
    v_mfma_f32_16x16x32_bf16 v[220:223], a[12:15], v[156:159], v[220:223]
    buffer_load_dwordx4 v[140:143], v55, s[24:27], s78 offen sc1
    v_mfma_f32_16x16x32_bf16 v[220:223], a[92:95], v[152:155], v[220:223]
    ds_read_b128 v[96:99], v50 offset:32768
    ds_read_b128 v[100:103], v51 offset:32768
    v_mfma_f32_16x16x32_bf16 v[220:223], a[76:79], v[148:151], v[220:223]
    s_xor_b32 s78, s78, 65536
    ds_read_b128 v[104:107], v50 offset:36864
    ds_read_b128 v[108:111], v51 offset:36864
    v_mfma_f32_16x16x32_bf16 v[220:223], a[220:223], v[144:147], v[220:223]
    s_waitcnt vmcnt(9)
    v_mfma_f32_16x16x32_bf16 v[224:227], a[208:211], v[160:163], v[224:227]
    buffer_load_dwordx4 v[144:147], v52, s[24:27], s78 offen sc1
    v_mfma_f32_16x16x32_bf16 v[224:227], a[64:67], v[164:167], v[224:227]
    ds_read_b128 v[112:115], v50 offset:40960
    ds_read_b128 v[116:119], v51 offset:40960
    v_mfma_f32_16x16x32_bf16 v[224:227], a[80:83], v[168:171], v[224:227]
    ds_read_b128 v[120:123], v50 offset:45056
    ds_read_b128 v[124:127], v51 offset:45056
    v_mfma_f32_16x16x32_bf16 v[224:227], a[0:3], v[172:175], v[224:227]
    v_mfma_f32_16x16x32_bf16 v[228:231], a[4:7], v[172:175], v[228:231]
    buffer_load_dwordx4 v[148:151], v53, s[24:27], s78 offen sc1
    v_mfma_f32_16x16x32_bf16 v[228:231], a[84:87], v[168:171], v[228:231]
    v_mfma_f32_16x16x32_bf16 v[228:231], a[68:71], v[164:167], v[228:231]
    v_mfma_f32_16x16x32_bf16 v[228:231], a[212:215], v[160:163], v[228:231]
    s_waitcnt lgkmcnt(0)
    v_add_f32 v96, v96, v104
    v_add_f32 v97, v97, v105
    v_mfma_f32_16x16x32_bf16 v[232:235], a[216:219], v[160:163], v[232:235]
    buffer_load_dwordx4 v[152:155], v54, s[24:27], s78 offen sc1
    v_mfma_f32_16x16x32_bf16 v[232:235], a[72:75], v[164:167], v[232:235]
    v_add_f32 v98, v98, v106
    v_add_f32 v99, v99, v107
    v_mfma_f32_16x16x32_bf16 v[232:235], a[88:91], v[168:171], v[232:235]
    v_add_f32 v100, v100, v108
    v_add_f32 v101, v101, v109
    v_mfma_f32_16x16x32_bf16 v[232:235], a[8:11], v[172:175], v[232:235]
    v_add_f32 v102, v102, v110
    v_add_f32 v103, v103, v111
    v_mfma_f32_16x16x32_bf16 v[236:239], a[12:15], v[172:175], v[236:239]
    buffer_load_dwordx4 v[156:159], v55, s[24:27], s78 offen sc1
    v_mfma_f32_16x16x32_bf16 v[236:239], a[92:95], v[168:171], v[236:239]
    v_add_f32 v112, v112, v120
    v_add_f32 v113, v113, v121
    v_mfma_f32_16x16x32_bf16 v[236:239], a[76:79], v[164:167], v[236:239]
    s_xor_b32 s78, s78, 196608
    v_add_f32 v114, v114, v122
    v_add_f32 v115, v115, v123
    v_mfma_f32_16x16x32_bf16 v[236:239], a[220:223], v[160:163], v[236:239]
    v_add_f32 v116, v116, v124
    v_add_f32 v117, v117, v125
    s_waitcnt vmcnt(9)
    v_mfma_f32_16x16x32_bf16 v[240:243], a[208:211], v[176:179], v[240:243]
    buffer_load_dwordx4 v[160:163], v52, s[24:27], s78 offen sc1
    v_mfma_f32_16x16x32_bf16 v[240:243], a[64:67], v[180:183], v[240:243]
    v_add_f32 v118, v118, v126
    v_add_f32 v119, v119, v127
    v_mfma_f32_16x16x32_bf16 v[240:243], a[80:83], v[184:187], v[240:243]
    v_add_f32 v96, v96, v112
    v_add_f32 v97, v97, v113
    v_mfma_f32_16x16x32_bf16 v[240:243], a[0:3], v[188:191], v[240:243]
    v_add_f32 v98, v98, v114
    v_add_f32 v99, v99, v115
    v_mfma_f32_16x16x32_bf16 v[244:247], a[4:7], v[188:191], v[244:247]
    buffer_load_dwordx4 v[164:167], v53, s[24:27], s78 offen sc1
    v_mfma_f32_16x16x32_bf16 v[244:247], a[84:87], v[184:187], v[244:247]
    v_add_f32 v100, v100, v116
    v_add_f32 v101, v101, v117
    v_mfma_f32_16x16x32_bf16 v[244:247], a[68:71], v[180:183], v[244:247]
    v_add_f32 v102, v102, v118
    v_add_f32 v103, v103, v119
    v_mfma_f32_16x16x32_bf16 v[244:247], a[212:215], v[176:179], v[244:247]
    v_cvt_pk_bf16_f32 v104, v96, v97
    v_cvt_pk_bf16_f32 v105, v98, v99
    v_mfma_f32_16x16x32_bf16 v[248:251], a[216:219], v[176:179], v[248:251]
    buffer_load_dwordx4 v[168:171], v54, s[24:27], s78 offen sc1
    v_mfma_f32_16x16x32_bf16 v[248:251], a[72:75], v[180:183], v[248:251]
    v_cvt_pk_bf16_f32 v106, v100, v101
    v_cvt_pk_bf16_f32 v107, v102, v103
    v_mfma_f32_16x16x32_bf16 v[248:251], a[88:91], v[184:187], v[248:251]
    buffer_store_dwordx4 v[104:107], v30, s[24:27], s69 offen offset:1024 sc1
    v_mfma_f32_16x16x32_bf16 v[248:251], a[8:11], v[188:191], v[248:251]
    v_mfma_f32_16x16x32_bf16 v[252:255], a[12:15], v[188:191], v[252:255]
    buffer_load_dwordx4 v[172:175], v55, s[24:27], s78 offen sc1
    v_mfma_f32_16x16x32_bf16 v[252:255], a[92:95], v[184:187], v[252:255]
    v_mfma_f32_16x16x32_bf16 v[252:255], a[76:79], v[180:183], v[252:255]
    s_xor_b32 s78, s78, 65536
    v_mfma_f32_16x16x32_bf16 v[252:255], a[220:223], v[176:179], v[252:255]
    s_waitcnt vmcnt(9)
    v_mfma_f32_16x16x32_bf16 v[192:195], a[16:19], v[128:131], v[192:195]
    buffer_load_dwordx4 v[176:179], v52, s[24:27], s78 offen sc1
    v_mfma_f32_16x16x32_bf16 v[192:195], a[32:35], v[132:135], v[192:195]
    v_mfma_f32_16x16x32_bf16 v[192:195], a[48:51], v[136:139], v[192:195]
    v_mfma_f32_16x16x32_bf16 v[192:195], a[128:131], v[140:143], v[192:195]
    v_mfma_f32_16x16x32_bf16 v[196:199], a[132:135], v[140:143], v[196:199]
    buffer_load_dwordx4 v[180:183], v53, s[24:27], s78 offen sc1
    v_mfma_f32_16x16x32_bf16 v[196:199], a[52:55], v[136:139], v[196:199]
    v_mfma_f32_16x16x32_bf16 v[196:199], a[36:39], v[132:135], v[196:199]
    v_mfma_f32_16x16x32_bf16 v[196:199], a[20:23], v[128:131], v[196:199]
    v_mfma_f32_16x16x32_bf16 v[200:203], a[24:27], v[128:131], v[200:203]
    buffer_load_dwordx4 v[184:187], v54, s[24:27], s78 offen sc1
    v_mfma_f32_16x16x32_bf16 v[200:203], a[40:43], v[132:135], v[200:203]
    v_mfma_f32_16x16x32_bf16 v[200:203], a[56:59], v[136:139], v[200:203]
    v_mfma_f32_16x16x32_bf16 v[200:203], a[136:139], v[140:143], v[200:203]
    v_mfma_f32_16x16x32_bf16 v[204:207], a[140:143], v[140:143], v[204:207]
    buffer_load_dwordx4 v[188:191], v55, s[24:27], s78 offen sc1
    v_mfma_f32_16x16x32_bf16 v[204:207], a[60:63], v[136:139], v[204:207]
    v_mfma_f32_16x16x32_bf16 v[204:207], a[44:47], v[132:135], v[204:207]
    s_xor_b32 s78, s78, 196608
    v_mfma_f32_16x16x32_bf16 v[204:207], a[28:31], v[128:131], v[204:207]
    s_waitcnt vmcnt(9)
    v_mfma_f32_16x16x32_bf16 v[208:211], a[16:19], v[144:147], v[208:211]
    buffer_load_dwordx4 v[128:131], v52, s[24:27], s79 offen sc1
    v_mfma_f32_16x16x32_bf16 v[208:211], a[32:35], v[148:151], v[208:211]
    v_mfma_f32_16x16x32_bf16 v[208:211], a[48:51], v[152:155], v[208:211]
    v_mfma_f32_16x16x32_bf16 v[208:211], a[128:131], v[156:159], v[208:211]
    v_mfma_f32_16x16x32_bf16 v[212:215], a[132:135], v[156:159], v[212:215]
    buffer_load_dwordx4 v[132:135], v53, s[24:27], s79 offen sc1
    v_mfma_f32_16x16x32_bf16 v[212:215], a[52:55], v[152:155], v[212:215]
    v_mfma_f32_16x16x32_bf16 v[212:215], a[36:39], v[148:151], v[212:215]
    v_mfma_f32_16x16x32_bf16 v[212:215], a[20:23], v[144:147], v[212:215]
    v_mfma_f32_16x16x32_bf16 v[216:219], a[24:27], v[144:147], v[216:219]
    buffer_load_dwordx4 v[136:139], v54, s[24:27], s79 offen sc1
    v_mfma_f32_16x16x32_bf16 v[216:219], a[40:43], v[148:151], v[216:219]
    v_mfma_f32_16x16x32_bf16 v[216:219], a[56:59], v[152:155], v[216:219]
    v_mfma_f32_16x16x32_bf16 v[216:219], a[136:139], v[156:159], v[216:219]
    v_mfma_f32_16x16x32_bf16 v[220:223], a[140:143], v[156:159], v[220:223]
    buffer_load_dwordx4 v[140:143], v55, s[24:27], s79 offen sc1
    v_mfma_f32_16x16x32_bf16 v[220:223], a[60:63], v[152:155], v[220:223]
    v_mfma_f32_16x16x32_bf16 v[220:223], a[44:47], v[148:151], v[220:223]
    s_xor_b32 s79, s79, 65536
    v_mfma_f32_16x16x32_bf16 v[220:223], a[28:31], v[144:147], v[220:223]
    s_waitcnt vmcnt(8)
    v_mfma_f32_16x16x32_bf16 v[224:227], a[16:19], v[160:163], v[224:227]
    buffer_load_dwordx4 v[144:147], v52, s[24:27], s79 offen sc1
    v_mfma_f32_16x16x32_bf16 v[224:227], a[32:35], v[164:167], v[224:227]
    v_mfma_f32_16x16x32_bf16 v[224:227], a[48:51], v[168:171], v[224:227]
    v_mfma_f32_16x16x32_bf16 v[224:227], a[128:131], v[172:175], v[224:227]
    v_mfma_f32_16x16x32_bf16 v[228:231], a[132:135], v[172:175], v[228:231]
    buffer_load_dwordx4 v[148:151], v53, s[24:27], s79 offen sc1
    v_mfma_f32_16x16x32_bf16 v[228:231], a[52:55], v[168:171], v[228:231]
    v_mfma_f32_16x16x32_bf16 v[228:231], a[36:39], v[164:167], v[228:231]
    v_mfma_f32_16x16x32_bf16 v[228:231], a[20:23], v[160:163], v[228:231]
    v_mfma_f32_16x16x32_bf16 v[232:235], a[24:27], v[160:163], v[232:235]
    buffer_load_dwordx4 v[152:155], v54, s[24:27], s79 offen sc1
    v_mfma_f32_16x16x32_bf16 v[232:235], a[40:43], v[164:167], v[232:235]
    v_mfma_f32_16x16x32_bf16 v[232:235], a[56:59], v[168:171], v[232:235]
    v_mfma_f32_16x16x32_bf16 v[232:235], a[136:139], v[172:175], v[232:235]
    v_mfma_f32_16x16x32_bf16 v[236:239], a[140:143], v[172:175], v[236:239]
    buffer_load_dwordx4 v[156:159], v55, s[24:27], s79 offen sc1
    v_mfma_f32_16x16x32_bf16 v[236:239], a[60:63], v[168:171], v[236:239]
    v_mfma_f32_16x16x32_bf16 v[236:239], a[44:47], v[164:167], v[236:239]
    s_xor_b32 s79, s79, 196608
    v_mfma_f32_16x16x32_bf16 v[236:239], a[28:31], v[160:163], v[236:239]
    s_waitcnt vmcnt(8)
    v_mfma_f32_16x16x32_bf16 v[240:243], a[16:19], v[176:179], v[240:243]
    buffer_load_dwordx4 v[160:163], v52, s[24:27], s79 offen sc1
    v_mfma_f32_16x16x32_bf16 v[240:243], a[32:35], v[180:183], v[240:243]
    v_mfma_f32_16x16x32_bf16 v[240:243], a[48:51], v[184:187], v[240:243]
    v_mfma_f32_16x16x32_bf16 v[240:243], a[128:131], v[188:191], v[240:243]
    v_mfma_f32_16x16x32_bf16 v[244:247], a[132:135], v[188:191], v[244:247]
    buffer_load_dwordx4 v[164:167], v53, s[24:27], s79 offen sc1
    v_mfma_f32_16x16x32_bf16 v[244:247], a[52:55], v[184:187], v[244:247]
    v_mfma_f32_16x16x32_bf16 v[244:247], a[36:39], v[180:183], v[244:247]
    v_mfma_f32_16x16x32_bf16 v[244:247], a[20:23], v[176:179], v[244:247]
    v_mfma_f32_16x16x32_bf16 v[248:251], a[24:27], v[176:179], v[248:251]
    buffer_load_dwordx4 v[168:171], v54, s[24:27], s79 offen sc1
    v_mfma_f32_16x16x32_bf16 v[248:251], a[40:43], v[180:183], v[248:251]
    v_mfma_f32_16x16x32_bf16 v[248:251], a[56:59], v[184:187], v[248:251]
    v_mfma_f32_16x16x32_bf16 v[248:251], a[136:139], v[188:191], v[248:251]
    v_mfma_f32_16x16x32_bf16 v[252:255], a[140:143], v[188:191], v[252:255]
    buffer_load_dwordx4 v[172:175], v55, s[24:27], s79 offen sc1
    v_mfma_f32_16x16x32_bf16 v[252:255], a[60:63], v[184:187], v[252:255]
    v_mfma_f32_16x16x32_bf16 v[252:255], a[44:47], v[180:183], v[252:255]
    s_xor_b32 s79, s79, 65536
    v_mfma_f32_16x16x32_bf16 v[252:255], a[28:31], v[176:179], v[252:255]
    s_waitcnt vmcnt(8)
    v_mfma_f32_16x16x32_bf16 v[192:195], a[96:99], v[128:131], v[192:195]
    buffer_load_dwordx4 v[176:179], v52, s[24:27], s79 offen sc1
    v_mfma_f32_16x16x32_bf16 v[192:195], a[112:115], v[132:135], v[192:195]
    v_add_u32 v48, 65536, v48
    v_add_u32 v49, 65536, v49
    v_mfma_f32_16x16x32_bf16 v[192:195], a[224:227], v[136:139], v[192:195]
    v_add_u32 v50, 65536, v50
    v_add_u32 v51, 65536, v51
    v_mfma_f32_16x16x32_bf16 v[192:195], a[240:243], v[140:143], v[192:195]
    v_lshlrev_b32 v64, 16, v40
    v_and_b32 v65, 0xffff0000, v40
    v_mfma_f32_16x16x32_bf16 v[196:199], a[244:247], v[140:143], v[196:199]
    buffer_load_dwordx4 v[180:183], v53, s[24:27], s79 offen sc1
    v_mfma_f32_16x16x32_bf16 v[196:199], a[228:231], v[136:139], v[196:199]
    v_lshlrev_b32 v66, 16, v41
    v_and_b32 v67, 0xffff0000, v41
    v_mfma_f32_16x16x32_bf16 v[196:199], a[116:119], v[132:135], v[196:199]
    v_lshlrev_b32 v68, 16, v42
    v_and_b32 v69, 0xffff0000, v42
    v_mfma_f32_16x16x32_bf16 v[196:199], a[100:103], v[128:131], v[196:199]
    v_lshlrev_b32 v70, 16, v43
    v_and_b32 v71, 0xffff0000, v43
    v_mfma_f32_16x16x32_bf16 v[200:203], a[104:107], v[128:131], v[200:203]
    buffer_load_dwordx4 v[184:187], v54, s[24:27], s79 offen sc1
    v_mfma_f32_16x16x32_bf16 v[200:203], a[120:123], v[132:135], v[200:203]
    v_lshlrev_b32 v72, 16, v44
    v_and_b32 v73, 0xffff0000, v44
    v_mfma_f32_16x16x32_bf16 v[200:203], a[232:235], v[136:139], v[200:203]
    v_lshlrev_b32 v74, 16, v45
    v_and_b32 v75, 0xffff0000, v45
    v_mfma_f32_16x16x32_bf16 v[200:203], a[248:251], v[140:143], v[200:203]
    v_lshlrev_b32 v76, 16, v46
    v_and_b32 v77, 0xffff0000, v46
    v_mfma_f32_16x16x32_bf16 v[204:207], a[252:255], v[140:143], v[204:207]
    buffer_load_dwordx4 v[188:191], v55, s[24:27], s79 offen sc1
    v_mfma_f32_16x16x32_bf16 v[204:207], a[236:239], v[136:139], v[204:207]
    v_lshlrev_b32 v78, 16, v47
    v_and_b32 v79, 0xffff0000, v47
    v_mfma_f32_16x16x32_bf16 v[204:207], a[124:127], v[132:135], v[204:207]
    s_xor_b32 s79, s79, 196608
    v_lshlrev_b32 v80, 16, v16
    v_and_b32 v81, 0xffff0000, v16
    v_mfma_f32_16x16x32_bf16 v[204:207], a[108:111], v[128:131], v[204:207]
    v_lshlrev_b32 v82, 16, v17
    v_and_b32 v83, 0xffff0000, v17
    s_waitcnt vmcnt(8)
    v_mfma_f32_16x16x32_bf16 v[208:211], a[96:99], v[144:147], v[208:211]
    v_lshlrev_b32 v84, 16, v18
    v_and_b32 v85, 0xffff0000, v18
    v_mfma_f32_16x16x32_bf16 v[208:211], a[112:115], v[148:151], v[208:211]
    v_lshlrev_b32 v86, 16, v19
    v_and_b32 v87, 0xffff0000, v19
    v_mfma_f32_16x16x32_bf16 v[208:211], a[224:227], v[152:155], v[208:211]
    ds_write_b128 v48, v[192:195] offset:0
    v_mfma_f32_16x16x32_bf16 v[208:211], a[240:243], v[156:159], v[208:211]
    v_lshlrev_b32 v88, 16, v20
    v_and_b32 v89, 0xffff0000, v20
    v_mfma_f32_16x16x32_bf16 v[212:215], a[244:247], v[156:159], v[212:215]
    v_lshlrev_b32 v90, 16, v21
    v_and_b32 v91, 0xffff0000, v21
    v_mfma_f32_16x16x32_bf16 v[212:215], a[228:231], v[152:155], v[212:215]
    v_lshlrev_b32 v92, 16, v22
    v_and_b32 v93, 0xffff0000, v22
    v_mfma_f32_16x16x32_bf16 v[212:215], a[116:119], v[148:151], v[212:215]
    ds_write_b128 v49, v[196:199] offset:0
    v_mfma_f32_16x16x32_bf16 v[212:215], a[100:103], v[144:147], v[212:215]
    v_lshlrev_b32 v94, 16, v23
    v_and_b32 v95, 0xffff0000, v23
    v_mfma_f32_16x16x32_bf16 v[216:219], a[104:107], v[144:147], v[216:219]
    v_mfma_f32_16x16x32_bf16 v[216:219], a[120:123], v[148:151], v[216:219]
    buffer_load_dwordx4 v[8:11], v30, s[24:27], s70 offen offset:0 sc1
    v_mfma_f32_16x16x32_bf16 v[216:219], a[232:235], v[152:155], v[216:219]
    ds_write_b128 v48, v[200:203] offset:128
    v_mfma_f32_16x16x32_bf16 v[216:219], a[248:251], v[156:159], v[216:219]
    v_mfma_f32_16x16x32_bf16 v[220:223], a[252:255], v[156:159], v[220:223]
    v_mfma_f32_16x16x32_bf16 v[220:223], a[236:239], v[152:155], v[220:223]
    ds_write_b128 v49, v[204:207] offset:128
    v_mfma_f32_16x16x32_bf16 v[220:223], a[124:127], v[148:151], v[220:223]
    v_mfma_f32_16x16x32_bf16 v[220:223], a[108:111], v[144:147], v[220:223]
    buffer_load_dwordx4 v[12:15], v30, s[24:27], s70 offen offset:1024 sc1
    s_waitcnt vmcnt(6)
    v_mfma_f32_16x16x32_bf16 v[224:227], a[96:99], v[160:163], v[224:227]
    v_mfma_f32_16x16x32_bf16 v[224:227], a[112:115], v[164:167], v[224:227]
    v_mfma_f32_16x16x32_bf16 v[224:227], a[224:227], v[168:171], v[224:227]
    ds_write_b128 v48, v[208:211] offset:16384
    v_mfma_f32_16x16x32_bf16 v[224:227], a[240:243], v[172:175], v[224:227]
    v_mfma_f32_16x16x32_bf16 v[228:231], a[244:247], v[172:175], v[228:231]
    v_mfma_f32_16x16x32_bf16 v[228:231], a[228:231], v[168:171], v[228:231]
    v_mfma_f32_16x16x32_bf16 v[228:231], a[116:119], v[164:167], v[228:231]
    ds_write_b128 v49, v[212:215] offset:16384
    v_mfma_f32_16x16x32_bf16 v[228:231], a[100:103], v[160:163], v[228:231]
    v_mfma_f32_16x16x32_bf16 v[232:235], a[104:107], v[160:163], v[232:235]
    v_mfma_f32_16x16x32_bf16 v[232:235], a[120:123], v[164:167], v[232:235]
    v_mfma_f32_16x16x32_bf16 v[232:235], a[232:235], v[168:171], v[232:235]
    ds_write_b128 v48, v[216:219] offset:16512
    v_mfma_f32_16x16x32_bf16 v[232:235], a[248:251], v[172:175], v[232:235]
    v_mfma_f32_16x16x32_bf16 v[236:239], a[252:255], v[172:175], v[236:239]
    v_mfma_f32_16x16x32_bf16 v[236:239], a[236:239], v[168:171], v[236:239]
    ds_write_b128 v49, v[220:223] offset:16512
    v_mfma_f32_16x16x32_bf16 v[236:239], a[124:127], v[164:167], v[236:239]
    v_mfma_f32_16x16x32_bf16 v[236:239], a[108:111], v[160:163], v[236:239]
    s_waitcnt vmcnt(2)
    v_mfma_f32_16x16x32_bf16 v[240:243], a[96:99], v[176:179], v[240:243]
    v_mfma_f32_16x16x32_bf16 v[240:243], a[112:115], v[180:183], v[240:243]
    s_waitcnt lgkmcnt(0)
    s_barrier
    v_mfma_f32_16x16x32_bf16 v[240:243], a[224:227], v[184:187], v[240:243]
    ds_write_b128 v48, v[224:227] offset:32768
    v_mfma_f32_16x16x32_bf16 v[240:243], a[240:243], v[188:191], v[240:243]
    v_mfma_f32_16x16x32_bf16 v[244:247], a[244:247], v[188:191], v[244:247]
    ds_read_b128 v[192:195], v50 offset:0
    ds_read_b128 v[196:199], v51 offset:0
    v_mfma_f32_16x16x32_bf16 v[244:247], a[228:231], v[184:187], v[244:247]
    v_mfma_f32_16x16x32_bf16 v[244:247], a[116:119], v[180:183], v[244:247]
    ds_write_b128 v49, v[228:231] offset:32768
    v_mfma_f32_16x16x32_bf16 v[244:247], a[100:103], v[176:179], v[244:247]
    v_mfma_f32_16x16x32_bf16 v[248:251], a[104:107], v[176:179], v[248:251]
    ds_read_b128 v[200:203], v50 offset:4096
    ds_read_b128 v[204:207], v51 offset:4096
    v_mfma_f32_16x16x32_bf16 v[248:251], a[120:123], v[180:183], v[248:251]
    v_mfma_f32_16x16x32_bf16 v[248:251], a[232:235], v[184:187], v[248:251]
    ds_write_b128 v48, v[232:235] offset:32896
    v_mfma_f32_16x16x32_bf16 v[248:251], a[248:251], v[188:191], v[248:251]
    v_mfma_f32_16x16x32_bf16 v[252:255], a[252:255], v[188:191], v[252:255]
    ds_read_b128 v[208:211], v50 offset:8192
    ds_read_b128 v[212:215], v51 offset:8192
    v_mfma_f32_16x16x32_bf16 v[252:255], a[236:239], v[184:187], v[252:255]
    ds_write_b128 v49, v[236:239] offset:32896
    v_mfma_f32_16x16x32_bf16 v[252:255], a[124:127], v[180:183], v[252:255]
    v_mfma_f32_16x16x32_bf16 v[252:255], a[108:111], v[176:179], v[252:255]
    ds_read_b128 v[216:219], v50 offset:12288
    ds_read_b128 v[220:223], v51 offset:12288
    ds_write_b128 v48, v[240:243] offset:49152
    ds_write_b128 v49, v[244:247] offset:49152
    s_mov_b32 s48, s84
    s_mov_b32 s49, s85
    s_mov_b32 s50, 2097152
    s_mov_b32 s51, 0x00020000
    ds_write_b128 v48, v[248:251] offset:49280
    s_nop 0
    ds_write_b128 v49, v[252:255] offset:49280
    s_waitcnt vmcnt(0)
    v_max3_u32 v5, v8, v9, v10
    v_max3_u32 v6, v11, v12, v13
    v_max3_u32 v5, v5, v14, v15
    v_max_u32 v5, v5, v6
    v_cmp_ne_u32 vcc, -1, v5
    s_nop 0
    s_cmp_eq_u64 vcc, -1
    s_cbranch_scc0 L_pf_wait
L_pf_ok:
    v_lshlrev_b32 v96, 16, v8
    v_and_b32 v97, 0xffff0000, v8
    v_lshlrev_b32 v98, 16, v9
    v_and_b32 v99, 0xffff0000, v9
    v_lshlrev_b32 v100, 16, v10
    v_and_b32 v101, 0xffff0000, v10
    v_lshlrev_b32 v102, 16, v11
    v_and_b32 v103, 0xffff0000, v11
    v_lshlrev_b32 v104, 16, v12
    v_and_b32 v105, 0xffff0000, v12
    v_lshlrev_b32 v106, 16, v13
    v_and_b32 v107, 0xffff0000, v13
    v_lshlrev_b32 v108, 16, v14
    v_and_b32 v109, 0xffff0000, v14
    v_lshlrev_b32 v110, 16, v15
    v_and_b32 v111, 0xffff0000, v15
    s_waitcnt lgkmcnt(0)
    s_barrier
    ds_read_b128 v[224:227], v50 offset:32768
    ds_read_b128 v[228:231], v51 offset:32768
    ds_read_b128 v[232:235], v50 offset:36864
    ds_read_b128 v[236:239], v51 offset:36864
    ds_read_b128 v[240:243], v50 offset:40960
    ds_read_b128 v[244:247], v51 offset:40960
    ds_read_b128 v[248:251], v50 offset:45056
    ds_read_b128 v[252:255], v51 offset:45056
    v_pk_add_f32 v[192:193], v[192:193], v[200:201]
    v_pk_add_f32 v[208:209], v[208:209], v[216:217]
    v_pk_add_f32 v[194:195], v[194:195], v[202:203]
    v_pk_add_f32 v[210:211], v[210:211], v[218:219]
    v_pk_add_f32 v[196:197], v[196:197], v[204:205]
    v_pk_add_f32 v[212:213], v[212:213], v[220:221]
    v_pk_add_f32 v[198:199], v[198:199], v[206:207]
    v_pk_add_f32 v[214:215], v[214:215], v[222:223]
    v_pk_add_f32 v[192:193], v[192:193], v[208:209]
    v_pk_add_f32 v[194:195], v[194:195], v[210:211]
    v_pk_add_f32 v[196:197], v[196:197], v[212:213]
    v_pk_add_f32 v[198:199], v[198:199], v[214:215]
    v_pk_add_f32 v[192:193], v[192:193], v[96:97]
    v_pk_add_f32 v[194:195], v[194:195], v[98:99]
    v_pk_add_f32 v[196:197], v[196:197], v[100:101]
    v_pk_add_f32 v[198:199], v[198:199], v[102:103]
    v_cvt_pk_bf16_f32 v200, v192, v193
    v_cvt_pk_bf16_f32 v201, v194, v195
    v_cvt_pk_bf16_f32 v202, v196, v197
    v_cvt_pk_bf16_f32 v203, v198, v199
    v_lshlrev_b32 v192, 16, v200
    v_and_b32 v193, 0xffff0000, v200
    v_lshlrev_b32 v194, 16, v201
    v_and_b32 v195, 0xffff0000, v201
    v_lshlrev_b32 v196, 16, v202
    v_and_b32 v197, 0xffff0000, v202
    v_lshlrev_b32 v198, 16, v203
    v_and_b32 v199, 0xffff0000, v203
    v_pk_mul_f32 v[192:193], v[192:193], v[64:65]
    v_pk_mul_f32 v[194:195], v[194:195], v[66:67]
    v_pk_mul_f32 v[196:197], v[196:197], v[68:69]
    v_pk_mul_f32 v[198:199], v[198:199], v[70:71]
    v_cvt_pk_bf16_f32 v200, v192, v193
    v_cvt_pk_bf16_f32 v201, v194, v195
    v_cvt_pk_bf16_f32 v202, v196, v197
    v_cvt_pk_bf16_f32 v203, v198, v199
    v_lshlrev_b32 v192, 16, v200
    v_and_b32 v193, 0xffff0000, v200
    v_lshlrev_b32 v194, 16, v201
    v_and_b32 v195, 0xffff0000, v201
    v_lshlrev_b32 v196, 16, v202
    v_and_b32 v197, 0xffff0000, v202
    v_lshlrev_b32 v198, 16, v203
    v_and_b32 v199, 0xffff0000, v203
    v_pk_add_f32 v[192:193], v[192:193], v[80:81]
    v_pk_add_f32 v[194:195], v[194:195], v[82:83]
    v_pk_add_f32 v[196:197], v[196:197], v[84:85]
    v_pk_add_f32 v[198:199], v[198:199], v[86:87]
    v_cvt_pk_bf16_f32 v200, v192, v193
    v_cvt_pk_bf16_f32 v201, v194, v195
    v_cvt_pk_bf16_f32 v202, v196, v197
    v_cvt_pk_bf16_f32 v203, v198, v199
    buffer_store_dwordx4 v[200:203], v56, s[48:51], s58 offen
    s_waitcnt lgkmcnt(0)
    v_pk_add_f32 v[224:225], v[224:225], v[232:233]
    v_pk_add_f32 v[240:241], v[240:241], v[248:249]
    v_pk_add_f32 v[226:227], v[226:227], v[234:235]
    v_pk_add_f32 v[242:243], v[242:243], v[250:251]
    v_pk_add_f32 v[228:229], v[228:229], v[236:237]
    v_pk_add_f32 v[244:245], v[244:245], v[252:253]
    v_pk_add_f32 v[230:231], v[230:231], v[238:239]
    v_pk_add_f32 v[246:247], v[246:247], v[254:255]
    v_pk_add_f32 v[224:225], v[224:225], v[240:241]
    v_pk_add_f32 v[226:227], v[226:227], v[242:243]
    v_pk_add_f32 v[228:229], v[228:229], v[244:245]
    v_pk_add_f32 v[230:231], v[230:231], v[246:247]
    v_pk_add_f32 v[224:225], v[224:225], v[104:105]
    v_pk_add_f32 v[226:227], v[226:227], v[106:107]
    v_pk_add_f32 v[228:229], v[228:229], v[108:109]
    v_pk_add_f32 v[230:231], v[230:231], v[110:111]
    v_cvt_pk_bf16_f32 v232, v224, v225
    v_cvt_pk_bf16_f32 v233, v226, v227
    v_cvt_pk_bf16_f32 v234, v228, v229
    v_cvt_pk_bf16_f32 v235, v230, v231
    v_lshlrev_b32 v224, 16, v232
    v_and_b32 v225, 0xffff0000, v232
    v_lshlrev_b32 v226, 16, v233
L_pad12:
    s_cbranch_execz L_pad16
    v_and_b32 v227, 0xffff0000, v233
    v_lshlrev_b32 v228, 16, v234
    v_and_b32 v229, 0xffff0000, v234
    v_lshlrev_b32 v230, 16, v235
    v_and_b32 v231, 0xffff0000, v235
    v_pk_mul_f32 v[224:225], v[224:225], v[72:73]
    v_pk_mul_f32 v[226:227], v[226:227], v[74:75]
    v_pk_mul_f32 v[228:229], v[228:229], v[76:77]
    v_pk_mul_f32 v[230:231], v[230:231], v[78:79]
    v_cvt_pk_bf16_f32 v232, v224, v225
    v_cvt_pk_bf16_f32 v233, v226, v227
    v_cvt_pk_bf16_f32 v234, v228, v229
    v_cvt_pk_bf16_f32 v235, v230, v231
    v_lshlrev_b32 v224, 16, v232
    v_and_b32 v225, 0xffff0000, v232
    v_lshlrev_b32 v226, 16, v233
    v_and_b32 v227, 0xffff0000, v233
    v_lshlrev_b32 v228, 16, v234
    v_and_b32 v229, 0xffff0000, v234
    v_lshlrev_b32 v230, 16, v235
    v_and_b32 v231, 0xffff0000, v235
    v_pk_add_f32 v[224:225], v[224:225], v[88:89]
    v_pk_add_f32 v[226:227], v[226:227], v[90:91]
    v_pk_add_f32 v[228:229], v[228:229], v[92:93]
    v_pk_add_f32 v[230:231], v[230:231], v[94:95]
    v_cvt_pk_bf16_f32 v232, v224, v225
    v_cvt_pk_bf16_f32 v233, v226, v227
    v_cvt_pk_bf16_f32 v234, v228, v229
    v_cvt_pk_bf16_f32 v235, v230, v231
    buffer_store_dwordx4 v[232:235], v57, s[48:51], s58 offen
    s_endpgm
L_rf1:
    buffer_load_dword v33, v35, s[24:27], s7 offen sc1
    s_branch L_rf1_ok
L_rf5:
    buffer_load_dword v33, v35, s[24:27], s7 offen sc1
    s_branch L_rf5_ok
L_rf9:
    buffer_load_dword v33, v35, s[24:27], s7 offen sc1
    s_branch L_rf9_ok
L_go_wait:
    s_mov_b32 s57, 0
L_go_chk:
    v_and_b32 v116, v116, v117
    v_and_b32 v118, v118, v119
    v_and_b32 v116, v116, v118
    s_nop 0
    v_readfirstlane_b32 s42, v116
    s_nop 3
    s_cmp_lg_u32 s42, 0
    s_cbranch_scc1 L_go_ok
    s_add_u32 s57, s57, 1
    s_cmp_gt_u32 s57, 0x40000
    s_cbranch_scc1 L_go_ok
    s_sleep 1
    buffer_load_dwordx4 v[116:119], off, s[44:47], 0 sc1
    s_waitcnt vmcnt(0)
    s_branch L_go_chk
L_st_wait:
    s_mov_b32 s57, 0
L_st_chk:
    v_min3_u32 v59, v49, v53, v57
    v_min_u32 v59, v59, v61
    v_cmp_ne_u32 vcc, 0, v59
    s_nop 0
    s_cmp_eq_u64 vcc, -1
    s_cbranch_scc1 L_st_ok
    s_add_u32 s57, s57, 1
    s_cmp_gt_u32 s57, 0x40000
    s_cbranch_scc1 L_st_ok
    s_sleep 1
    buffer_load_dword v49, v55, s[24:27], s90 offen offset:0 sc1
    buffer_load_dword v53, v55, s[24:27], s90 offen offset:64 sc1
    buffer_load_dword v57, v55, s[24:27], s90 offen offset:128 sc1
    buffer_load_dword v61, v55, s[24:27], s90 offen offset:192 sc1
    s_waitcnt vmcnt(0)
    s_branch L_st_chk
L_pf_wait:
    s_mov_b32 s57, 0
L_pf_chk:
    v_max3_u32 v5, v8, v9, v10
    v_max3_u32 v6, v11, v12, v13
    v_max3_u32 v5, v5, v14, v15
    v_max_u32 v5, v5, v6
    v_cmp_ne_u32 vcc, -1, v5
    s_nop 0
    s_cmp_eq_u64 vcc, -1
    s_cbranch_scc1 L_pf_ok
    s_add_u32 s57, s57, 1
    s_cmp_gt_u32 s57, 0x40000
    s_cbranch_scc1 L_pf_ok
    s_sleep 1
    buffer_load_dwordx4 v[8:11], v30, s[24:27], s70 offen offset:0 sc1
    buffer_load_dwordx4 v[12:15], v30, s[24:27], s70 offen offset:1024 sc1
    s_waitcnt vmcnt(0)
    s_branch L_pf_chk
L_keys_wait:
    s_waitcnt vmcnt(0)
    v_mov_b32 v25, 0
    v_mov_b32 v33, 0
    s_mov_b32 s57, 0
L_keys_chk:
    v_cmp_ne_u32 vcc, 0, v26
    s_nop 0
    s_cmp_eq_u32 vcc_lo, -1
    s_cbranch_scc1 L_keys_ok
    s_add_u32 s57, s57, 1
    s_cmp_gt_u32 s57, 0x40000
    s_cbranch_scc1 L_keys_ok
    s_sleep 1
    buffer_load_dword v26, v34, s[44:47], 0 offen offset:32 sc1
    s_waitcnt vmcnt(0)
    s_branch L_keys_chk
L_up_wait:
    s_mov_b32 s57, 0
L_up_chk:
    v_max3_u32 v24, v36, v37, v38
    v_max3_u32 v25, v39, v60, v61
    v_max3_u32 v24, v24, v62, v63
    v_max_u32 v24, v24, v25
    v_cmp_ne_u32 vcc, -1, v24
    s_nop 0
    s_cmp_eq_u64 vcc, -1
    s_cbranch_scc1 L_up_ok
    s_add_u32 s57, s57, 1
    s_cmp_gt_u32 s57, 0x40000
    s_cbranch_scc1 L_up_ok
    s_sleep 1
    buffer_load_dwordx4 v[36:39], v31, s[24:27], s62 offen sc1
    buffer_load_dwordx4 v[60:63], v32, s[24:27], s62 offen sc1
    s_waitcnt vmcnt(0)
    s_branch L_up_chk
L_hw1:
    v_mov_b32 v28, 0
    s_mov_b32 s57, 0
L_hw1_chk:
    v_cmp_eq_u32 vcc, 1, v28
    s_nop 0
    s_or_b32 s5, s5, vcc_lo
    s_bitcmp1_b32 s5, 1
    s_cbranch_scc1 L_hw1_ok
    s_add_u32 s57, s57, 1
    s_cmp_gt_u32 s57, 0x40000
    s_cbranch_scc1 L_hw1_ok
    s_sleep 1
    buffer_load_dword v28, v35, s[24:27], s7 offen sc1
    s_waitcnt vmcnt(0)
    s_branch L_hw1_chk
L_hw2:
    v_mov_b32 v28, 0
    s_mov_b32 s57, 0
L_hw2_chk:
    v_cmp_eq_u32 vcc, 1, v28
    s_nop 0
    s_or_b32 s5, s5, vcc_lo
    s_bitcmp1_b32 s5, 2
    s_cbranch_scc1 L_hw2_ok
    s_add_u32 s57, s57, 1
    s_cmp_gt_u32 s57, 0x40000
    s_cbranch_scc1 L_hw2_ok
    s_sleep 1
    buffer_load_dword v28, v35, s[24:27], s7 offen sc1
    s_waitcnt vmcnt(0)
    s_branch L_hw2_chk
L_hw3:
    v_mov_b32 v28, 0
    s_mov_b32 s57, 0
L_hw3_chk:
    v_cmp_eq_u32 vcc, 1, v28
    s_nop 0
    s_or_b32 s5, s5, vcc_lo
    s_bitcmp1_b32 s5, 3
    s_cbranch_scc1 L_hw3_ok
    s_add_u32 s57, s57, 1
    s_cmp_gt_u32 s57, 0x40000
    s_cbranch_scc1 L_hw3_ok
    s_sleep 1
    buffer_load_dword v28, v35, s[24:27], s7 offen sc1
    s_waitcnt vmcnt(0)
    s_branch L_hw3_chk
L_hookA:
L_pad13:
    s_cbranch_execz L_pad17
    s_cmp_eq_u32 s33, 23
    s_cbranch_scc1 L_h23
    s_cmp_eq_u32 s33, 31
    s_cbranch_scc1 L_h31
    s_cmp_eq_u32 s33, 11
    s_cbranch_scc1 L_h11
L_h21:
    v_lshrrev_b32 v5, 2, v3
    v_lshl_add_u32 v5, v4, 3, v5
    v_lshlrev_b32 v5, 5, v5
    v_and_b32 v6, 3, v3
    v_lshl_add_u32 v5, v6, 3, v5
    v_lshl_add_u32 v5, v2, 12, v5
    v_add_u32 v64, 131072, v5
    v_cmp_ne_u32 vcc, 0, v26
    s_nop 0
    s_cmp_eq_u32 vcc_lo, -1
    s_cbranch_scc0 L_h21_wait
L_h21_ok:
    v_and_b32 v6, 0x7ff, v26
    v_sub_u32 v6, 2047, v6
    v_lshlrev_b32 v6, 10, v6
    v_lshl_add_u32 v6, v4, 4, v6
    s_lshl_b32 s42, s28, 8
    buffer_load_dwordx4 a[144:147], v6, s[24:27], s42 offen offset:0 sc1
    ds_read_b64_tr_b16 a[160:161], v64 offset:0
    ds_read_b64_tr_b16 a[162:163], v64 offset:128
    ds_read_b64_tr_b16 a[176:177], v64 offset:16384
    ds_read_b64_tr_b16 a[178:179], v64 offset:16512
    buffer_load_dwordx4 a[148:151], v6, s[24:27], s42 offen offset:64 sc1
    ds_read_b64_tr_b16 a[164:165], v64 offset:1024
    ds_read_b64_tr_b16 a[166:167], v64 offset:1152
    ds_read_b64_tr_b16 a[180:181], v64 offset:17408
    ds_read_b64_tr_b16 a[182:183], v64 offset:17536
    buffer_load_dwordx4 a[152:155], v6, s[24:27], s42 offen offset:128 sc1
    ds_read_b64_tr_b16 a[168:169], v64 offset:2048
    ds_read_b64_tr_b16 a[170:171], v64 offset:2176
    ds_read_b64_tr_b16 a[184:185], v64 offset:18432
    ds_read_b64_tr_b16 a[186:187], v64 offset:18560
    buffer_load_dwordx4 a[156:159], v6, s[24:27], s42 offen offset:192 sc1
    ds_read_b64_tr_b16 a[172:173], v64 offset:3072
    ds_read_b64_tr_b16 a[174:175], v64 offset:3200
    ds_read_b64_tr_b16 a[188:189], v64 offset:19456
    ds_read_b64_tr_b16 a[190:191], v64 offset:19584
    s_mov_b32 s33, 22
    s_branch L_retA
L_h21_wait:
    s_mov_b32 s57, 0
L_h21_chk:
    v_cmp_ne_u32 vcc, 0, v26
    s_nop 0
    s_cmp_eq_u32 vcc_lo, -1
    s_cbranch_scc1 L_h21_ok
    s_add_u32 s57, s57, 1
    s_cmp_gt_u32 s57, 0x40000
    s_cbranch_scc1 L_h21_ok
    s_sleep 1
    buffer_load_dword v26, v34, s[44:47], 0 offen offset:32 sc1
    s_waitcnt vmcnt(0)
    s_branch L_h21_chk
L_hookB:
    s_cmp_eq_u32 s33, 30
    s_cbranch_scc1 L_h30
    s_cmp_eq_u32 s33, 10
    s_cbranch_scc1 L_h10
L_h22:
    v_mfma_f32_16x16x32_bf16 v[40:43], a[160:163], a[144:147], 0
    s_mov_b32 s48, s82
    v_lshlrev_b32 v6, 4, v1
    v_mfma_f32_16x16x32_bf16 v[40:43], a[164:167], a[148:151], v[40:43]
    s_mov_b32 s49, s83
    v_lshl_add_u32 v5, v2, 12, v6
    v_mfma_f32_16x16x32_bf16 v[40:43], a[168:171], a[152:155], v[40:43]
    s_lshl_b32 s42, s4, 14
    v_add_u32 v5, 131072, v5
    v_and_b32 v64, 1, v2
    v_mfma_f32_16x16x32_bf16 v[40:43], a[172:175], a[156:159], v[40:43]
    s_add_u32 m0, s31, 147456
    v_lshlrev_b32 v64, 7, v64
    v_xor_b32 v64, v64, v6
    v_mfma_f32_16x16x32_bf16 v[44:47], a[176:179], a[144:147], 0
    s_add_u32 s42, s42, s31
    v_xor_b32 v65, 32, v64
    v_xor_b32 v66, 64, v64
    v_mfma_f32_16x16x32_bf16 v[44:47], a[180:183], a[148:151], v[44:47]
    v_xor_b32 v67, 0x60, v64
    v_mfma_f32_16x16x32_bf16 v[44:47], a[184:187], a[152:155], v[44:47]
    v_mfma_f32_16x16x32_bf16 v[44:47], a[188:191], a[156:159], v[44:47]
    buffer_load_dwordx4 v64, s[48:51], s42 offen offset:0 lds
    buffer_load_dwordx4 v65, s[48:51], s42 offen offset:1024 lds
    buffer_load_dwordx4 v66, s[48:51], s42 offen offset:2048 lds
    buffer_load_dwordx4 v67, s[48:51], s42 offen offset:3072 lds
    ds_write_b128 v5, v[40:43]
    s_nop 2
    ds_write_b128 v5, v[44:47] offset:1024
    s_mov_b32 s33, 23
    s_branch L_loop
L_h23:
    v_lshlrev_b32 v6, 4, v1
    v_add_u32 v5, 131072, v6
    ds_read_b128 v[64:67], v5 offset:0
    ds_read_b128 v[68:71], v5 offset:1024
    ds_read_b128 v[72:75], v5 offset:4096
    ds_read_b128 v[76:79], v5 offset:5120
    ds_read_b128 v[80:83], v5 offset:8192
    ds_read_b128 v[84:87], v5 offset:9216
    ds_read_b128 v[88:91], v5 offset:12288
    ds_read_b128 v[92:95], v5 offset:13312
    v_lshrrev_b32 v5, 2, v1
    v_and_b32 v40, 7, v5
    v_lshlrev_b32 v5, 10, v5
    v_lshl_add_u32 v5, v40, 5, v5
    v_and_b32 v40, 3, v1
    v_lshl_add_u32 v5, v40, 3, v5
    v_lshl_add_u32 v5, v2, 8, v5
    v_add_u32 v40, 147456, v5
    v_xor_b32 v41, 32, v40
    v_xor_b32 v42, 64, v40
    v_xor_b32 v43, 96, v40
    v_xor_b32 v44, 128, v40
    v_xor_b32 v45, 160, v40
    v_xor_b32 v46, 192, v40
    v_xor_b32 v47, 224, v40
    ds_read_b64_tr_b16 a[144:145], v40
    ds_read_b64_tr_b16 a[146:147], v41
    ds_read_b64_tr_b16 a[148:149], v42
    ds_read_b64_tr_b16 a[150:151], v43
    ds_read_b64_tr_b16 a[152:153], v44
    ds_read_b64_tr_b16 a[154:155], v45
    ds_read_b64_tr_b16 a[156:157], v46
    ds_read_b64_tr_b16 a[158:159], v47
    s_mov_b32 vcc_lo, 0xff00ff00
    s_mov_b32 vcc_hi, 0xff00ff00
    s_waitcnt lgkmcnt(8)
    v_pk_add_f32 v[64:65], v[64:65], v[72:73]
    v_pk_add_f32 v[80:81], v[80:81], v[88:89]
    v_pk_add_f32 v[66:67], v[66:67], v[74:75]
    v_pk_add_f32 v[82:83], v[82:83], v[90:91]
    v_pk_add_f32 v[68:69], v[68:69], v[76:77]
    v_pk_add_f32 v[84:85], v[84:85], v[92:93]
    v_pk_add_f32 v[70:71], v[70:71], v[78:79]
    v_pk_add_f32 v[86:87], v[86:87], v[94:95]
    v_pk_add_f32 v[64:65], v[64:65], v[80:81]
    v_pk_add_f32 v[66:67], v[66:67], v[82:83]
    v_pk_add_f32 v[68:69], v[68:69], v[84:85]
    v_pk_add_f32 v[70:71], v[70:71], v[86:87]
    v_cvt_pk_bf16_f32 v72, v64, v65
    v_cvt_pk_bf16_f32 v73, v66, v67
    v_cvt_pk_bf16_f32 v74, v68, v69
    v_cvt_pk_bf16_f32 v75, v70, v71
    v_lshlrev_b32 v64, 16, v72
    v_and_b32 v65, 0xffff0000, v72
    v_lshlrev_b32 v66, 16, v73
    v_and_b32 v67, 0xffff0000, v73
    v_lshlrev_b32 v68, 16, v74
    v_and_b32 v69, 0xffff0000, v74
    v_lshlrev_b32 v70, 16, v75
    v_and_b32 v71, 0xffff0000, v75
    v_mul_f32 v72, 0xbfb8aa3b, v64
    v_mul_f32 v73, 0xbfb8aa3b, v65
    v_mul_f32 v74, 0xbfb8aa3b, v66
    v_mul_f32 v75, 0xbfb8aa3b, v67
    v_exp_f32 v72, v72
    v_exp_f32 v73, v73
    v_exp_f32 v74, v74
    v_exp_f32 v75, v75
    v_add_f32 v72, 1.0, v72
    v_add_f32 v73, 1.0, v73
    v_add_f32 v74, 1.0, v74
    v_add_f32 v75, 1.0, v75
    v_rcp_f32 v72, v72
    v_rcp_f32 v73, v73
    v_rcp_f32 v74, v74
    v_rcp_f32 v75, v75
    v_mul_f32 v64, v64, v72
    v_mul_f32 v65, v65, v73
    v_mul_f32 v66, v66, v74
    v_mul_f32 v67, v67, v75
    v_cvt_pk_bf16_f32 v72, v64, v65
    v_cvt_pk_bf16_f32 v73, v66, v67
    v_lshlrev_b32 v64, 16, v72
    v_and_b32 v65, 0xffff0000, v72
    v_lshlrev_b32 v66, 16, v73
    v_and_b32 v67, 0xffff0000, v73
    v_mul_f32 v64, v64, v68
    v_mul_f32 v65, v65, v69
    v_mul_f32 v66, v66, v70
    v_mul_f32 v67, v67, v71
    v_cvt_pk_bf16_f32 v72, v64, v65
    v_cvt_pk_bf16_f32 v73, v66, v67
    s_waitcnt lgkmcnt(0)
    v_cndmask_b32 v40, v72, 0, vcc
    v_cndmask_b32 v41, v73, 0, vcc
    v_cndmask_b32 v42, 0, v72, vcc
    v_cndmask_b32 v43, 0, v73, vcc
    s_nop 1
    v_mfma_f32_16x16x32_bf16 v[64:67], a[144:147], v[40:43], 0
    v_mfma_f32_16x16x32_bf16 v[68:71], a[148:151], v[40:43], 0
    v_mfma_f32_16x16x32_bf16 v[72:75], a[152:155], v[40:43], 0
    v_mfma_f32_16x16x32_bf16 v[76:79], a[156:159], v[40:43], 0
    s_nop 4
    buffer_store_dwordx4 v[64:67], v6, s[24:27], s71 offen offset:0 sc1
    buffer_store_dwordx4 v[68:71], v6, s[24:27], s71 offen offset:1024 sc1
    buffer_store_dwordx4 v[72:75], v6, s[24:27], s71 offen offset:2048 sc1
    buffer_store_dwordx4 v[76:79], v6, s[24:27], s71 offen offset:3072 sc1
    s_mov_b32 s33, 0
    s_branch L_retA
L_h30:
L_pad14:
    s_cbranch_execz L_pad18
    v_cmp_ne_u32 vcc, 0, v26
    s_nop 0
    s_cmp_eq_u32 vcc_lo, -1
    s_cbranch_scc0 L_h30_wait
L_h30_ok:
    s_lshl_b32 s43, s4, 2
    s_add_u32 s43, s43, s28
    s_lshl_b32 s42, s43, 6
    s_add_u32 s42, s42, 3145728
    v_and_b32 v6, 3, v1
    v_lshrrev_b32 v40, 2, v1
    v_mul_u32_u24 v40, 114688, v40
    v_lshl_add_u32 v40, v6, 4, v40
    s_mov_b32 s3, s42
    buffer_load_dwordx4 a[144:147], v40, s[24:27], s3 offen sc1
    s_add_u32 s3, s3, 16384
    buffer_load_dwordx4 a[148:151], v40, s[24:27], s3 offen sc1
    s_add_u32 s3, s3, 16384
    buffer_load_dwordx4 a[152:155], v40, s[24:27], s3 offen sc1
    s_add_u32 s3, s3, 16384
    buffer_load_dwordx4 a[156:159], v40, s[24:27], s3 offen sc1
    s_add_u32 s3, s3, 16384
    buffer_load_dwordx4 a[160:163], v40, s[24:27], s3 offen sc1
    s_add_u32 s3, s3, 16384
    buffer_load_dwordx4 a[164:167], v40, s[24:27], s3 offen sc1
    s_add_u32 s3, s3, 16384
    buffer_load_dwordx4 a[168:171], v40, s[24:27], s3 offen sc1
    s_mov_b32 s33, 31
    s_branch L_loop
L_h30_wait:
    s_mov_b32 s57, 0
L_h30_chk:
    v_cmp_ne_u32 vcc, 0, v26
    s_nop 0
    s_cmp_eq_u32 vcc_lo, -1
    s_cbranch_scc1 L_h30_ok
    s_add_u32 s57, s57, 1
    s_cmp_gt_u32 s57, 0x40000
    s_cbranch_scc1 L_h30_ok
    s_sleep 1
    buffer_load_dword v26, v34, s[44:47], 0 offen offset:32 sc1
    s_waitcnt vmcnt(0)
    s_branch L_h30_chk
L_h31_wait:
    s_lshl_b32 s43, s4, 2
    s_add_u32 s43, s43, s28
    s_lshl_b32 s42, s43, 6
    s_add_u32 s42, s42, 3145728
    v_and_b32 v6, 3, v1
    v_lshrrev_b32 v40, 2, v1
    v_mul_u32_u24 v40, 114688, v40
    v_lshl_add_u32 v40, v6, 4, v40
    s_mov_b32 s57, 0
L_h31_chk:
    v_accvgpr_read_b32 v64, a144
    v_accvgpr_read_b32 v65, a145
    v_accvgpr_read_b32 v66, a146
    v_accvgpr_read_b32 v67, a147
    v_accvgpr_read_b32 v68, a148
    v_accvgpr_read_b32 v69, a149
    v_accvgpr_read_b32 v70, a150
    v_accvgpr_read_b32 v71, a151
    v_accvgpr_read_b32 v72, a152
    v_accvgpr_read_b32 v73, a153
    v_accvgpr_read_b32 v74, a154
    v_accvgpr_read_b32 v75, a155
    v_accvgpr_read_b32 v76, a156
    v_accvgpr_read_b32 v77, a157
    v_accvgpr_read_b32 v78, a158
    v_accvgpr_read_b32 v79, a159
    v_accvgpr_read_b32 v80, a160
    v_accvgpr_read_b32 v81, a161
    v_accvgpr_read_b32 v82, a162
    v_accvgpr_read_b32 v83, a163
    v_accvgpr_read_b32 v84, a164
    v_accvgpr_read_b32 v85, a165
    v_accvgpr_read_b32 v86, a166
    v_accvgpr_read_b32 v87, a167
    v_accvgpr_read_b32 v88, a168
    v_accvgpr_read_b32 v89, a169
    v_accvgpr_read_b32 v90, a170
    v_accvgpr_read_b32 v91, a171
    v_max_u32 v92, v64, v65
    v_max3_u32 v92, v92, v66, v67
    v_max3_u32 v92, v92, v68, v69
    v_max3_u32 v92, v92, v70, v71
    v_max3_u32 v92, v92, v72, v73
    v_max3_u32 v92, v92, v74, v75
    v_max3_u32 v92, v92, v76, v77
    v_max3_u32 v92, v92, v78, v79
    v_max3_u32 v92, v92, v80, v81
    v_max3_u32 v92, v92, v82, v83
    v_max3_u32 v92, v92, v84, v85
    v_max3_u32 v92, v92, v86, v87
    v_max3_u32 v92, v92, v88, v89
    v_max3_u32 v92, v92, v90, v91
    v_cmp_ne_u32 vcc, -1, v92
    s_nop 0
    s_cmp_eq_u64 vcc, -1
    s_cbranch_scc1 L_h31_ok
    s_add_u32 s57, s57, 1
    s_cmp_gt_u32 s57, 0x40000
    s_cbranch_scc1 L_h31_ok
    s_sleep 1
    s_mov_b32 s3, s42
    buffer_load_dwordx4 a[144:147], v40, s[24:27], s3 offen sc1
    s_add_u32 s3, s3, 16384
    buffer_load_dwordx4 a[148:151], v40, s[24:27], s3 offen sc1
    s_add_u32 s3, s3, 16384
    buffer_load_dwordx4 a[152:155], v40, s[24:27], s3 offen sc1
    s_add_u32 s3, s3, 16384
    buffer_load_dwordx4 a[156:159], v40, s[24:27], s3 offen sc1
    s_add_u32 s3, s3, 16384
    buffer_load_dwordx4 a[160:163], v40, s[24:27], s3 offen sc1
    s_add_u32 s3, s3, 16384
    buffer_load_dwordx4 a[164:167], v40, s[24:27], s3 offen sc1
    s_add_u32 s3, s3, 16384
    buffer_load_dwordx4 a[168:171], v40, s[24:27], s3 offen sc1
    s_waitcnt vmcnt(0)
    s_branch L_h31_chk
L_h31:
L_pad15:
    s_cbranch_execz L_pad19
    v_accvgpr_read_b32 v64, a144
    v_accvgpr_read_b32 v65, a145
    v_accvgpr_read_b32 v66, a146
    v_accvgpr_read_b32 v67, a147
    v_accvgpr_read_b32 v68, a148
    v_accvgpr_read_b32 v69, a149
    v_accvgpr_read_b32 v70, a150
    v_accvgpr_read_b32 v71, a151
    v_accvgpr_read_b32 v72, a152
    v_accvgpr_read_b32 v73, a153
    v_accvgpr_read_b32 v74, a154
    v_accvgpr_read_b32 v75, a155
    v_accvgpr_read_b32 v76, a156
    v_accvgpr_read_b32 v77, a157
    v_accvgpr_read_b32 v78, a158
    v_accvgpr_read_b32 v79, a159
    v_accvgpr_read_b32 v80, a160
    v_accvgpr_read_b32 v81, a161
    v_accvgpr_read_b32 v82, a162
    v_accvgpr_read_b32 v83, a163
    v_accvgpr_read_b32 v84, a164
    v_accvgpr_read_b32 v85, a165
    v_accvgpr_read_b32 v86, a166
    v_accvgpr_read_b32 v87, a167
    v_accvgpr_read_b32 v88, a168
    v_accvgpr_read_b32 v89, a169
    v_accvgpr_read_b32 v90, a170
    v_accvgpr_read_b32 v91, a171
    v_max_u32 v92, v64, v65
    v_max3_u32 v92, v92, v66, v67
    v_max3_u32 v92, v92, v68, v69
    v_max3_u32 v92, v92, v70, v71
    v_max3_u32 v92, v92, v72, v73
    v_max3_u32 v92, v92, v74, v75
    v_max3_u32 v92, v92, v76, v77
    v_max3_u32 v92, v92, v78, v79
    v_max3_u32 v92, v92, v80, v81
    v_max3_u32 v92, v92, v82, v83
    v_max3_u32 v92, v92, v84, v85
    v_max3_u32 v92, v92, v86, v87
    v_max3_u32 v92, v92, v88, v89
    v_max3_u32 v92, v92, v90, v91
    v_cmp_ne_u32 vcc, -1, v92
    s_nop 0
    s_cmp_eq_u64 vcc, -1
    s_cbranch_scc0 L_h31_wait
L_h31_ok:
    v_pk_add_f32 v[64:65], v[64:65], v[68:69]
    v_pk_add_f32 v[66:67], v[66:67], v[70:71]
    v_pk_add_f32 v[64:65], v[64:65], v[72:73]
    v_pk_add_f32 v[66:67], v[66:67], v[74:75]
    v_pk_add_f32 v[64:65], v[64:65], v[76:77]
    v_pk_add_f32 v[66:67], v[66:67], v[78:79]
    v_pk_add_f32 v[64:65], v[64:65], v[80:81]
    v_pk_add_f32 v[66:67], v[66:67], v[82:83]
    v_pk_add_f32 v[64:65], v[64:65], v[84:85]
    v_pk_add_f32 v[66:67], v[66:67], v[86:87]
    v_pk_add_f32 v[64:65], v[64:65], v[88:89]
    v_pk_add_f32 v[66:67], v[66:67], v[90:91]
    v_ashrrev_i32 v84, 31, v26
    v_not_b32 v84, v84
    v_add_f32_dpp v64, v64, v64 row_ror:4 row_mask:0xf bank_mask:0xf
    v_add_f32_dpp v65, v65, v65 row_ror:4 row_mask:0xf bank_mask:0xf
    v_add_f32_dpp v66, v66, v66 row_ror:4 row_mask:0xf bank_mask:0xf
    v_add_f32_dpp v67, v67, v67 row_ror:4 row_mask:0xf bank_mask:0xf
    v_add_f32_dpp v64, v64, v64 row_ror:8 row_mask:0xf bank_mask:0xf
    v_add_f32_dpp v65, v65, v65 row_ror:8 row_mask:0xf bank_mask:0xf
    v_add_f32_dpp v66, v66, v66 row_ror:8 row_mask:0xf bank_mask:0xf
    v_add_f32_dpp v67, v67, v67 row_ror:8 row_mask:0xf bank_mask:0xf
    v_mov_b32 v68, v64
    v_mov_b32 v69, v65
    v_mov_b32 v70, v66
    v_mov_b32 v71, v67
    v_permlane16_swap_b32 v64, v68
    v_permlane16_swap_b32 v65, v69
    v_permlane16_swap_b32 v66, v70
    v_permlane16_swap_b32 v67, v71
    v_add_f32 v64, v64, v68
    v_add_f32 v65, v65, v69
    v_add_f32 v66, v66, v70
    v_add_f32 v67, v67, v71
    v_mov_b32 v68, v64
    v_mov_b32 v69, v65
    v_mov_b32 v70, v66
    v_mov_b32 v71, v67
    v_permlane32_swap_b32 v64, v68
    v_permlane32_swap_b32 v65, v69
    v_permlane32_swap_b32 v66, v70
    v_permlane32_swap_b32 v67, v71
    v_add_f32 v64, v64, v68
    v_add_f32 v65, v65, v69
    v_add_f32 v66, v66, v70
    v_add_f32 v67, v67, v71
    v_or_b32 v84, 0x80000000, v84
    v_xor_b32 v6, v26, v84
    v_and_b32 v6, 0xffff0000, v6
    v_mul_f32 v84, 0xbfb8aa3b, v6
    v_exp_f32 v84, v84
    s_nop 0
    v_add_f32 v84, 1.0, v84
    v_rcp_f32 v84, v84
    s_nop 0
    v_cvt_pk_bf16_f32 v84, v84, v84
    v_and_b32 v84, 0xffff0000, v84
    s_lshl_b32 s43, s4, 2
    s_add_u32 s43, s43, s28
    s_lshr_b32 s42, s43, 4
    s_lshl_b32 s42, s42, 6
    s_bfe_u32 s3, s43, 0x10001
    s_lshl_b32 s3, s3, 5
    s_add_u32 s42, s42, s3
    s_bfe_u32 s3, s43, 0x20002
    s_lshl_b32 s3, s3, 3
    s_add_u32 s42, s42, s3
    s_add_u32 s42, s42, 2113536
    s_and_b32 s3, s43, 1
    v_lshrrev_b32 v5, 2, v1
    v_cmp_eq_u32 vcc, s3, v5
    v_lshlrev_b32 v5, 10, v1
    v_mov_b32 v6, 1073741824
    v_cndmask_b32 v5, v6, v5, vcc
    v_cvt_pk_bf16_f32 v68, v64, v65
    v_cvt_pk_bf16_f32 v69, v66, v67
    v_lshlrev_b32 v64, 16, v68
    v_and_b32 v65, 0xffff0000, v68
    v_lshlrev_b32 v66, 16, v69
    v_and_b32 v67, 0xffff0000, v69
    v_mul_f32 v64, v64, v84
    v_mul_f32 v65, v65, v84
    v_mul_f32 v66, v66, v84
    v_mul_f32 v67, v67, v84
    v_cvt_pk_bf16_f32 v68, v64, v65
    v_cvt_pk_bf16_f32 v69, v66, v67
    buffer_store_dwordx2 v[68:69], v5, s[24:27], s42 offen sc1
    s_mov_b32 s33, 0
    s_branch L_retA
L_h10:
    v_lshlrev_b32 v5, 5, v0
    s_mov_b32 s42, 2097152
    buffer_load_dwordx4 a[144:147], v5, s[24:27], s42 offen sc1
    buffer_load_dwordx4 a[148:151], v5, s[24:27], s42 offen offset:16 sc1
    s_mov_b32 s33, 11
    s_branch L_loop
L_h11:
    v_lshlrev_b32 v5, 5, v0
    s_mov_b32 s42, 2097152
    s_mov_b32 s57, 0
L_h11_chk:
    v_accvgpr_read_b32 v64, a144
    v_accvgpr_read_b32 v65, a145
    v_accvgpr_read_b32 v66, a146
    v_accvgpr_read_b32 v67, a147
    v_accvgpr_read_b32 v68, a148
    v_accvgpr_read_b32 v69, a149
    v_accvgpr_read_b32 v70, a150
    v_accvgpr_read_b32 v71, a151
    v_min3_u32 v72, v64, v65, v66
    v_min3_u32 v72, v72, v67, v68
    v_min3_u32 v72, v72, v69, v70
    v_min_u32 v72, v72, v71
    v_cmp_ne_u32 vcc, 0, v72
    s_nop 0
    s_cmp_eq_u64 vcc, -1
    s_cbranch_scc1 L_h11_ok
    s_add_u32 s57, s57, 1
    s_cmp_gt_u32 s57, 0x40000
    s_cbranch_scc1 L_h11_ok
    s_sleep 1
    buffer_load_dwordx4 a[144:147], v5, s[24:27], s42 offen sc1
    buffer_load_dwordx4 a[148:151], v5, s[24:27], s42 offen offset:16 sc1
    s_waitcnt vmcnt(0)
    s_branch L_h11_chk
L_h11_ok:
    v_mov_b32 v74, 0
    v_max3_u32 v72, v64, v65, v66
    v_max3_u32 v72, v72, v67, v68
    v_max3_u32 v72, v72, v69, v70
    v_max_u32 v72, v72, v71
    s_nop 1
    v_max_u32_dpp v72, v72, v72 quad_perm:[1,0,3,2] row_mask:0xf bank_mask:0xf
    s_nop 1
    v_max_u32_dpp v72, v72, v72 quad_perm:[2,3,0,1] row_mask:0xf bank_mask:0xf
    s_nop 1
    v_max_u32_dpp v72, v72, v72 row_half_mirror row_mask:0xf bank_mask:0xf
    s_nop 1
    v_max_u32_dpp v72, v72, v72 row_mirror row_mask:0xf bank_mask:0xf
    v_mov_b32 v73, v72
    s_nop 1
    v_permlane16_swap_b32 v72, v73
    v_max_u32 v72, v72, v73
    v_mov_b32 v73, v72
    s_nop 1
    v_permlane32_swap_b32 v72, v73
    v_max_u32 v72, v72, v73
    v_cmp_ne_u32 s[92:93], v64, v72
    v_cmp_ne_u32 s[94:95], v65, v72
    v_cmp_ne_u32 s[96:97], v66, v72
    v_cmp_ne_u32 s[98:99], v67, v72
    v_cndmask_b32 v64, 0, v64, s[92:93]
    v_cndmask_b32 v65, 0, v65, s[94:95]
    v_cndmask_b32 v66, 0, v66, s[96:97]
    v_cndmask_b32 v67, 0, v67, s[98:99]
    v_cmp_ne_u32 s[92:93], v68, v72
    v_cmp_ne_u32 s[94:95], v69, v72
    v_cmp_ne_u32 s[96:97], v70, v72
    v_cmp_ne_u32 s[98:99], v71, v72
    v_cndmask_b32 v68, 0, v68, s[92:93]
    v_cndmask_b32 v69, 0, v69, s[94:95]
    v_cndmask_b32 v70, 0, v70, s[96:97]
    v_cndmask_b32 v71, 0, v71, s[98:99]
    v_cmp_eq_u32 vcc, 0, v1
    s_nop 1
    v_cndmask_b32 v74, v74, v72, vcc
    v_max3_u32 v72, v64, v65, v66
    v_max3_u32 v72, v72, v67, v68
    v_max3_u32 v72, v72, v69, v70
    v_max_u32 v72, v72, v71
    s_nop 1
    v_max_u32_dpp v72, v72, v72 quad_perm:[1,0,3,2] row_mask:0xf bank_mask:0xf
    s_nop 1
    v_max_u32_dpp v72, v72, v72 quad_perm:[2,3,0,1] row_mask:0xf bank_mask:0xf
    s_nop 1
    v_max_u32_dpp v72, v72, v72 row_half_mirror row_mask:0xf bank_mask:0xf
    s_nop 1
    v_max_u32_dpp v72, v72, v72 row_mirror row_mask:0xf bank_mask:0xf
    v_mov_b32 v73, v72
    s_nop 1
    v_permlane16_swap_b32 v72, v73
    v_max_u32 v72, v72, v73
    v_mov_b32 v73, v72
    s_nop 1
    v_permlane32_swap_b32 v72, v73
    v_max_u32 v72, v72, v73
    v_cmp_ne_u32 s[92:93], v64, v72
    v_cmp_ne_u32 s[94:95], v65, v72
    v_cmp_ne_u32 s[96:97], v66, v72
    v_cmp_ne_u32 s[98:99], v67, v72
    v_cndmask_b32 v64, 0, v64, s[92:93]
    v_cndmask_b32 v65, 0, v65, s[94:95]
    v_cndmask_b32 v66, 0, v66, s[96:97]
    v_cndmask_b32 v67, 0, v67, s[98:99]
    v_cmp_ne_u32 s[92:93], v68, v72
    v_cmp_ne_u32 s[94:95], v69, v72
    v_cmp_ne_u32 s[96:97], v70, v72
    v_cmp_ne_u32 s[98:99], v71, v72
    v_cndmask_b32 v68, 0, v68, s[92:93]
    v_cndmask_b32 v69, 0, v69, s[94:95]
    v_cndmask_b32 v70, 0, v70, s[96:97]
    v_cndmask_b32 v71, 0, v71, s[98:99]
    v_cmp_eq_u32 vcc, 1, v1
    s_nop 1
    v_cndmask_b32 v74, v74, v72, vcc
    v_max3_u32 v72, v64, v65, v66
    v_max3_u32 v72, v72, v67, v68
    v_max3_u32 v72, v72, v69, v70
    v_max_u32 v72, v72, v71
    s_nop 1
    v_max_u32_dpp v72, v72, v72 quad_perm:[1,0,3,2] row_mask:0xf bank_mask:0xf
    s_nop 1
    v_max_u32_dpp v72, v72, v72 quad_perm:[2,3,0,1] row_mask:0xf bank_mask:0xf
    s_nop 1
    v_max_u32_dpp v72, v72, v72 row_half_mirror row_mask:0xf bank_mask:0xf
    s_nop 1
    v_max_u32_dpp v72, v72, v72 row_mirror row_mask:0xf bank_mask:0xf
    v_mov_b32 v73, v72
    s_nop 1
    v_permlane16_swap_b32 v72, v73
    v_max_u32 v72, v72, v73
    v_mov_b32 v73, v72
    s_nop 1
    v_permlane32_swap_b32 v72, v73
    v_max_u32 v72, v72, v73
    v_cmp_ne_u32 s[92:93], v64, v72
    v_cmp_ne_u32 s[94:95], v65, v72
    v_cmp_ne_u32 s[96:97], v66, v72
    v_cmp_ne_u32 s[98:99], v67, v72
    v_cndmask_b32 v64, 0, v64, s[92:93]
    v_cndmask_b32 v65, 0, v65, s[94:95]
    v_cndmask_b32 v66, 0, v66, s[96:97]
    v_cndmask_b32 v67, 0, v67, s[98:99]
    v_cmp_ne_u32 s[92:93], v68, v72
    v_cmp_ne_u32 s[94:95], v69, v72
    v_cmp_ne_u32 s[96:97], v70, v72
    v_cmp_ne_u32 s[98:99], v71, v72
    v_cndmask_b32 v68, 0, v68, s[92:93]
    v_cndmask_b32 v69, 0, v69, s[94:95]
    v_cndmask_b32 v70, 0, v70, s[96:97]
    v_cndmask_b32 v71, 0, v71, s[98:99]
    v_cmp_eq_u32 vcc, 2, v1
    s_nop 1
    v_cndmask_b32 v74, v74, v72, vcc
    v_max3_u32 v72, v64, v65, v66
    v_max3_u32 v72, v72, v67, v68
    v_max3_u32 v72, v72, v69, v70
    v_max_u32 v72, v72, v71
    s_nop 1
    v_max_u32_dpp v72, v72, v72 quad_perm:[1,0,3,2] row_mask:0xf bank_mask:0xf
    s_nop 1
    v_max_u32_dpp v72, v72, v72 quad_perm:[2,3,0,1] row_mask:0xf bank_mask:0xf
    s_nop 1
    v_max_u32_dpp v72, v72, v72 row_half_mirror row_mask:0xf bank_mask:0xf
    s_nop 1
    v_max_u32_dpp v72, v72, v72 row_mirror row_mask:0xf bank_mask:0xf
    v_mov_b32 v73, v72
    s_nop 1
    v_permlane16_swap_b32 v72, v73
    v_max_u32 v72, v72, v73
    v_mov_b32 v73, v72
    s_nop 1
    v_permlane32_swap_b32 v72, v73
    v_max_u32 v72, v72, v73
    v_cmp_ne_u32 s[92:93], v64, v72
    v_cmp_ne_u32 s[94:95], v65, v72
    v_cmp_ne_u32 s[96:97], v66, v72
    v_cmp_ne_u32 s[98:99], v67, v72
    v_cndmask_b32 v64, 0, v64, s[92:93]
    v_cndmask_b32 v65, 0, v65, s[94:95]
    v_cndmask_b32 v66, 0, v66, s[96:97]
    v_cndmask_b32 v67, 0, v67, s[98:99]
    v_cmp_ne_u32 s[92:93], v68, v72
    v_cmp_ne_u32 s[94:95], v69, v72
    v_cmp_ne_u32 s[96:97], v70, v72
    v_cmp_ne_u32 s[98:99], v71, v72
    v_cndmask_b32 v68, 0, v68, s[92:93]
    v_cndmask_b32 v69, 0, v69, s[94:95]
    v_cndmask_b32 v70, 0, v70, s[96:97]
    v_cndmask_b32 v71, 0, v71, s[98:99]
    v_cmp_eq_u32 vcc, 3, v1
    s_nop 1
    v_cndmask_b32 v74, v74, v72, vcc
    v_max3_u32 v72, v64, v65, v66
    v_max3_u32 v72, v72, v67, v68
    v_max3_u32 v72, v72, v69, v70
    v_max_u32 v72, v72, v71
    s_nop 1
    v_max_u32_dpp v72, v72, v72 quad_perm:[1,0,3,2] row_mask:0xf bank_mask:0xf
    s_nop 1
    v_max_u32_dpp v72, v72, v72 quad_perm:[2,3,0,1] row_mask:0xf bank_mask:0xf
    s_nop 1
    v_max_u32_dpp v72, v72, v72 row_half_mirror row_mask:0xf bank_mask:0xf
    s_nop 1
    v_max_u32_dpp v72, v72, v72 row_mirror row_mask:0xf bank_mask:0xf
    v_mov_b32 v73, v72
    s_nop 1
    v_permlane16_swap_b32 v72, v73
    v_max_u32 v72, v72, v73
    v_mov_b32 v73, v72
    s_nop 1
    v_permlane32_swap_b32 v72, v73
    v_max_u32 v72, v72, v73
    v_cmp_ne_u32 s[92:93], v64, v72
    v_cmp_ne_u32 s[94:95], v65, v72
    v_cmp_ne_u32 s[96:97], v66, v72
    v_cmp_ne_u32 s[98:99], v67, v72
    v_cndmask_b32 v64, 0, v64, s[92:93]
    v_cndmask_b32 v65, 0, v65, s[94:95]
    v_cndmask_b32 v66, 0, v66, s[96:97]
    v_cndmask_b32 v67, 0, v67, s[98:99]
    v_cmp_ne_u32 s[92:93], v68, v72
    v_cmp_ne_u32 s[94:95], v69, v72
    v_cmp_ne_u32 s[96:97], v70, v72
    v_cmp_ne_u32 s[98:99], v71, v72
    v_cndmask_b32 v68, 0, v68, s[92:93]
    v_cndmask_b32 v69, 0, v69, s[94:95]
    v_cndmask_b32 v70, 0, v70, s[96:97]
    v_cndmask_b32 v71, 0, v71, s[98:99]
    v_cmp_eq_u32 vcc, 4, v1
    s_nop 1
    v_cndmask_b32 v74, v74, v72, vcc
    v_max3_u32 v72, v64, v65, v66
    v_max3_u32 v72, v72, v67, v68
    v_max3_u32 v72, v72, v69, v70
    v_max_u32 v72, v72, v71
    s_nop 1
    v_max_u32_dpp v72, v72, v72 quad_perm:[1,0,3,2] row_mask:0xf bank_mask:0xf
    s_nop 1
    v_max_u32_dpp v72, v72, v72 quad_perm:[2,3,0,1] row_mask:0xf bank_mask:0xf
    s_nop 1
    v_max_u32_dpp v72, v72, v72 row_half_mirror row_mask:0xf bank_mask:0xf
    s_nop 1
    v_max_u32_dpp v72, v72, v72 row_mirror row_mask:0xf bank_mask:0xf
    v_mov_b32 v73, v72
    s_nop 1
    v_permlane16_swap_b32 v72, v73
    v_max_u32 v72, v72, v73
    v_mov_b32 v73, v72
    s_nop 1
    v_permlane32_swap_b32 v72, v73
    v_max_u32 v72, v72, v73
    v_cmp_ne_u32 s[92:93], v64, v72
    v_cmp_ne_u32 s[94:95], v65, v72
    v_cmp_ne_u32 s[96:97], v66, v72
    v_cmp_ne_u32 s[98:99], v67, v72
    v_cndmask_b32 v64, 0, v64, s[92:93]
    v_cndmask_b32 v65, 0, v65, s[94:95]
    v_cndmask_b32 v66, 0, v66, s[96:97]
    v_cndmask_b32 v67, 0, v67, s[98:99]
    v_cmp_ne_u32 s[92:93], v68, v72
    v_cmp_ne_u32 s[94:95], v69, v72
    v_cmp_ne_u32 s[96:97], v70, v72
    v_cmp_ne_u32 s[98:99], v71, v72
    v_cndmask_b32 v68, 0, v68, s[92:93]
    v_cndmask_b32 v69, 0, v69, s[94:95]
    v_cndmask_b32 v70, 0, v70, s[96:97]
    v_cndmask_b32 v71, 0, v71, s[98:99]
    v_cmp_eq_u32 vcc, 5, v1
    s_nop 1
    v_cndmask_b32 v74, v74, v72, vcc
    v_max3_u32 v72, v64, v65, v66
    v_max3_u32 v72, v72, v67, v68
    v_max3_u32 v72, v72, v69, v70
    v_max_u32 v72, v72, v71
    s_nop 1
    v_max_u32_dpp v72, v72, v72 quad_perm:[1,0,3,2] row_mask:0xf bank_mask:0xf
    s_nop 1
    v_max_u32_dpp v72, v72, v72 quad_perm:[2,3,0,1] row_mask:0xf bank_mask:0xf
    s_nop 1
    v_max_u32_dpp v72, v72, v72 row_half_mirror row_mask:0xf bank_mask:0xf
    s_nop 1
    v_max_u32_dpp v72, v72, v72 row_mirror row_mask:0xf bank_mask:0xf
    v_mov_b32 v73, v72
    s_nop 1
    v_permlane16_swap_b32 v72, v73
    v_max_u32 v72, v72, v73
    v_mov_b32 v73, v72
    s_nop 1
    v_permlane32_swap_b32 v72, v73
    v_max_u32 v72, v72, v73
    v_cmp_ne_u32 s[92:93], v64, v72
    v_cmp_ne_u32 s[94:95], v65, v72
    v_cmp_ne_u32 s[96:97], v66, v72
    v_cmp_ne_u32 s[98:99], v67, v72
    v_cndmask_b32 v64, 0, v64, s[92:93]
    v_cndmask_b32 v65, 0, v65, s[94:95]
    v_cndmask_b32 v66, 0, v66, s[96:97]
    v_cndmask_b32 v67, 0, v67, s[98:99]
    v_cmp_ne_u32 s[92:93], v68, v72
    v_cmp_ne_u32 s[94:95], v69, v72
    v_cmp_ne_u32 s[96:97], v70, v72
    v_cmp_ne_u32 s[98:99], v71, v72
    v_cndmask_b32 v68, 0, v68, s[92:93]
    v_cndmask_b32 v69, 0, v69, s[94:95]
    v_cndmask_b32 v70, 0, v70, s[96:97]
    v_cndmask_b32 v71, 0, v71, s[98:99]
    v_cmp_eq_u32 vcc, 6, v1
    s_nop 1
    v_cndmask_b32 v74, v74, v72, vcc
    v_max3_u32 v72, v64, v65, v66
    v_max3_u32 v72, v72, v67, v68
    v_max3_u32 v72, v72, v69, v70
    v_max_u32 v72, v72, v71
    s_nop 1
    v_max_u32_dpp v72, v72, v72 quad_perm:[1,0,3,2] row_mask:0xf bank_mask:0xf
    s_nop 1
    v_max_u32_dpp v72, v72, v72 quad_perm:[2,3,0,1] row_mask:0xf bank_mask:0xf
    s_nop 1
    v_max_u32_dpp v72, v72, v72 row_half_mirror row_mask:0xf bank_mask:0xf
    s_nop 1
    v_max_u32_dpp v72, v72, v72 row_mirror row_mask:0xf bank_mask:0xf
    v_mov_b32 v73, v72
    s_nop 1
    v_permlane16_swap_b32 v72, v73
    v_max_u32 v72, v72, v73
    v_mov_b32 v73, v72
    s_nop 1
    v_permlane32_swap_b32 v72, v73
    v_max_u32 v72, v72, v73
    v_cmp_eq_u32 vcc, 7, v1
    s_nop 1
    v_cndmask_b32 v74, v74, v72, vcc
    v_lshlrev_b32 v5, 2, v0
    v_add_u32 v5, 131072, v5
    ds_write_b32 v5, v74
    s_waitcnt lgkmcnt(0)
    s_barrier
    v_bfe_u32 v5, v1, 3, 2
    v_lshlrev_b32 v5, 8, v5
    v_and_b32 v6, 7, v1
    v_lshl_add_u32 v5, v6, 2, v5
    v_add_u32 v5, 131072, v5
    ds_read_b32 v64, v5
    v_mov_b32 v65, 0
    s_waitcnt lgkmcnt(0)
    v_readlane_b32 s40, v64, 0
    v_readlane_b32 s41, v64, 1
    v_readlane_b32 s42, v64, 2
    v_readlane_b32 s43, v64, 3
    v_cmp_gt_u32 s[92:93], s40, v64
    v_cmp_gt_u32 s[94:95], s41, v64
    v_cmp_gt_u32 s[96:97], s42, v64
    v_cmp_gt_u32 s[98:99], s43, v64
    v_addc_co_u32 v65, vcc, 0, v65, s[92:93]
    v_addc_co_u32 v65, vcc, 0, v65, s[94:95]
    v_addc_co_u32 v65, vcc, 0, v65, s[96:97]
    v_addc_co_u32 v65, vcc, 0, v65, s[98:99]
    v_readlane_b32 s40, v64, 4
    v_readlane_b32 s41, v64, 5
    v_readlane_b32 s42, v64, 6
    v_readlane_b32 s43, v64, 7
    v_cmp_gt_u32 s[92:93], s40, v64
    v_cmp_gt_u32 s[94:95], s41, v64
    v_cmp_gt_u32 s[96:97], s42, v64
    v_cmp_gt_u32 s[98:99], s43, v64
    v_addc_co_u32 v65, vcc, 0, v65, s[92:93]
    v_addc_co_u32 v65, vcc, 0, v65, s[94:95]
    v_addc_co_u32 v65, vcc, 0, v65, s[96:97]
    v_addc_co_u32 v65, vcc, 0, v65, s[98:99]
    v_readlane_b32 s40, v64, 8
    v_readlane_b32 s41, v64, 9
    v_readlane_b32 s42, v64, 10
    v_readlane_b32 s43, v64, 11
    v_cmp_gt_u32 s[92:93], s40, v64
    v_cmp_gt_u32 s[94:95], s41, v64
    v_cmp_gt_u32 s[96:97], s42, v64
    v_cmp_gt_u32 s[98:99], s43, v64
    v_addc_co_u32 v65, vcc, 0, v65, s[92:93]
    v_addc_co_u32 v65, vcc, 0, v65, s[94:95]
    v_addc_co_u32 v65, vcc, 0, v65, s[96:97]
    v_addc_co_u32 v65, vcc, 0, v65, s[98:99]
    v_readlane_b32 s40, v64, 12
    v_readlane_b32 s41, v64, 13
    v_readlane_b32 s42, v64, 14
    v_readlane_b32 s43, v64, 15
    v_cmp_gt_u32 s[92:93], s40, v64
    v_cmp_gt_u32 s[94:95], s41, v64
    v_cmp_gt_u32 s[96:97], s42, v64
    v_cmp_gt_u32 s[98:99], s43, v64
    v_addc_co_u32 v65, vcc, 0, v65, s[92:93]
    v_addc_co_u32 v65, vcc, 0, v65, s[94:95]
    v_addc_co_u32 v65, vcc, 0, v65, s[96:97]
    v_addc_co_u32 v65, vcc, 0, v65, s[98:99]
    v_readlane_b32 s40, v64, 16
    v_readlane_b32 s41, v64, 17
    v_readlane_b32 s42, v64, 18
    v_readlane_b32 s43, v64, 19
    v_cmp_gt_u32 s[92:93], s40, v64
    v_cmp_gt_u32 s[94:95], s41, v64
    v_cmp_gt_u32 s[96:97], s42, v64
    v_cmp_gt_u32 s[98:99], s43, v64
    v_addc_co_u32 v65, vcc, 0, v65, s[92:93]
    v_addc_co_u32 v65, vcc, 0, v65, s[94:95]
    v_addc_co_u32 v65, vcc, 0, v65, s[96:97]
    v_addc_co_u32 v65, vcc, 0, v65, s[98:99]
    v_readlane_b32 s40, v64, 20
    v_readlane_b32 s41, v64, 21
    v_readlane_b32 s42, v64, 22
    v_readlane_b32 s43, v64, 23
    v_cmp_gt_u32 s[92:93], s40, v64
    v_cmp_gt_u32 s[94:95], s41, v64
    v_cmp_gt_u32 s[96:97], s42, v64
    v_cmp_gt_u32 s[98:99], s43, v64
    v_addc_co_u32 v65, vcc, 0, v65, s[92:93]
    v_addc_co_u32 v65, vcc, 0, v65, s[94:95]
    v_addc_co_u32 v65, vcc, 0, v65, s[96:97]
    v_addc_co_u32 v65, vcc, 0, v65, s[98:99]
    v_readlane_b32 s40, v64, 24
    v_readlane_b32 s41, v64, 25
    v_readlane_b32 s42, v64, 26
    v_readlane_b32 s43, v64, 27
    v_cmp_gt_u32 s[92:93], s40, v64
    v_cmp_gt_u32 s[94:95], s41, v64
    v_cmp_gt_u32 s[96:97], s42, v64
    v_cmp_gt_u32 s[98:99], s43, v64
    v_addc_co_u32 v65, vcc, 0, v65, s[92:93]
    v_addc_co_u32 v65, vcc, 0, v65, s[94:95]
    v_addc_co_u32 v65, vcc, 0, v65, s[96:97]
    v_addc_co_u32 v65, vcc, 0, v65, s[98:99]
    v_readlane_b32 s40, v64, 28
    v_readlane_b32 s41, v64, 29
    v_readlane_b32 s42, v64, 30
    v_readlane_b32 s43, v64, 31
    v_cmp_gt_u32 s[92:93], s40, v64
    v_cmp_gt_u32 s[94:95], s41, v64
    v_cmp_gt_u32 s[96:97], s42, v64
    v_cmp_gt_u32 s[98:99], s43, v64
    v_addc_co_u32 v65, vcc, 0, v65, s[92:93]
    v_addc_co_u32 v65, vcc, 0, v65, s[94:95]
    v_addc_co_u32 v65, vcc, 0, v65, s[96:97]
    v_addc_co_u32 v65, vcc, 0, v65, s[98:99]
    v_cmp_gt_u32 vcc, 8, v65
    v_cmp_gt_u32 s[92:93], 32, v0
    v_lshlrev_b32 v5, 2, v65
    v_mov_b32 v6, 1073741824
    s_and_b64 vcc, vcc, s[92:93]
    s_nop 0
    v_cndmask_b32 v5, v6, v5, vcc
    buffer_store_dword v64, v5, s[44:47], 0 offen offset:32 sc1
    s_mov_b32 s33, 0
    s_branch L_retA
L_fallback:
    s_mov_b32 s37, 1
    s_mov_b32 s33, 0
    s_mov_b32 s38, 0x80000
    s_mov_b32 s32, 0
    s_mov_b32 s70, 1073741824
    s_mov_b32 s91, 0
    v_mov_b32 v48, 0xff800000
    v_mov_b32 v52, 0xff800000
    v_mov_b32 v56, 0xff800000
    v_mov_b32 v60, 0xff800000
    v_lshrrev_b32 v5, 4, v1
    v_xor_b32 v5, v5, v1
    v_and_b32 v5, 2, v5
    v_cmp_eq_u32 vcc, 0, v5
    v_mov_b32 v6, 0x3f803f80
    s_nop 0
    v_cndmask_b32 v5, 0, v6, vcc
    v_accvgpr_write_b32 a136, v5
    v_accvgpr_write_b32 a128, 0
    v_accvgpr_write_b32 a132, 0
    v_accvgpr_write_b32 a140, 0
    v_accvgpr_write_b32 a137, v5
    v_accvgpr_write_b32 a129, 0
    v_accvgpr_write_b32 a133, 0
    v_accvgpr_write_b32 a141, 0
    v_accvgpr_write_b32 a138, v5
    v_accvgpr_write_b32 a130, 0
    v_accvgpr_write_b32 a134, 0
    v_accvgpr_write_b32 a142, 0
    v_accvgpr_write_b32 a139, v5
    v_accvgpr_write_b32 a131, 0
    v_accvgpr_write_b32 a135, 0
    v_accvgpr_write_b32 a143, 0
    s_waitcnt vmcnt(0) lgkmcnt(0)
L_fb_loop:
    s_barrier
    s_mov_b32 m0, s31
    s_nop 0
    buffer_load_dwordx4 v20, s[16:19], s32 offen offset:0 lds
    buffer_load_dwordx4 v21, s[16:19], s32 offen offset:1024 lds
    buffer_load_dwordx4 v22, s[16:19], s32 offen offset:2048 lds
    buffer_load_dwordx4 v23, s[16:19], s32 offen offset:3072 lds
    s_waitcnt vmcnt(0)
    s_barrier
    ds_read_b128 a[64:67], v8 offset:0
    ds_read_b128 a[68:71], v9 offset:0
    ds_read_b128 a[72:75], v10 offset:0
    ds_read_b128 a[76:79], v11 offset:0
    ds_read_b128 a[80:83], v8 offset:4096
    ds_read_b128 a[84:87], v9 offset:4096
    ds_read_b128 a[88:91], v10 offset:4096
    ds_read_b128 a[92:95], v11 offset:4096
    s_waitcnt lgkmcnt(0)
    v_mfma_f32_16x16x32_bf16 v[64:67], a[64:67], a[0:3], 0
    v_mfma_f32_16x16x32_bf16 v[64:67], a[68:71], a[4:7], v[64:67]
    v_mfma_f32_16x16x32_bf16 v[64:67], a[72:75], a[8:11], v[64:67]
    v_mfma_f32_16x16x32_bf16 v[64:67], a[76:79], a[12:15], v[64:67]
    v_mfma_f32_16x16x32_bf16 v[68:71], a[92:95], a[12:15], 0
    v_mfma_f32_16x16x32_bf16 v[68:71], a[88:91], a[8:11], v[68:71]
    v_mfma_f32_16x16x32_bf16 v[68:71], a[84:87], a[4:7], v[68:71]
    v_mfma_f32_16x16x32_bf16 v[68:71], a[80:83], a[0:3], v[68:71]
    v_mfma_f32_16x16x32_bf16 v[76:79], a[80:83], a[16:19], 0
    v_mfma_f32_16x16x32_bf16 v[76:79], a[84:87], a[20:23], v[76:79]
    v_mfma_f32_16x16x32_bf16 v[76:79], a[88:91], a[24:27], v[76:79]
    v_mfma_f32_16x16x32_bf16 v[76:79], a[92:95], a[28:31], v[76:79]
    v_mfma_f32_16x16x32_bf16 v[72:75], a[76:79], a[28:31], 0
    v_mfma_f32_16x16x32_bf16 v[72:75], a[72:75], a[24:27], v[72:75]
    v_mfma_f32_16x16x32_bf16 v[72:75], a[68:71], a[20:23], v[72:75]
    v_mfma_f32_16x16x32_bf16 v[72:75], a[64:67], a[16:19], v[72:75]
    v_mfma_f32_16x16x32_bf16 v[80:83], a[64:67], a[32:35], 0
    v_mfma_f32_16x16x32_bf16 v[80:83], a[68:71], a[36:39], v[80:83]
    v_mfma_f32_16x16x32_bf16 v[80:83], a[72:75], a[40:43], v[80:83]
    v_mfma_f32_16x16x32_bf16 v[80:83], a[76:79], a[44:47], v[80:83]
    v_mfma_f32_16x16x32_bf16 v[84:87], a[92:95], a[44:47], 0
    v_mfma_f32_16x16x32_bf16 v[84:87], a[88:91], a[40:43], v[84:87]
    v_mfma_f32_16x16x32_bf16 v[84:87], a[84:87], a[36:39], v[84:87]
    v_mfma_f32_16x16x32_bf16 v[84:87], a[80:83], a[32:35], v[84:87]
    v_mfma_f32_16x16x32_bf16 v[92:95], a[80:83], a[48:51], 0
    v_mfma_f32_16x16x32_bf16 v[92:95], a[84:87], a[52:55], v[92:95]
    v_mfma_f32_16x16x32_bf16 v[92:95], a[88:91], a[56:59], v[92:95]
    v_mfma_f32_16x16x32_bf16 v[92:95], a[92:95], a[60:63], v[92:95]
    v_mfma_f32_16x16x32_bf16 v[88:91], a[76:79], a[60:63], 0
    v_mfma_f32_16x16x32_bf16 v[88:91], a[72:75], a[56:59], v[88:91]
    v_mfma_f32_16x16x32_bf16 v[88:91], a[68:71], a[52:55], v[88:91]
    v_mfma_f32_16x16x32_bf16 v[88:91], a[64:67], a[48:51], v[88:91]
    s_nop 7
    v_max3_f32 v48, v48, v64, v65
    v_max3_f32 v48, v48, v66, v67
    v_max3_f32 v48, v48, v68, v69
    v_max3_f32 v48, v48, v70, v71
    v_max3_f32 v52, v52, v72, v73
    v_max3_f32 v52, v52, v74, v75
    v_max3_f32 v52, v52, v76, v77
    v_max3_f32 v52, v52, v78, v79
    v_max3_f32 v56, v56, v80, v81
    v_max3_f32 v56, v56, v82, v83
    v_max3_f32 v56, v56, v84, v85
    v_max3_f32 v56, v56, v86, v87
    v_max3_f32 v60, v60, v88, v89
    v_max3_f32 v60, v60, v90, v91
    v_max3_f32 v60, v60, v92, v93
    v_max3_f32 v60, v60, v94, v95
    ds_read_b128 a[64:67], v8 offset:8192
    ds_read_b128 a[68:71], v9 offset:8192
    ds_read_b128 a[72:75], v10 offset:8192
    ds_read_b128 a[76:79], v11 offset:8192
    ds_read_b128 a[80:83], v8 offset:12288
    ds_read_b128 a[84:87], v9 offset:12288
    ds_read_b128 a[88:91], v10 offset:12288
    ds_read_b128 a[92:95], v11 offset:12288
    s_waitcnt lgkmcnt(0)
    v_mfma_f32_16x16x32_bf16 v[64:67], a[64:67], a[0:3], 0
    v_mfma_f32_16x16x32_bf16 v[64:67], a[68:71], a[4:7], v[64:67]
    v_mfma_f32_16x16x32_bf16 v[64:67], a[72:75], a[8:11], v[64:67]
    v_mfma_f32_16x16x32_bf16 v[64:67], a[76:79], a[12:15], v[64:67]
    v_mfma_f32_16x16x32_bf16 v[68:71], a[92:95], a[12:15], 0
    v_mfma_f32_16x16x32_bf16 v[68:71], a[88:91], a[8:11], v[68:71]
    v_mfma_f32_16x16x32_bf16 v[68:71], a[84:87], a[4:7], v[68:71]
    v_mfma_f32_16x16x32_bf16 v[68:71], a[80:83], a[0:3], v[68:71]
    v_mfma_f32_16x16x32_bf16 v[76:79], a[80:83], a[16:19], 0
    v_mfma_f32_16x16x32_bf16 v[76:79], a[84:87], a[20:23], v[76:79]
    v_mfma_f32_16x16x32_bf16 v[76:79], a[88:91], a[24:27], v[76:79]
    v_mfma_f32_16x16x32_bf16 v[76:79], a[92:95], a[28:31], v[76:79]
    v_mfma_f32_16x16x32_bf16 v[72:75], a[76:79], a[28:31], 0
    v_mfma_f32_16x16x32_bf16 v[72:75], a[72:75], a[24:27], v[72:75]
    v_mfma_f32_16x16x32_bf16 v[72:75], a[68:71], a[20:23], v[72:75]
    v_mfma_f32_16x16x32_bf16 v[72:75], a[64:67], a[16:19], v[72:75]
    v_mfma_f32_16x16x32_bf16 v[80:83], a[64:67], a[32:35], 0
    v_mfma_f32_16x16x32_bf16 v[80:83], a[68:71], a[36:39], v[80:83]
    v_mfma_f32_16x16x32_bf16 v[80:83], a[72:75], a[40:43], v[80:83]
    v_mfma_f32_16x16x32_bf16 v[80:83], a[76:79], a[44:47], v[80:83]
    v_mfma_f32_16x16x32_bf16 v[84:87], a[92:95], a[44:47], 0
    v_mfma_f32_16x16x32_bf16 v[84:87], a[88:91], a[40:43], v[84:87]
    v_mfma_f32_16x16x32_bf16 v[84:87], a[84:87], a[36:39], v[84:87]
    v_mfma_f32_16x16x32_bf16 v[84:87], a[80:83], a[32:35], v[84:87]
    v_mfma_f32_16x16x32_bf16 v[92:95], a[80:83], a[48:51], 0
    v_mfma_f32_16x16x32_bf16 v[92:95], a[84:87], a[52:55], v[92:95]
    v_mfma_f32_16x16x32_bf16 v[92:95], a[88:91], a[56:59], v[92:95]
    v_mfma_f32_16x16x32_bf16 v[92:95], a[92:95], a[60:63], v[92:95]
    v_mfma_f32_16x16x32_bf16 v[88:91], a[76:79], a[60:63], 0
    v_mfma_f32_16x16x32_bf16 v[88:91], a[72:75], a[56:59], v[88:91]
    v_mfma_f32_16x16x32_bf16 v[88:91], a[68:71], a[52:55], v[88:91]
    v_mfma_f32_16x16x32_bf16 v[88:91], a[64:67], a[48:51], v[88:91]
    s_nop 7
    v_max3_f32 v48, v48, v64, v65
    v_max3_f32 v48, v48, v66, v67
    v_max3_f32 v48, v48, v68, v69
    v_max3_f32 v48, v48, v70, v71
    v_max3_f32 v52, v52, v72, v73
    v_max3_f32 v52, v52, v74, v75
    v_max3_f32 v52, v52, v76, v77
    v_max3_f32 v52, v52, v78, v79
    v_max3_f32 v56, v56, v80, v81
    v_max3_f32 v56, v56, v82, v83
    v_max3_f32 v56, v56, v84, v85
    v_max3_f32 v56, v56, v86, v87
    v_max3_f32 v60, v60, v88, v89
    v_max3_f32 v60, v60, v90, v91
    v_max3_f32 v60, v60, v92, v93
    v_max3_f32 v60, v60, v94, v95
    s_add_u32 s32, s32, 16384
    s_cmp_lt_u32 s32, 524288
    s_cbranch_scc1 L_fb_loop
    v_mov_b32 v49, v48
    v_mov_b32 v53, v52
    v_mov_b32 v57, v56
    v_mov_b32 v61, v60
    v_permlane16_swap_b32 v48, v49
    v_permlane16_swap_b32 v52, v53
    v_permlane16_swap_b32 v56, v57
    v_permlane16_swap_b32 v60, v61
    v_max_f32 v48, v48, v49
    v_max_f32 v52, v52, v53
    v_max_f32 v56, v56, v57
    v_max_f32 v60, v60, v61
    v_mov_b32 v49, v48
    v_mov_b32 v53, v52
    v_mov_b32 v57, v56
    v_mov_b32 v61, v60
    v_permlane32_swap_b32 v48, v49
    v_permlane32_swap_b32 v52, v53
    v_permlane32_swap_b32 v56, v57
    v_permlane32_swap_b32 v60, v61
    v_max_f32 v48, v48, v49
    v_max_f32 v52, v52, v53
    v_max_f32 v56, v56, v57
    v_max_f32 v60, v60, v61
    v_sub_f32 v51, 0, v48
    v_sub_f32 v50, 0, v48
    v_sub_f32 v49, 0, v48
    v_sub_f32 v48, 0, v48
    v_sub_f32 v55, 0, v52
    v_sub_f32 v54, 0, v52
    v_sub_f32 v53, 0, v52
    v_sub_f32 v52, 0, v52
    v_sub_f32 v59, 0, v56
    v_sub_f32 v58, 0, v56
    v_sub_f32 v57, 0, v56
    v_sub_f32 v56, 0, v56
    v_sub_f32 v63, 0, v60
    v_sub_f32 v62, 0, v60
    v_sub_f32 v61, 0, v60
    v_sub_f32 v60, 0, v60
    s_mov_b32 s32, 0
    s_mov_b32 s39, 0
    s_barrier
    s_add_u32 m0, s31, 0
    s_nop 0
    buffer_load_dwordx4 v20, s[16:19], s32 offen offset:0 lds
    buffer_load_dwordx4 v21, s[16:19], s32 offen offset:1024 lds
    buffer_load_dwordx4 v22, s[16:19], s32 offen offset:2048 lds
    buffer_load_dwordx4 v23, s[16:19], s32 offen offset:3072 lds
    s_add_u32 s32, s32, 16384
    s_add_u32 m0, s31, 16384
    s_nop 0
    buffer_load_dwordx4 v20, s[16:19], s32 offen offset:0 lds
    buffer_load_dwordx4 v21, s[16:19], s32 offen offset:1024 lds
    buffer_load_dwordx4 v22, s[16:19], s32 offen offset:2048 lds
    buffer_load_dwordx4 v23, s[16:19], s32 offen offset:3072 lds
    s_add_u32 s32, s32, 16384
    s_add_u32 m0, s31, 65536
    s_nop 0
    buffer_load_dwordx4 v24, s[20:23], s39 offen offset:0 lds
    buffer_load_dwordx4 v25, s[20:23], s39 offen offset:1024 lds
    buffer_load_dwordx4 v24, s[20:23], s39 offen offset:2048 lds
    buffer_load_dwordx4 v25, s[20:23], s39 offen offset:3072 lds
    s_add_u32 s39, s39, 16384
    s_add_u32 m0, s31, 32768
    s_nop 0
    buffer_load_dwordx4 v20, s[16:19], s32 offen offset:0 lds
    buffer_load_dwordx4 v21, s[16:19], s32 offen offset:1024 lds
    buffer_load_dwordx4 v22, s[16:19], s32 offen offset:2048 lds
    buffer_load_dwordx4 v23, s[16:19], s32 offen offset:3072 lds
    s_add_u32 s32, s32, 16384
    s_add_u32 m0, s31, 81920
    s_nop 0
    buffer_load_dwordx4 v24, s[20:23], s39 offen offset:0 lds
    buffer_load_dwordx4 v25, s[20:23], s39 offen offset:1024 lds
    buffer_load_dwordx4 v24, s[20:23], s39 offen offset:2048 lds
    buffer_load_dwordx4 v25, s[20:23], s39 offen offset:3072 lds
    s_add_u32 s39, s39, 16384
    s_waitcnt vmcnt(0)
    s_barrier
    ds_read_b128 a[64:67], v8 offset:0
    ds_read_b128 a[68:71], v9 offset:0
    ds_read_b128 a[72:75], v10 offset:0
    ds_read_b128 a[76:79], v11 offset:0
    ds_read_b128 a[80:83], v8 offset:4096
    ds_read_b128 a[84:87], v9 offset:4096
    ds_read_b128 a[88:91], v10 offset:4096
    ds_read_b128 a[92:95], v11 offset:4096
    s_waitcnt lgkmcnt(0)
    v_mfma_f32_16x16x32_bf16 v[64:67], a[64:67], a[0:3], v[48:51]
    v_mfma_f32_16x16x32_bf16 v[64:67], a[68:71], a[4:7], v[64:67]
    v_mfma_f32_16x16x32_bf16 v[64:67], a[72:75], a[8:11], v[64:67]
    v_mfma_f32_16x16x32_bf16 v[64:67], a[76:79], a[12:15], v[64:67]
    v_mfma_f32_16x16x32_bf16 v[68:71], a[92:95], a[12:15], v[48:51]
    v_mfma_f32_16x16x32_bf16 v[68:71], a[88:91], a[8:11], v[68:71]
    v_mfma_f32_16x16x32_bf16 v[68:71], a[84:87], a[4:7], v[68:71]
    v_mfma_f32_16x16x32_bf16 v[68:71], a[80:83], a[0:3], v[68:71]
    v_mfma_f32_16x16x32_bf16 v[76:79], a[80:83], a[16:19], v[52:55]
    v_mfma_f32_16x16x32_bf16 v[76:79], a[84:87], a[20:23], v[76:79]
    v_mfma_f32_16x16x32_bf16 v[76:79], a[88:91], a[24:27], v[76:79]
    v_mfma_f32_16x16x32_bf16 v[76:79], a[92:95], a[28:31], v[76:79]
    v_mfma_f32_16x16x32_bf16 v[72:75], a[76:79], a[28:31], v[52:55]
    v_mfma_f32_16x16x32_bf16 v[72:75], a[72:75], a[24:27], v[72:75]
    v_mfma_f32_16x16x32_bf16 v[72:75], a[68:71], a[20:23], v[72:75]
    v_mfma_f32_16x16x32_bf16 v[72:75], a[64:67], a[16:19], v[72:75]
    v_mfma_f32_16x16x32_bf16 v[80:83], a[64:67], a[32:35], v[56:59]
    v_mfma_f32_16x16x32_bf16 v[80:83], a[68:71], a[36:39], v[80:83]
    v_mfma_f32_16x16x32_bf16 v[80:83], a[72:75], a[40:43], v[80:83]
    v_mfma_f32_16x16x32_bf16 v[80:83], a[76:79], a[44:47], v[80:83]
    v_mfma_f32_16x16x32_bf16 v[84:87], a[92:95], a[44:47], v[56:59]
    v_mfma_f32_16x16x32_bf16 v[84:87], a[88:91], a[40:43], v[84:87]
    v_mfma_f32_16x16x32_bf16 v[84:87], a[84:87], a[36:39], v[84:87]
    v_mfma_f32_16x16x32_bf16 v[84:87], a[80:83], a[32:35], v[84:87]
    v_mfma_f32_16x16x32_bf16 v[92:95], a[80:83], a[48:51], v[60:63]
    v_mfma_f32_16x16x32_bf16 v[92:95], a[84:87], a[52:55], v[92:95]
    v_mfma_f32_16x16x32_bf16 v[92:95], a[88:91], a[56:59], v[92:95]
    v_mfma_f32_16x16x32_bf16 v[92:95], a[92:95], a[60:63], v[92:95]
    v_mfma_f32_16x16x32_bf16 v[88:91], a[76:79], a[60:63], v[60:63]
    v_mfma_f32_16x16x32_bf16 v[88:91], a[72:75], a[56:59], v[88:91]
    v_mfma_f32_16x16x32_bf16 v[88:91], a[68:71], a[52:55], v[88:91]
    v_mfma_f32_16x16x32_bf16 v[88:91], a[64:67], a[48:51], v[88:91]
    s_nop 7
    ds_read_b128 a[64:67], v8 offset:8192
    ds_read_b128 a[68:71], v9 offset:8192
    ds_read_b128 a[72:75], v10 offset:8192
    ds_read_b128 a[76:79], v11 offset:8192
    ds_read_b128 a[80:83], v8 offset:12288
    ds_read_b128 a[84:87], v9 offset:12288
    ds_read_b128 a[88:91], v10 offset:12288
    ds_read_b128 a[92:95], v11 offset:12288
    s_branch L_sm0
L_end:
    s_endpgm
.section .rodata,"a"
.p2align 6
.amdhsa_kernel recurrent_scan__mha_block_cached__moe_arch_mod__prompt_kernel
  .amdhsa_next_free_vgpr 512
  .amdhsa_next_free_sgpr 102
  .amdhsa_accum_offset 256
  .amdhsa_group_segment_fixed_size 0
  .amdhsa_kernarg_size 104
  .amdhsa_user_sgpr_count 2
  .amdhsa_user_sgpr_kernarg_segment_ptr 1
  .amdhsa_system_sgpr_workgroup_id_x 1
.end_amdhsa_kernel
```
